```python
import torch

def _softmax(x, axis=-1):
    return torch.softmax(x, dim=axis)
def _gelu(x):
    return torch.nn.functional.gelu(x, approximate="tanh")
def _silu(x):
    return torch.nn.functional.silu(x)
def _sigmoid(x):
    return torch.sigmoid(x)
def _layernorm(x, axis=-1, eps=1e-5):
    m = x.mean(dim=axis, keepdim=True)
    v = x.var(dim=axis, keepdim=True, unbiased=False)
    return (x - m) / torch.sqrt(v + eps)
def _scatter_add(tgt, idx, src, axis=0):
    return tgt.clone().index_add_(axis, idx, src)
def _segment_sum(src, seg, n):
    out = torch.zeros((n,) + src.shape[1:], dtype=src.dtype)
    return out.index_add_(0, seg, src)
def _pad(x, pw):
    flat = tuple(v for pair in reversed(pw) for v in pair)
    return torch.nn.functional.pad(x, flat)

kernel_name = 'sequential_preLN__sliding_local_dilated__geglu_ffn__prompt'

def setup_inputs():

    _w = (lambda a: (lambda t: t.to(torch.bfloat16) if t.is_floating_point() else t)(torch.as_tensor(a)))
    def _A_setup():
        B, S, D = 1, 2048, 1024
        return {
            "x": _w((lambda *s: torch.randn(*s, dtype=torch.bfloat16) * 0.05)(B, S, D)),
            "wqkv": _w((lambda *s: torch.randn(*s, dtype=torch.bfloat16) * 0.05)(D, 3 * D)),
            "wo": _w((lambda *s: torch.randn(*s, dtype=torch.bfloat16) * 0.05)(D, D)),
        }
    _A_in = _A_setup()

    def _B_setup():
        B, S, D, F = 1, 2048, 1024, 3584
        return {
            "x": _w((lambda *s: torch.randn(*s, dtype=torch.bfloat16) * 0.05)(B, S, D)),
            "w_gate": _w((lambda *s: torch.randn(*s, dtype=torch.bfloat16) * 0.05)(D, F)),
            "w_up": _w((lambda *s: torch.randn(*s, dtype=torch.bfloat16) * 0.05)(D, F)),
            "w_down": _w((lambda *s: torch.randn(*s, dtype=torch.bfloat16) * 0.05)(F, D)),
        }
    _B_in = _B_setup()

    return {
        "A_x": _A_in["x"],
        "A_wqkv": _A_in["wqkv"],
        "A_wo": _A_in["wo"],
        "B_x": _B_in["x"],
        "B_w_gate": _B_in["w_gate"],
        "B_w_up": _B_in["w_up"],
        "B_w_down": _B_in["w_down"],
    }

def reference(A_x, A_wqkv, A_wo, B_x, B_w_gate, B_w_up, B_w_down):
    def _A_ref(x, wqkv, wo):
        B, S, D = x.shape
        H = 32; Dh = D // H
        W, dil = 8, 2
        qkv = (lambda x, *d: x.permute(*d))((x @ wqkv).reshape(B, S, 3, H, Dh), 2, 0, 3, 1, 4)
        q, k, v = qkv[0], qkv[1], qkv[2]
        scale = Dh ** -0.5
        pos = torch.arange(S)
        off = torch.arange(W) * dil
        idx = pos[:, None] - off[None, :]
        mask = idx >= 0
        idx_c = torch.where(mask, idx, 0).reshape(-1)
        kg = k[:, :, idx_c, :].reshape(B, H, S, W, Dh)
        vg = v[:, :, idx_c, :].reshape(B, H, S, W, Dh)
        logits = torch.einsum("bhsd,bhswd->bhsw", q, kg) * scale
        logits = torch.where(mask[None, None, :, :], logits, -1e9)
        attn = _softmax(logits, axis=-1)
        o = torch.einsum("bhsw,bhswd->bhsd", attn, vg)
        return (lambda x, *d: x.permute(*d))(o, 0, 2, 1, 3).reshape(B, S, D) @ wo

    def _B_ref(x, w_gate, w_up, w_down):
        return (_gelu(x @ w_gate) * (x @ w_up)) @ w_down

    x = A_x
    h = x + _A_ref(_layernorm(x, axis=-1), A_wqkv, A_wo)
    h2 = h + _B_ref(_layernorm(h, axis=-1), B_w_gate, B_w_up, B_w_down)
    return h2
```

```asm
; @launch grid=(256,1,1) block=(256,1,1) lds=163840
.amdgcn_target "amdgcn-amd-amdhsa--gfx950"

.macro MF d, a, b
    v_mfma_f32_16x16x32_bf16 v[\d:\d+3], a[\a:\a+3], a[\b:\b+3], v[\d:\d+3]
.endm
.macro TR d, r, o
    ds_read_b64_tr_b16 a[\d:\d+1], v[\r] offset:\o
.endm
.macro XL d, r, o
    buffer_load_dwordx4 a[\d:\d+3], v[\r], s[36:39], s44 offen offset:\o
.endm
.macro WN r, o
    buffer_load_dwordx4 v[\r], s[40:43], s45 offen offset:\o nt lds
.endm
.macro WL r, o
    buffer_load_dwordx4 v[\r], s[40:43], s45 offen offset:\o  lds
.endm
.text
.globl sequential_preLN__sliding_local_dilated__geglu_ffn__prompt_kernel
.p2align 12
.type sequential_preLN__sliding_local_dilated__geglu_ffn__prompt_kernel,@function
sequential_preLN__sliding_local_dilated__geglu_ffn__prompt_kernel:
 s_cmp_ge_u32 s2, 256
 s_cbranch_scc1 L_sequential_preLN__sliding_local_dilated__geglu_ffn__prompt_kernel_end
 s_load_dwordx16 s[16:31], s[0:1], 0
 s_load_dwordx4 s[32:35], s[0:1], 64
 s_and_b32 s3, s2, 7
 s_lshr_b32 s4, s2, 3
 v_lshrrev_b32 v2, 6, v0
 v_and_b32 v1, 63, v0
 v_readfirstlane_b32 s7, v2
 v_and_b32 v3, 15, v1
 v_lshrrev_b32 v4, 4, v1
 s_memrealtime s[98:99]
 s_and_b32 s5, s3, 1
 s_lshl_b32 s5, s5, 3
 s_and_b32 s9, s4, 7
 s_add_u32 s5, s5, s9
 s_lshr_b32 s6, s3, 1
 s_lshl_b32 s6, s6, 2
 s_lshr_b32 s9, s4, 3
 s_add_u32 s6, s6, s9
 v_lshlrev_b32 v5, 4, v1
 s_lshl_b32 s8, s5, 3
 s_lshl_b32 s9, s7, 1
 s_add_u32 s8, s8, s9
 s_lshl_b32 s44, s8, 15
 s_sub_u32 s44, s44, 128
 v_lshrrev_b32 v20, 3, v1
 v_and_b32 v21, 7, v1
 v_lshrrev_b32 v22, 1, v20
 v_xor_b32 v21, v21, v22
 v_lshlrev_b32 v20, 11, v20
 v_lshl_add_u32 v196, v21, 4, v20
 v_xor_b32 v21, 64, v196
 v_add_u32 v197, 15360, v21
 v_add_u32 v198, 30720, v196
 v_add_u32 v199, 46080, v21
 s_lshl_b32 s72, s7, 12
 s_add_u32 s72, s72, 114688
 s_bitcmp1_b32 s7, 0
 s_cselect_b32 s9, 16448, 0
 v_xor_b32 v202, s9, v196
 v_lshrrev_b32 v20, 3, v1
 v_bfe_u32 v21, v1, 4, 1
 s_and_b32 s9, s7, 1
 s_lshl_b32 s9, s9, 1
 v_or_b32 v21, s9, v21
 v_bfe_u32 v22, v1, 1, 2
 v_xor_b32 v22, v22, v21
 v_and_b32 v23, 1, v1
 v_lshlrev_b32 v22, 5, v22
 v_lshl_add_u32 v22, v23, 4, v22
 v_lshl_add_u32 v20, s7, 3, v20
 s_movk_i32 s9, 6144
 v_mul_u32_u24 v20, s9, v20
 s_lshl_b32 s9, s6, 7
 v_add3_u32 v7, v20, v22, s9
 v_add_u32 v8, 1024, v7
 v_add_u32 v9, 2048, v7
 s_mov_b32 s45, 0xfffd0000
 s_mul_i32 s46, s7, 3072
 s_lshl_b32 s11, s2, 2
 s_add_u32 s11, s11, s7
 s_lshl_b32 s9, s5, 3
 s_sub_u32 s9, s9, 1
 s_max_i32 s9, s9, 0
 s_lshl_b32 s66, s9, 7
 s_lshl_b32 s65, s8, 7
 s_lshl_b32 s67, s9, 15
 s_lshr_b32 s10, s7, 1
 s_lshl_b32 s10, s10, 7
 s_add_u32 s67, s67, s10
 s_sub_u32 s67, s67, 256
 s_lshl_b32 s68, s7, 10
 s_add_u32 s68, s68, 98304
 s_lshl_b32 s75, s11, 12
 v_mov_b32 v30, 0
 s_waitcnt lgkmcnt(0)
 s_mov_b32 s36, s16
 s_mov_b32 s37, s17
 s_mov_b32 s38, 4194304
 s_mov_b32 s39, 0x00020000
 s_mov_b32 s40, s18
 s_mov_b32 s41, s19
 s_mov_b32 s42, 6291456
 s_mov_b32 s43, 0x00020000
 s_lshr_b32 s76, s18, 7
 s_sub_u32 s76, 3, s76
 s_lshr_b32 s78, s4, 3
 s_xor_b32 s78, s78, s76
 s_bfe_u32 s78, s78, 0x10001
 s_and_b32 s79, s4, 15
 s_lshl_b32 s79, s79, 3
 s_add_u32 s79, s79, s3
 buffer_load_dwordx4 v[32:35], v5, s[36:39], s75 offen offset:0
 buffer_load_dwordx4 v[36:39], v5, s[36:39], s75 offen offset:1024
 buffer_load_dwordx4 v[40:43], v5, s[36:39], s75 offen offset:2048
 buffer_load_dwordx4 v[44:47], v5, s[36:39], s75 offen offset:3072
 s_add_u32 m0, s46, 0
 s_add_u32 s45, s45, 196608
 WL 7,0
 s_mov_b32 s52, s32
 s_mov_b32 s53, s33
 s_mov_b32 s54, 256
 s_mov_b32 s55, 0x00020000
 s_or_b32 s98, s98, 8
 s_and_b32 s98, s98, -8
 v_mov_b32 v31, s98
 s_cmp_eq_u32 s11, 0
 s_cselect_b32 s76, 0, 256
 buffer_store_dword v31, v30, s[52:55], s76 offen sc0 sc1
 s_and_b32 s76, s4, 7
 s_cmp_eq_u32 s7, 0
 s_cbranch_scc1 L_sp_w0
 s_cmp_eq_u32 s7, 1
 s_cbranch_scc1 L_sp_w1
 s_cmp_eq_u32 s7, 2
 s_cbranch_scc1 L_sp_w2
L_sp_w3:
 s_cmp_eq_u32 s76, 0
 s_cbranch_scc1 L_sequential_preLN__sliding_local_dilated__geglu_ffn__prompt_kernel_sp_e3
 s_cmp_eq_u32 s76, 1
 s_cbranch_scc1 L_sequential_preLN__sliding_local_dilated__geglu_ffn__prompt_kernel_sp_e7
 s_cmp_eq_u32 s76, 2
 s_cbranch_scc1 L_sequential_preLN__sliding_local_dilated__geglu_ffn__prompt_kernel_sp_e11
 s_cmp_eq_u32 s76, 3
 s_cbranch_scc1 L_sequential_preLN__sliding_local_dilated__geglu_ffn__prompt_kernel_sp_e15
 s_cmp_eq_u32 s76, 4
 s_cbranch_scc1 L_sequential_preLN__sliding_local_dilated__geglu_ffn__prompt_kernel_sp_e19
 s_cmp_eq_u32 s76, 5
 s_cbranch_scc1 L_sequential_preLN__sliding_local_dilated__geglu_ffn__prompt_kernel_sp_e23
 s_cmp_eq_u32 s76, 6
 s_cbranch_scc1 L_sequential_preLN__sliding_local_dilated__geglu_ffn__prompt_kernel_sp_e27
 s_branch L_sequential_preLN__sliding_local_dilated__geglu_ffn__prompt_kernel_sp_e31
L_sp_w0:
 s_cmp_eq_u32 s76, 0
 s_cbranch_scc1 L_sequential_preLN__sliding_local_dilated__geglu_ffn__prompt_kernel_sp_e0
 s_cmp_eq_u32 s76, 1
 s_cbranch_scc1 L_sequential_preLN__sliding_local_dilated__geglu_ffn__prompt_kernel_sp_e4
 s_cmp_eq_u32 s76, 2
 s_cbranch_scc1 L_sequential_preLN__sliding_local_dilated__geglu_ffn__prompt_kernel_sp_e8
 s_cmp_eq_u32 s76, 3
 s_cbranch_scc1 L_sequential_preLN__sliding_local_dilated__geglu_ffn__prompt_kernel_sp_e12
 s_cmp_eq_u32 s76, 4
 s_cbranch_scc1 L_sequential_preLN__sliding_local_dilated__geglu_ffn__prompt_kernel_sp_e16
 s_cmp_eq_u32 s76, 5
 s_cbranch_scc1 L_sequential_preLN__sliding_local_dilated__geglu_ffn__prompt_kernel_sp_e20
 s_cmp_eq_u32 s76, 6
 s_cbranch_scc1 L_sequential_preLN__sliding_local_dilated__geglu_ffn__prompt_kernel_sp_e24
 s_branch L_sequential_preLN__sliding_local_dilated__geglu_ffn__prompt_kernel_sp_e28
L_sp_w1:
 s_cmp_eq_u32 s76, 0
 s_cbranch_scc1 L_sequential_preLN__sliding_local_dilated__geglu_ffn__prompt_kernel_sp_e1
 s_cmp_eq_u32 s76, 1
 s_cbranch_scc1 L_sequential_preLN__sliding_local_dilated__geglu_ffn__prompt_kernel_sp_e5
 s_cmp_eq_u32 s76, 2
 s_cbranch_scc1 L_sequential_preLN__sliding_local_dilated__geglu_ffn__prompt_kernel_sp_e9
 s_cmp_eq_u32 s76, 3
 s_cbranch_scc1 L_sequential_preLN__sliding_local_dilated__geglu_ffn__prompt_kernel_sp_e13
 s_cmp_eq_u32 s76, 4
 s_cbranch_scc1 L_sequential_preLN__sliding_local_dilated__geglu_ffn__prompt_kernel_sp_e17
 s_cmp_eq_u32 s76, 5
 s_cbranch_scc1 L_sequential_preLN__sliding_local_dilated__geglu_ffn__prompt_kernel_sp_e21
 s_cmp_eq_u32 s76, 6
 s_cbranch_scc1 L_sequential_preLN__sliding_local_dilated__geglu_ffn__prompt_kernel_sp_e25
 s_branch L_sequential_preLN__sliding_local_dilated__geglu_ffn__prompt_kernel_sp_e29
L_sp_w2:
 s_cmp_eq_u32 s76, 0
 s_cbranch_scc1 L_sequential_preLN__sliding_local_dilated__geglu_ffn__prompt_kernel_sp_e2
 s_cmp_eq_u32 s76, 1
 s_cbranch_scc1 L_sequential_preLN__sliding_local_dilated__geglu_ffn__prompt_kernel_sp_e6
 s_cmp_eq_u32 s76, 2
 s_cbranch_scc1 L_sequential_preLN__sliding_local_dilated__geglu_ffn__prompt_kernel_sp_e10
 s_cmp_eq_u32 s76, 3
 s_cbranch_scc1 L_sequential_preLN__sliding_local_dilated__geglu_ffn__prompt_kernel_sp_e14
 s_cmp_eq_u32 s76, 4
 s_cbranch_scc1 L_sequential_preLN__sliding_local_dilated__geglu_ffn__prompt_kernel_sp_e18
 s_cmp_eq_u32 s76, 5
 s_cbranch_scc1 L_sequential_preLN__sliding_local_dilated__geglu_ffn__prompt_kernel_sp_e22
 s_cmp_eq_u32 s76, 6
 s_cbranch_scc1 L_sequential_preLN__sliding_local_dilated__geglu_ffn__prompt_kernel_sp_e26
 s_branch L_sequential_preLN__sliding_local_dilated__geglu_ffn__prompt_kernel_sp_e30
L_sequential_preLN__sliding_local_dilated__geglu_ffn__prompt_kernel_sp_ret:
 WL 8,1024
 WL 9,2048
 s_add_u32 m0, s46, 12288
 s_add_u32 s45, s45, 196608
 WL 7,0
 WL 8,1024
 WL 9,2048
 s_add_u32 m0, s72, 0
 s_add_u32 s44, s44, 128
 buffer_load_dwordx4 v196, s[36:39], s44 offen offset:0 lds
 buffer_load_dwordx4 v197, s[36:39], s44 offen offset:1024 lds
 buffer_load_dwordx4 v198, s[36:39], s44 offen offset:2048 lds
 buffer_load_dwordx4 v199, s[36:39], s44 offen offset:3072 lds
 s_add_u32 m0, s68, 0
 s_add_u32 s67, s67, 256
 buffer_load_dwordx4 v202, s[36:39], s67 offen lds
 s_add_u32 s60, s34, 14680064
 s_addc_u32 s61, s35, 0
 s_mov_b32 s62, 262144
 s_mov_b32 s63, 0x00020000
 s_add_u32 s56, s34, 13631488
 s_addc_u32 s57, s35, 0
 s_mov_b32 s58, 135168
 s_mov_b32 s59, 0x00020000
 v_lshrrev_b32 v26, 2, v3
 v_and_b32 v27, 3, v3
 v_lshrrev_b32 v28, 1, v26
 v_and_b32 v29, 1, v4
 v_lshl_or_b32 v28, v29, 1, v28
 v_mul_u32_u24 v29, 3072, v4
 v_lshl_add_u32 v29, v26, 7, v29
 v_lshl_add_u32 v29, v27, 3, v29
 v_lshl_add_u32 v29, v28, 5, v29
 s_lshl_b32 s9, s7, 5
 v_xor_b32 v21, s9, v29
 v_add_u32 v22, 49152, v21
 v_lshlrev_b32 v23, 4, v4
 v_lshlrev_b32 v24, 2, v3
 v_lshrrev_b32 v26, 1, v3
 v_xor_b32 v27, v4, v26
 v_lshlrev_b32 v28, 7, v3
 v_lshl_add_u32 v27, v27, 4, v28
 v_add_u32 v2, s72, v27
 v_xor_b32 v6, 64, v2
 v_lshrrev_b32 v48, 1, v4
 v_xor_b32 v48, v48, v26
 v_lshl_add_u32 v48, v48, 4, v28
 v_and_b32 v49, 1, v4
 v_lshl_add_u32 v48, v49, 3, v48
 v_add_u32 v226, s72, v48
 v_cmp_eq_u32 vcc, 0, v3
 v_add_u32 v27, 98304, v27
 v_xor_b32 v28, 64, v27
 v_mov_b32 v26, 110592
 v_cndmask_b32 v200, v27, v26, vcc
 v_cndmask_b32 v201, v28, v26, vcc
 v_cndmask_b32 v20, 1, 0, vcc
 s_lshl_b32 s9, s7, 6
 s_add_u32 s9, s9, 159744
 v_add_u32 v26, 160768, v5
 v_add_u32 v27, s9, v23
 v_cndmask_b32 v229, v26, v27, vcc
 v_add_u32 v230, 159744, v23
 v_cmp_eq_u32 vcc, 0, v4
 s_add_u32 s9, s9, 512
 v_add_u32 v27, s9, v24
 v_lshlrev_b32 v28, 3, v0
 v_cndmask_b32 v0, v26, v27, vcc
 s_lshl_b32 s9, s7, 12
 s_add_u32 s9, s9, 139264
 v_add_u32 v231, s9, v5
 v_mov_b32 v26, 0x3f803f80
 v_mov_b32 v27, 0x3f803f80
 v_and_b32 v28, 1, v1
 v_lshlrev_b32 v28, 3, v28
 v_add_u32 v28, 110592, v28
 ds_write_b64 v28, v[26:27]
 v_xor_b32 v10, 0, v29
 v_add_u32 v14, 49152, v10
 v_xor_b32 v11, 32, v29
 v_add_u32 v15, 49152, v11
 v_xor_b32 v12, 64, v29
 v_add_u32 v16, 49152, v12
 v_xor_b32 v13, 96, v29
 v_add_u32 v17, 49152, v13
 v_lshlrev_b32 v19, 7, v1
 v_mov_b32 v26, 0x7fffffff
 s_mov_b32 s12, 28
 v_cmp_gt_u32 vcc, s12, v1
 s_lshl_b32 s12, s2, 1
 s_and_b32 s13, s7, 1
 s_add_u32 s12, s12, s13
 s_lshl_b32 s12, s12, 0
 s_and_b32 s13, s12, 31
 s_lshr_b32 s12, s12, 5
 s_lshl_b32 s12, s12, 6
 s_add_u32 s12, s12, s13
 s_mul_i32 s12, s12, 7168
 v_cndmask_b32 v19, v26, v19, vcc
 v_lshlrev_b32 v48, 2, v4
 v_sub_u32 v48, v48, v3
 v_mov_b32 v49, 0xf149f2ca
 s_or_b32 s9, s5, s7
 s_cmp_eq_u32 s9, 0
 s_cselect_b32 s9, 64, 2
 v_add_u32 v50, 0, v48
 v_and_b32 v51, 1, v50
 v_lshl_add_u32 v52, v51, 8, v50
 v_cmp_ge_i32 vcc, 0, v52
 s_nop 1
 v_cndmask_b32 v220, v49, 0, vcc
 v_lshlrev_b32 v51, 8, v51
 v_sub_u32 v52, v50, v51
 v_cmp_le_i32 vcc, 2, v52
 s_nop 1
 v_cndmask_b32 v216, v49, 0, vcc
 v_cmp_le_i32 vcc, s9, v52
 s_nop 1
 v_cndmask_b32 v212, v49, 0, vcc
 v_add_u32 v50, 1, v48
 v_and_b32 v51, 1, v50
 v_lshl_add_u32 v52, v51, 8, v50
 v_cmp_ge_i32 vcc, 0, v52
 s_nop 1
 v_cndmask_b32 v221, v49, 0, vcc
 v_lshlrev_b32 v51, 8, v51
 v_sub_u32 v52, v50, v51
 v_cmp_le_i32 vcc, 2, v52
 s_nop 1
 v_cndmask_b32 v217, v49, 0, vcc
 v_cmp_le_i32 vcc, s9, v52
 s_nop 1
 v_cndmask_b32 v213, v49, 0, vcc
 v_add_u32 v50, 2, v48
 v_and_b32 v51, 1, v50
 v_lshl_add_u32 v52, v51, 8, v50
 v_cmp_ge_i32 vcc, 0, v52
 s_nop 1
 v_cndmask_b32 v222, v49, 0, vcc
 v_lshlrev_b32 v51, 8, v51
 v_sub_u32 v52, v50, v51
 v_cmp_le_i32 vcc, 2, v52
 s_nop 1
 v_cndmask_b32 v218, v49, 0, vcc
 v_cmp_le_i32 vcc, s9, v52
 s_nop 1
 v_cndmask_b32 v214, v49, 0, vcc
 v_add_u32 v50, 3, v48
 v_and_b32 v51, 1, v50
 v_lshl_add_u32 v52, v51, 8, v50
 v_cmp_ge_i32 vcc, 0, v52
 s_nop 1
 v_cndmask_b32 v223, v49, 0, vcc
 v_lshlrev_b32 v51, 8, v51
 v_sub_u32 v52, v50, v51
 v_cmp_le_i32 vcc, 2, v52
 s_nop 1
 v_cndmask_b32 v219, v49, 0, vcc
 v_cmp_le_i32 vcc, s9, v52
 s_nop 1
 v_cndmask_b32 v215, v49, 0, vcc
 s_and_b32 s14, s3, 3
 s_lshl_b32 s14, s14, 2
 s_and_b32 s9, s4, 3
 s_add_u32 s14, s14, s9
 s_lshr_b32 s15, s3, 2
 s_lshl_b32 s15, s15, 3
 s_lshr_b32 s9, s4, 2
 s_add_u32 s15, s15, s9
 v_lshrrev_b32 v48, 3, v1
 v_lshrrev_b32 v49, 1, v48
 v_and_b32 v49, 3, v49
 v_bfe_u32 v50, v1, 1, 2
 v_xor_b32 v50, v50, v49
 v_and_b32 v51, 1, v1
 v_lshlrev_b32 v50, 5, v50
 v_lshl_add_u32 v50, v51, 4, v50
 s_and_b32 s9, s7, 2
 s_add_u32 s9, s9, s7
 v_lshl_add_u32 v48, s9, 4, v48
 v_lshl_add_u32 v224, v48, 11, v50
 s_lshl_b32 s9, s15, 7
 v_add_u32 v224, s9, v224
 v_add_u32 v225, 15360, v224
 s_lshl_b32 s10, s14, 3
 s_lshl_b32 s13, s7, 1
 s_add_u32 s10, s10, s13
 s_lshl_b32 s13, s10, 15
 s_add_u32 s73, s13, s9
 s_lshl_b32 s10, s10, 7
 v_add_u32 v228, s10, v24
 s_lshr_b32 s64, s11, 5
 s_lshl_b32 s64, s64, 6
 s_bfe_u32 s10, s11, 0x20002
 s_lshl_b32 s10, s10, 4
 s_add_u32 s64, s64, s10
 s_bfe_u32 s10, s11, 0x10004
 s_lshl_b32 s10, s10, 3
 s_add_u32 s64, s64, s10
 s_and_b32 s10, s11, 3
 s_lshl_b32 s10, s10, 1
 s_add_u32 s64, s64, s10
 s_add_u32 s64, s64, 131072
 s_lshl_b32 s97, s2, 2
 s_add_u32 s97, s97, 24576
 s_cmp_eq_u32 s7, 0
 s_cselect_b32 s97, s97, 262144
 s_lshl_b32 s70, s8, 15
 s_lshl_b32 s10, s6, 11
 s_add_u32 s70, s70, s10
 s_lshl_b32 s69, s8, 6
 s_lshl_b32 s10, s6, 2
 s_add_u32 s69, s69, s10
 s_lshr_b32 s10, s11, 3
 s_lshl_b32 s10, s10, 7
 s_and_b32 s13, s11, 7
 s_lshl_b32 s13, s13, 3
 s_add_u32 s10, s10, s13
 s_movk_i32 s13, 24576
 s_add_u32 m0, s46, 24576
 s_add_u32 s45, s45, 196608
 WL 7,0
 WL 8,1024
 WL 9,2048
 s_add_u32 m0, s46, 36864
 s_add_u32 s45, s45, 196608
 WL 7,0
 WL 8,1024
 WL 9,2048
 s_add_u32 m0, s72, 16384
 s_add_u32 s44, s44, 128
 buffer_load_dwordx4 v196, s[36:39], s44 offen offset:0 lds
 buffer_load_dwordx4 v197, s[36:39], s44 offen offset:1024 lds
 buffer_load_dwordx4 v198, s[36:39], s44 offen offset:2048 lds
 buffer_load_dwordx4 v199, s[36:39], s44 offen offset:3072 lds
 v_lshlrev_b32 v203, 7, v1
 v_mov_b32 v62, 0x7fffffff
 s_mov_b32 s76, 6
 v_cmp_gt_u32 vcc, s76, v1
 s_lshl_b32 s76, s79, 2
 s_add_u32 s76, s76, s7
 s_mul_i32 s77, s11, 768
 s_add_u32 s77, s77, 1572864
 v_cndmask_b32 v203, v62, v203, vcc
 buffer_load_dword v253, v203, s[40:43], s77 offen
 s_add_u32 s77, s77, 786432
 buffer_load_dword v253, v203, s[40:43], s77 offen
 s_add_u32 s77, s77, 786432
 s_cmp_eq_u32 s7, 0
 s_cbranch_scc1 L_sequential_preLN__sliding_local_dilated__geglu_ffn__prompt_kernel_hop0_e0
 s_cmp_eq_u32 s7, 1
 s_cbranch_scc1 L_sequential_preLN__sliding_local_dilated__geglu_ffn__prompt_kernel_hop0_e1
 s_cmp_eq_u32 s7, 2
 s_cbranch_scc1 L_sequential_preLN__sliding_local_dilated__geglu_ffn__prompt_kernel_hop0_e2
 s_branch L_sequential_preLN__sliding_local_dilated__geglu_ffn__prompt_kernel_hop0_e3
L_sequential_preLN__sliding_local_dilated__geglu_ffn__prompt_kernel_hop0_ret:
 s_waitcnt vmcnt(27)
 v_lshlrev_b32 v64, 16, v32
 v_and_b32 v65, 0xffff0000, v32
 v_lshlrev_b32 v66, 16, v33
 v_and_b32 v67, 0xffff0000, v33
 v_lshlrev_b32 v68, 16, v34
 v_and_b32 v69, 0xffff0000, v34
 v_lshlrev_b32 v70, 16, v35
 v_and_b32 v71, 0xffff0000, v35
 s_waitcnt vmcnt(26)
 v_lshlrev_b32 v72, 16, v36
 v_and_b32 v73, 0xffff0000, v36
 v_lshlrev_b32 v74, 16, v37
 v_and_b32 v75, 0xffff0000, v37
 v_lshlrev_b32 v76, 16, v38
 v_and_b32 v77, 0xffff0000, v38
 v_lshlrev_b32 v78, 16, v39
 v_and_b32 v79, 0xffff0000, v39
 s_waitcnt vmcnt(25)
 v_lshlrev_b32 v80, 16, v40
 v_and_b32 v81, 0xffff0000, v40
 v_lshlrev_b32 v82, 16, v41
 v_and_b32 v83, 0xffff0000, v41
 v_lshlrev_b32 v84, 16, v42
 v_and_b32 v85, 0xffff0000, v42
 v_lshlrev_b32 v86, 16, v43
 v_and_b32 v87, 0xffff0000, v43
 s_waitcnt vmcnt(24)
 v_lshlrev_b32 v88, 16, v44
 v_and_b32 v89, 0xffff0000, v44
 v_lshlrev_b32 v90, 16, v45
 v_and_b32 v91, 0xffff0000, v45
 v_lshlrev_b32 v92, 16, v46
 v_and_b32 v93, 0xffff0000, v46
 v_lshlrev_b32 v94, 16, v47
 v_and_b32 v95, 0xffff0000, v47
 v_pk_add_f32 v[48:49], v[64:65], v[66:67]
 v_pk_add_f32 v[50:51], v[80:81], v[82:83]
 v_pk_add_f32 v[48:49], v[48:49], v[68:69]
 v_pk_add_f32 v[50:51], v[50:51], v[84:85]
 v_pk_add_f32 v[48:49], v[48:49], v[70:71]
 v_pk_add_f32 v[50:51], v[50:51], v[86:87]
 v_pk_add_f32 v[48:49], v[48:49], v[72:73]
 v_pk_add_f32 v[50:51], v[50:51], v[88:89]
 v_pk_add_f32 v[48:49], v[48:49], v[74:75]
 v_pk_add_f32 v[50:51], v[50:51], v[90:91]
 v_pk_add_f32 v[48:49], v[48:49], v[76:77]
 v_pk_add_f32 v[50:51], v[50:51], v[92:93]
 v_pk_add_f32 v[48:49], v[48:49], v[78:79]
 v_pk_add_f32 v[50:51], v[50:51], v[94:95]
 v_add_f32 v48, v48, v49
 v_add_f32 v49, v50, v51
 s_nop 0
 v_add_f32_dpp v48, v48, v48 row_ror:1 row_mask:0xf bank_mask:0xf
 v_add_f32_dpp v49, v49, v49 row_ror:1 row_mask:0xf bank_mask:0xf
 s_nop 0
 v_add_f32_dpp v48, v48, v48 row_ror:2 row_mask:0xf bank_mask:0xf
 v_add_f32_dpp v49, v49, v49 row_ror:2 row_mask:0xf bank_mask:0xf
 s_nop 0
 v_add_f32_dpp v48, v48, v48 row_ror:4 row_mask:0xf bank_mask:0xf
 v_add_f32_dpp v49, v49, v49 row_ror:4 row_mask:0xf bank_mask:0xf
 s_nop 0
 v_add_f32_dpp v48, v48, v48 row_ror:8 row_mask:0xf bank_mask:0xf
 v_add_f32_dpp v49, v49, v49 row_ror:8 row_mask:0xf bank_mask:0xf
 v_mov_b32 v50, v48
 v_mov_b32 v51, v49
 s_nop 0
 v_permlane16_swap_b32 v48, v50
 v_permlane16_swap_b32 v49, v51
 v_add_f32 v48, v48, v50
 v_add_f32 v49, v49, v51
 v_mov_b32 v50, v48
 v_mov_b32 v51, v49
 s_nop 0
 v_permlane32_swap_b32 v48, v50
 v_permlane32_swap_b32 v49, v51
 v_add_f32 v48, v48, v50
 v_add_f32 v49, v49, v51
 v_mul_f32 v48, 0x3a800000, v48
 v_mul_f32 v49, 0x3a800000, v49
 v_pk_add_f32 v[64:65], v[64:65], v[48:49] op_sel:[0,0] op_sel_hi:[1,0] neg_lo:[0,1] neg_hi:[0,1]
 v_pk_add_f32 v[80:81], v[80:81], v[48:49] op_sel:[0,1] op_sel_hi:[1,1] neg_lo:[0,1] neg_hi:[0,1]
 v_pk_add_f32 v[66:67], v[66:67], v[48:49] op_sel:[0,0] op_sel_hi:[1,0] neg_lo:[0,1] neg_hi:[0,1]
 v_pk_add_f32 v[82:83], v[82:83], v[48:49] op_sel:[0,1] op_sel_hi:[1,1] neg_lo:[0,1] neg_hi:[0,1]
 v_pk_add_f32 v[68:69], v[68:69], v[48:49] op_sel:[0,0] op_sel_hi:[1,0] neg_lo:[0,1] neg_hi:[0,1]
 v_pk_add_f32 v[84:85], v[84:85], v[48:49] op_sel:[0,1] op_sel_hi:[1,1] neg_lo:[0,1] neg_hi:[0,1]
 v_pk_add_f32 v[70:71], v[70:71], v[48:49] op_sel:[0,0] op_sel_hi:[1,0] neg_lo:[0,1] neg_hi:[0,1]
 v_pk_add_f32 v[86:87], v[86:87], v[48:49] op_sel:[0,1] op_sel_hi:[1,1] neg_lo:[0,1] neg_hi:[0,1]
 v_pk_add_f32 v[72:73], v[72:73], v[48:49] op_sel:[0,0] op_sel_hi:[1,0] neg_lo:[0,1] neg_hi:[0,1]
 v_pk_add_f32 v[88:89], v[88:89], v[48:49] op_sel:[0,1] op_sel_hi:[1,1] neg_lo:[0,1] neg_hi:[0,1]
 v_pk_add_f32 v[74:75], v[74:75], v[48:49] op_sel:[0,0] op_sel_hi:[1,0] neg_lo:[0,1] neg_hi:[0,1]
 v_pk_add_f32 v[90:91], v[90:91], v[48:49] op_sel:[0,1] op_sel_hi:[1,1] neg_lo:[0,1] neg_hi:[0,1]
 v_pk_add_f32 v[76:77], v[76:77], v[48:49] op_sel:[0,0] op_sel_hi:[1,0] neg_lo:[0,1] neg_hi:[0,1]
 v_pk_add_f32 v[92:93], v[92:93], v[48:49] op_sel:[0,1] op_sel_hi:[1,1] neg_lo:[0,1] neg_hi:[0,1]
 v_pk_add_f32 v[78:79], v[78:79], v[48:49] op_sel:[0,0] op_sel_hi:[1,0] neg_lo:[0,1] neg_hi:[0,1]
 v_pk_add_f32 v[94:95], v[94:95], v[48:49] op_sel:[0,1] op_sel_hi:[1,1] neg_lo:[0,1] neg_hi:[0,1]
 v_pk_mul_f32 v[52:53], v[64:65], v[64:65]
 v_pk_mul_f32 v[54:55], v[80:81], v[80:81]
 v_pk_fma_f32 v[52:53], v[66:67], v[66:67], v[52:53]
 v_pk_fma_f32 v[54:55], v[82:83], v[82:83], v[54:55]
 v_pk_fma_f32 v[52:53], v[68:69], v[68:69], v[52:53]
 v_pk_fma_f32 v[54:55], v[84:85], v[84:85], v[54:55]
 v_pk_fma_f32 v[52:53], v[70:71], v[70:71], v[52:53]
 v_pk_fma_f32 v[54:55], v[86:87], v[86:87], v[54:55]
 v_pk_fma_f32 v[52:53], v[72:73], v[72:73], v[52:53]
 v_pk_fma_f32 v[54:55], v[88:89], v[88:89], v[54:55]
 v_pk_fma_f32 v[52:53], v[74:75], v[74:75], v[52:53]
 v_pk_fma_f32 v[54:55], v[90:91], v[90:91], v[54:55]
 v_pk_fma_f32 v[52:53], v[76:77], v[76:77], v[52:53]
 v_pk_fma_f32 v[54:55], v[92:93], v[92:93], v[54:55]
 v_pk_fma_f32 v[52:53], v[78:79], v[78:79], v[52:53]
 v_pk_fma_f32 v[54:55], v[94:95], v[94:95], v[54:55]
 v_add_f32 v52, v52, v53
 v_add_f32 v53, v54, v55
 s_nop 0
 v_add_f32_dpp v52, v52, v52 row_ror:1 row_mask:0xf bank_mask:0xf
 v_add_f32_dpp v53, v53, v53 row_ror:1 row_mask:0xf bank_mask:0xf
 s_nop 0
 v_add_f32_dpp v52, v52, v52 row_ror:2 row_mask:0xf bank_mask:0xf
 v_add_f32_dpp v53, v53, v53 row_ror:2 row_mask:0xf bank_mask:0xf
 s_nop 0
 v_add_f32_dpp v52, v52, v52 row_ror:4 row_mask:0xf bank_mask:0xf
 v_add_f32_dpp v53, v53, v53 row_ror:4 row_mask:0xf bank_mask:0xf
 s_nop 0
 v_add_f32_dpp v52, v52, v52 row_ror:8 row_mask:0xf bank_mask:0xf
 v_add_f32_dpp v53, v53, v53 row_ror:8 row_mask:0xf bank_mask:0xf
 v_mov_b32 v54, v52
 v_mov_b32 v55, v53
 s_nop 0
 v_permlane16_swap_b32 v52, v54
 v_permlane16_swap_b32 v53, v55
 v_add_f32 v52, v52, v54
 v_add_f32 v53, v53, v55
 v_mov_b32 v54, v52
 v_mov_b32 v55, v53
 s_nop 0
 v_permlane32_swap_b32 v52, v54
 v_permlane32_swap_b32 v53, v55
 v_add_f32 v52, v52, v54
 v_add_f32 v53, v53, v55
 v_mov_b32 v54, 0x3727c5ac
 v_mov_b32 v55, 0x3727c5ac
 v_fmac_f32 v54, 0x3a800000, v52
 v_fmac_f32 v55, 0x3a800000, v53
 v_rsq_f32 v54, v54
 v_rsq_f32 v55, v55
 s_mov_b64 exec, 1
 buffer_store_dwordx2 v[48:49], v30, s[56:59], s10 offen sc0 sc1
 buffer_store_dwordx2 v[54:55], v30, s[56:59], s10 offen offset:64 sc0 sc1
 s_mov_b64 exec, -1
 s_waitcnt lgkmcnt(0)
 s_add_u32 m0, s46, 49152
 s_add_u32 s45, s45, 196608
 WL 7,0
 WL 8,1024
 WL 9,2048
 s_add_u32 m0, s46, 61440
 s_add_u32 s45, s45, 196608
 WL 7,0
 WL 8,1024
 WL 9,2048
 s_add_u32 m0, s72, 32768
 s_add_u32 s44, s44, 128
 buffer_load_dwordx4 v196, s[36:39], s44 offen offset:0 lds
 s_waitcnt vmcnt(22)
 s_barrier
 ds_read_b128 a[0:3], v2 offset:0
 ds_read_b128 a[4:7], v2 offset:2048
 ds_read_b128 a[8:11], v6 offset:0
 ds_read_b128 a[12:15], v6 offset:2048
 TR 128,10,0
 TR 130,10,512
 TR 132,10,12288
 TR 134,10,12800
 TR 136,11,0
 TR 138,11,512
 TR 140,11,12288
 TR 142,11,12800
 TR 144,12,0
 TR 146,12,512
 TR 148,12,12288
 TR 150,12,12800
 TR 152,13,0
 TR 154,13,512
 TR 156,13,12288
 TR 158,13,12800
 TR 160,10,1024
 TR 162,10,1536
 TR 164,10,13312
 TR 166,10,13824
 TR 168,11,1024
 TR 170,11,1536
 TR 172,11,13312
 TR 174,11,13824
 TR 176,12,1024
 TR 178,12,1536
 TR 180,12,13312
 TR 182,12,13824
 s_waitcnt vmcnt(21) lgkmcnt(0)
 s_barrier
 v_mfma_f32_16x16x32_bf16 v[32:35], a[128:131], a[0:3], 0
 TR 184,13,1024
 TR 186,13,1536
 MF 32,132,8
 TR 188,13,13312
 buffer_load_dwordx4 v197, s[36:39], s44 offen offset:1024 lds
 v_mfma_f32_16x16x32_bf16 v[80:83], a[132:135], a[12:15], 0
 TR 190,13,13824
 TR 192,10,2048
 MF 80,128,4
 TR 194,10,2560
 v_mfma_f32_16x16x32_bf16 v[84:87], a[136:139], a[4:7], 0
 TR 196,10,14336
 TR 198,10,14848
 buffer_load_dwordx4 v198, s[36:39], s44 offen offset:2048 lds
 MF 84,140,12
 TR 200,11,2048
 v_mfma_f32_16x16x32_bf16 v[36:39], a[140:143], a[8:11], 0
 TR 202,11,2560
 MF 36,136,0
 TR 204,11,14336
 TR 206,11,14848
 buffer_load_dwordx4 v199, s[36:39], s44 offen offset:3072 lds
 v_mfma_f32_16x16x32_bf16 v[40:43], a[144:147], a[0:3], 0
 TR 208,12,2048
 MF 40,148,8
 TR 210,12,2560
 TR 212,12,14336
 v_mfma_f32_16x16x32_bf16 v[88:91], a[148:151], a[12:15], 0
 TR 214,12,14848
 s_add_u32 m0, s68, 4096
 s_add_u32 s67, s67, 256
 buffer_load_dwordx4 v202, s[36:39], s67 offen lds
 MF 88,144,4
 TR 216,13,2048
 v_mfma_f32_16x16x32_bf16 v[92:95], a[152:155], a[4:7], 0
 TR 218,13,2560
 TR 220,13,14336
 MF 92,156,12
 TR 222,13,14848
 s_add_u32 m0, s46, 73728
 s_add_u32 s45, s45, 196608
 WL 7,0
 v_mfma_f32_16x16x32_bf16 v[44:47], a[156:159], a[8:11], 0
 s_movk_i32 s74, 0
 v_mad_u32_u24 v18, v20, s74, v200
 ds_read_b128 a[248:251], v18
 s_movk_i32 s74, 0
 v_mad_u32_u24 v18, v20, s74, v201
 ds_read_b128 a[252:255], v18
 MF 44,152,0
 TR 224,21,0
 v_mfma_f32_16x16x32_bf16 v[48:51], a[160:163], a[0:3], 0
 TR 226,21,512
 TR 228,21,12288
 WL 8,1024
 MF 48,164,8
 TR 230,21,12800
 v_mfma_f32_16x16x32_bf16 v[96:99], a[164:167], a[12:15], 0
 TR 232,21,1024
 MF 96,160,4
 TR 234,21,1536
 TR 236,21,13312
 s_branch L_sequential_preLN__sliding_local_dilated__geglu_ffn__prompt_kernel_pg0_skip
.p2align 12
L_sequential_preLN__sliding_local_dilated__geglu_ffn__prompt_kernel_pg0:
 s_branch L_sequential_preLN__sliding_local_dilated__geglu_ffn__prompt_kernel_pg4
L_sequential_preLN__sliding_local_dilated__geglu_ffn__prompt_kernel_pg0b:
 s_branch L_sequential_preLN__sliding_local_dilated__geglu_ffn__prompt_kernel_sp_ret
L_sequential_preLN__sliding_local_dilated__geglu_ffn__prompt_kernel_pg0_skip:
 WL 9,2048
 v_mfma_f32_16x16x32_bf16 v[100:103], a[168:171], a[4:7], 0
 TR 238,21,13824
 MF 100,172,12
 TR 240,21,2048
 TR 242,21,2560
 v_mfma_f32_16x16x32_bf16 v[52:55], a[172:175], a[8:11], 0
 TR 244,21,14336
 s_add_u32 m0, s46, 86016
 s_add_u32 s45, s45, 196608
 WL 7,0
 MF 52,168,0
 TR 246,21,14848
 v_mfma_f32_16x16x32_bf16 v[56:59], a[176:179], a[0:3], 0
 MF 56,180,8
 buffer_load_dword v253, v203, s[40:43], s77 offen
 s_add_u32 s77, s77, 786432
 v_mfma_f32_16x16x32_bf16 v[104:107], a[180:183], a[12:15], 0
 MF 104,176,4
 s_waitcnt vmcnt(20) lgkmcnt(0)
 s_barrier
 v_mfma_f32_16x16x32_bf16 v[60:63], a[184:187], a[0:3], 0
 ds_read_b128 a[16:19], v2 offset:16384
 ds_read_b128 a[20:23], v2 offset:18432
 MF 60,188,8
 ds_read_b128 a[24:27], v6 offset:16384
 WL 8,1024
 v_mfma_f32_16x16x32_bf16 v[108:111], a[188:191], a[12:15], 0
 ds_read_b128 a[28:31], v6 offset:18432
 TR 128,10,24576
 MF 108,184,4
 TR 130,10,25088
 v_mfma_f32_16x16x32_bf16 v[112:115], a[4:7], a[192:195], 0
 TR 132,10,36864
 TR 134,10,37376
 WL 9,2048
 MF 112,12,196
 TR 136,11,24576
 v_mfma_f32_16x16x32_bf16 v[64:67], a[8:11], a[196:199], 0
 TR 138,11,25088
 TR 140,11,36864
 s_add_u32 m0, s68, 8192
 s_add_u32 s67, s67, 256
 buffer_load_dwordx4 v202, s[36:39], s67 offen lds
 MF 64,0,192
 TR 142,11,37376
 v_mfma_f32_16x16x32_bf16 v[68:71], a[0:3], a[200:203], 0
 TR 144,12,24576
 TR 146,12,25088
 MF 68,8,204
 TR 148,12,36864
 s_add_u32 m0, s72, 0
 s_add_u32 s44, s44, 128
 buffer_load_dwordx4 v196, s[36:39], s44 offen offset:0 lds
 v_mfma_f32_16x16x32_bf16 v[116:119], a[12:15], a[204:207], 0
 TR 150,12,37376
 MF 116,4,200
 TR 152,13,24576
 TR 154,13,25088
 v_mfma_f32_16x16x32_bf16 v[120:123], a[4:7], a[208:211], 0
 TR 156,13,36864
 buffer_load_dwordx4 v197, s[36:39], s44 offen offset:1024 lds
 MF 120,12,212
 TR 158,13,37376
 TR 160,10,25600
 v_mfma_f32_16x16x32_bf16 v[72:75], a[8:11], a[212:215], 0
 TR 162,10,26112
 MF 72,0,208
 TR 164,10,37888
 TR 166,10,38400
 buffer_load_dwordx4 v198, s[36:39], s44 offen offset:2048 lds
 v_mfma_f32_16x16x32_bf16 v[76:79], a[0:3], a[216:219], 0
 TR 168,11,25600
 MF 76,8,220
 TR 170,11,26112
 TR 172,11,37888
 v_mfma_f32_16x16x32_bf16 v[124:127], a[12:15], a[220:223], 0
 TR 174,11,38400
 buffer_load_dwordx4 v199, s[36:39], s44 offen offset:3072 lds
 MF 124,4,216
 TR 176,12,25600
 TR 178,12,26112
 v_mfma_f32_16x16x32_bf16 v[128:131], a[224:227], a[248:251], 0
 TR 180,12,37888
 s_add_u32 m0, s46, 0
 s_add_u32 s45, s45, 196608
 WL 7,0
 MF 128,228,252
 TR 182,12,38400
 v_mfma_f32_16x16x32_bf16 v[132:135], a[236:239], a[252:255], 0
 MF 132,232,248
 buffer_load_dword v253, v203, s[40:43], s77 offen
 s_add_u32 s77, s77, 786432
 v_mfma_f32_16x16x32_bf16 v[136:139], a[248:251], a[240:243], 0
 MF 136,252,244
 s_waitcnt lgkmcnt(0)
 MF 32,128,16
 TR 184,13,25600
 TR 186,13,26112
 MF 32,132,24
 TR 188,13,37888
 WL 8,1024
 MF 80,132,28
 TR 190,13,38400
 TR 192,10,26624
 MF 80,128,20
 TR 194,10,27136
 WL 9,2048
 MF 84,136,20
 TR 196,10,38912
 TR 198,10,39424
 MF 84,140,28
 TR 200,11,26624
 MF 36,140,24
 TR 202,11,27136
 s_add_u32 m0, s46, 12288
 s_add_u32 s45, s45, 196608
 WL 7,0
 MF 36,136,16
 TR 204,11,38912
 TR 206,11,39424
 MF 40,144,16
 TR 208,12,26624
 WL 8,1024
 MF 40,148,24
 TR 210,12,27136
 TR 212,12,38912
 MF 88,148,28
 TR 214,12,39424
 MF 88,144,20
 TR 216,13,26624
 WL 9,2048
 MF 92,152,20
 TR 218,13,27136
 TR 220,13,38912
 MF 92,156,28
 TR 222,13,39424
 s_add_u32 m0, s72, 16384
 s_add_u32 s44, s44, 128
 buffer_load_dwordx4 v196, s[36:39], s44 offen offset:0 lds
 MF 44,156,24
 s_movk_i32 s74, 2048
 v_mad_u32_u24 v18, v20, s74, v200
 ds_read_b128 a[248:251], v18
 s_movk_i32 s74, 2048
 v_mad_u32_u24 v18, v20, s74, v201
 ds_read_b128 a[252:255], v18
 MF 44,152,16
 TR 224,21,24576
 buffer_load_dwordx4 v197, s[36:39], s44 offen offset:1024 lds
 MF 48,160,16
 TR 226,21,25088
 TR 228,21,36864
 MF 48,164,24
 TR 230,21,37376
 MF 96,164,28
 TR 232,21,25600
 buffer_load_dwordx4 v198, s[36:39], s44 offen offset:2048 lds
 MF 96,160,20
 TR 234,21,26112
 TR 236,21,37888
 MF 100,168,20
 TR 238,21,38400
 buffer_load_dword v253, v203, s[40:43], s77 offen
 s_add_u32 s77, s77, 786432
 MF 100,172,28
 TR 240,21,26624
 TR 242,21,27136
 MF 52,172,24
 TR 244,21,38912
 MF 52,168,16
 TR 246,21,39424
 s_mov_b32 s48, s20
 s_mov_b32 s49, s21
 s_mov_b32 s50, 2097152
 s_mov_b32 s51, 0x00020000
 s_lshl_b32 s76, s11, 11
 buffer_load_dwordx4 v[140:143], v5, s[48:51], s76 offen
 buffer_load_dwordx4 v[144:147], v5, s[48:51], s76 offen offset:1024
 s_cmp_ge_u32 s7, 2
 s_cselect_b32 s48, s26, s24
 s_cselect_b32 s49, s27, s25
 s_mov_b32 s50, 7340032
 MF 56,176,16
 MF 56,180,24
 buffer_load_dword v28, v30, s[52:55], 0 offen sc0 sc1
 MF 104,180,28
 MF 104,176,20
 s_waitcnt vmcnt(27) lgkmcnt(0)
 s_barrier
 MF 60,184,16
 ds_read_b128 a[32:35], v2 offset:32768
 ds_read_b128 a[36:39], v2 offset:34816
 MF 60,188,24
 ds_read_b128 a[40:43], v6 offset:32768
 buffer_load_dwordx4 v199, s[36:39], s44 offen offset:3072 lds
 MF 108,188,28
 ds_read_b128 a[44:47], v6 offset:34816
 TR 128,14,0
 MF 108,184,20
 TR 130,14,512
 MF 112,20,192
 TR 132,14,12288
 TR 134,14,12800
 s_add_u32 m0, s46, 24576
 s_add_u32 s45, s45, 196608
 WL 7,0
 MF 112,28,196
 TR 136,15,0
 MF 64,24,196
 TR 138,15,512
 TR 140,15,12288
 WL 8,1024
 MF 64,16,192
 TR 142,15,12800
 MF 68,16,200
 TR 144,16,0
 TR 146,16,512
 MF 68,24,204
 TR 148,16,12288
 WL 9,2048
 MF 116,28,204
 TR 150,16,12800
 MF 116,20,200
 TR 152,17,0
 TR 154,17,512
 MF 120,20,208
 TR 156,17,12288
 s_add_u32 m0, s46, 36864
 s_add_u32 s45, s45, 196608
 WL 7,0
 MF 120,28,212
 TR 158,17,12800
 TR 160,14,1024
 MF 72,24,212
 TR 162,14,1536
 MF 72,16,208
 TR 164,14,13312
 TR 166,14,13824
 WL 8,1024
 MF 76,16,216
 TR 168,15,1024
 MF 76,24,220
 TR 170,15,1536
 TR 172,15,13312
 MF 124,28,220
 TR 174,15,13824
 WL 9,2048
 MF 124,20,216
 TR 176,16,1024
 TR 178,16,1536
 MF 128,224,248
 TR 180,16,13312
 s_add_u32 m0, s68, 0
 s_add_u32 s67, s67, 256
 buffer_load_dwordx4 v202, s[36:39], s67 offen lds
 MF 128,228,252
 TR 182,16,13824
 MF 132,236,252
 MF 132,232,248
 buffer_load_dword v253, v203, s[40:43], s77 offen
 s_add_u32 s77, s77, 786432
 MF 136,248,240
 MF 136,252,244
 s_waitcnt vmcnt(35) lgkmcnt(0)
 s_barrier
 MF 32,128,32
 TR 184,17,1024
 TR 186,17,1536
 MF 32,132,40
 TR 188,17,13312
 MF 80,132,44
 TR 190,17,13824
 TR 192,14,2048
 MF 80,128,36
 TR 194,14,2560
 s_add_u32 m0, s72, 32768
 s_add_u32 s44, s44, 128
 buffer_load_dwordx4 v196, s[36:39], s44 offen offset:0 lds
 MF 84,136,36
 TR 196,14,14336
 TR 198,14,14848
 MF 84,140,44
 TR 200,15,2048
 MF 36,140,40
 TR 202,15,2560
 MF 36,136,32
 TR 204,15,14336
 TR 206,15,14848
 MF 40,144,32
 TR 208,16,2048
 MF 40,148,40
 TR 210,16,2560
 TR 212,16,14336
 MF 88,148,44
 TR 214,16,14848
 buffer_load_dwordx4 v197, s[36:39], s44 offen offset:1024 lds
 MF 88,144,36
 TR 216,17,2048
 MF 92,152,36
 TR 218,17,2560
 TR 220,17,14336
 MF 92,156,44
 TR 222,17,14848
 MF 44,156,40
 s_movk_i32 s74, 4096
 v_mad_u32_u24 v18, v20, s74, v200
 ds_read_b128 a[248:251], v18
 s_movk_i32 s74, 4096
 v_mad_u32_u24 v18, v20, s74, v201
 ds_read_b128 a[252:255], v18
 MF 44,152,32
 TR 224,22,0
 MF 48,160,32
 TR 226,22,512
 TR 228,22,12288
 buffer_load_dwordx4 v198, s[36:39], s44 offen offset:2048 lds
 MF 48,164,40
 TR 230,22,12800
 MF 96,164,44
 TR 232,22,1024
 MF 96,160,36
 TR 234,22,1536
 TR 236,22,13312
 MF 100,168,36
 TR 238,22,13824
 MF 100,172,44
 TR 240,22,2048
 TR 242,22,2560
 MF 52,172,40
 TR 244,22,14336
 MF 52,168,32
 TR 246,22,14848
 buffer_load_dwordx4 v199, s[36:39], s44 offen offset:3072 lds
 MF 56,176,32
 MF 56,180,40
 MF 104,180,44
 MF 104,176,36
 s_waitcnt vmcnt(27) lgkmcnt(0)
 s_barrier
 MF 60,184,32
 ds_read_b128 a[48:51], v2 offset:0
 ds_read_b128 a[52:55], v2 offset:2048
 MF 60,188,40
 ds_read_b128 a[56:59], v6 offset:0
 MF 108,188,44
 ds_read_b128 a[60:63], v6 offset:2048
 TR 128,14,24576
 s_add_u32 m0, s46, 49152
 s_add_u32 s45, s45, 196608
 WL 7,0
 MF 108,184,36
 TR 130,14,25088
 MF 112,36,192
 TR 132,14,36864
 TR 134,14,37376
 MF 112,44,196
 TR 136,15,24576
 MF 64,40,196
 TR 138,15,25088
 TR 140,15,36864
 WL 8,1024
 MF 64,32,192
 TR 142,15,37376
 MF 68,32,200
 TR 144,16,24576
 TR 146,16,25088
 MF 68,40,204
 TR 148,16,36864
 MF 116,44,204
 TR 150,16,37376
 WL 9,2048
 MF 116,36,200
 TR 152,17,24576
 TR 154,17,25088
 MF 120,36,208
 TR 156,17,36864
 MF 120,44,212
 TR 158,17,37376
 TR 160,14,25600
 MF 72,40,212
 TR 162,14,26112
 s_add_u32 m0, s46, 61440
 s_add_u32 s45, s45, 196608
 WL 7,0
 MF 72,32,208
 TR 164,14,37888
 TR 166,14,38400
 MF 76,32,216
 TR 168,15,25600
 MF 76,40,220
 TR 170,15,26112
 TR 172,15,37888
 MF 124,44,220
 TR 174,15,38400
 WL 8,1024
 MF 124,36,216
 TR 176,16,25600
 TR 178,16,26112
 MF 128,224,248
 TR 180,16,37888
 MF 128,228,252
 TR 182,16,38400
 MF 132,236,252
 WL 9,2048
 MF 132,232,248
 MF 136,248,240
 MF 136,252,244
 s_waitcnt lgkmcnt(0)
 MF 32,128,48
 TR 184,17,25600
 TR 186,17,26112
 MF 32,132,56
 TR 188,17,37888
 MF 80,132,60
 TR 190,17,38400
 TR 192,14,26624
 MF 80,128,52
 TR 194,14,27136
 s_add_u32 m0, s72, 0
 s_add_u32 s44, s44, 128
 buffer_load_dwordx4 v196, s[36:39], s44 offen offset:0 lds
 MF 84,136,52
 TR 196,14,38912
 TR 198,14,39424
 MF 84,140,60
 TR 200,15,26624
 MF 36,140,56
 TR 202,15,27136
 MF 36,136,48
 TR 204,15,38912
 TR 206,15,39424
 MF 40,144,48
 TR 208,16,26624
 MF 40,148,56
 TR 210,16,27136
 TR 212,16,38912
 MF 88,148,60
 TR 214,16,39424
 buffer_load_dwordx4 v197, s[36:39], s44 offen offset:1024 lds
 MF 88,144,52
 TR 216,17,26624
 MF 92,152,52
 TR 218,17,27136
 TR 220,17,38912
 MF 92,156,60
 TR 222,17,39424
 MF 44,156,56
 s_movk_i32 s74, 6144
 v_mad_u32_u24 v18, v20, s74, v200
 ds_read_b128 a[248:251], v18
 s_movk_i32 s74, 6144
 v_mad_u32_u24 v18, v20, s74, v201
 ds_read_b128 a[252:255], v18
 MF 44,152,48
 TR 224,22,24576
 MF 48,160,48
 TR 226,22,25088
 TR 228,22,36864
 buffer_load_dwordx4 v198, s[36:39], s44 offen offset:2048 lds
 MF 48,164,56
 TR 230,22,37376
 MF 96,164,60
 TR 232,22,25600
 MF 96,160,52
 TR 234,22,26112
 TR 236,22,37888
 MF 100,168,52
 TR 238,22,38400
 MF 100,172,60
 TR 240,22,26624
 TR 242,22,27136
 MF 52,172,56
 TR 244,22,38912
 MF 52,168,48
 TR 246,22,39424
 buffer_load_dwordx4 v199, s[36:39], s44 offen offset:3072 lds
 MF 56,176,48
 MF 56,180,56
 MF 104,180,60
 MF 104,176,52
 s_waitcnt vmcnt(22) lgkmcnt(0)
 s_barrier
 MF 60,184,48
 ds_read_b128 a[64:67], v2 offset:16384
 ds_read_b128 a[68:71], v2 offset:18432
 MF 60,188,56
 ds_read_b128 a[72:75], v6 offset:16384
 s_add_u32 m0, s46, 73728
 s_add_u32 s45, s45, 196608
 WL 7,0
 MF 108,188,60
 ds_read_b128 a[76:79], v6 offset:18432
 TR 128,10,0
 v_mov_b32 v27, 0x3f803f80
 MF 108,184,52
 TR 130,10,512
 v_mov_b32 v26, 0
 v_dot2_f32_bf16 v26, v140, v27, v26
 MF 112,52,192
 TR 132,10,12288
 TR 134,10,12800
 v_dot2_f32_bf16 v26, v141, v27, v26
 MF 112,60,196
 TR 136,11,0
 WL 8,1024
 MF 64,56,196
 TR 138,11,512
 TR 140,11,12288
 v_dot2_f32_bf16 v26, v142, v27, v26
 MF 64,48,192
 TR 142,11,12800
 v_dot2_f32_bf16 v26, v143, v27, v26
 v_dot2_f32_bf16 v26, v144, v27, v26
 MF 68,48,200
 TR 144,12,0
 TR 146,12,512
 WL 9,2048
 MF 68,56,204
 TR 148,12,12288
 v_dot2_f32_bf16 v26, v145, v27, v26
 v_dot2_f32_bf16 v26, v146, v27, v26
 MF 116,60,204
 TR 150,12,12800
 v_dot2_f32_bf16 v26, v147, v27, v26
 s_branch L_sequential_preLN__sliding_local_dilated__geglu_ffn__prompt_kernel_pg1_skip
.p2align 12
L_sequential_preLN__sliding_local_dilated__geglu_ffn__prompt_kernel_pg1:
 s_branch L_sequential_preLN__sliding_local_dilated__geglu_ffn__prompt_kernel_pg5
L_sequential_preLN__sliding_local_dilated__geglu_ffn__prompt_kernel_pg1b:
 s_branch L_sequential_preLN__sliding_local_dilated__geglu_ffn__prompt_kernel_sp_ret
L_sequential_preLN__sliding_local_dilated__geglu_ffn__prompt_kernel_pg1_skip:
 s_nop 2
 v_add_f32_dpp v26, v26, v26 row_ror:1 row_mask:0xf bank_mask:0xf
 MF 116,52,200
 TR 152,13,0
 TR 154,13,512
 v_add_f32_dpp v26, v26, v26 row_ror:2 row_mask:0xf bank_mask:0xf
 MF 120,52,208
 TR 156,13,12288
 s_add_u32 m0, s46, 86016
 s_add_u32 s45, s45, 196608
 WL 7,0
 MF 120,60,212
 TR 158,13,12800
 TR 160,10,1024
 v_add_f32_dpp v26, v26, v26 row_ror:4 row_mask:0xf bank_mask:0xf
 MF 72,56,212
 TR 162,10,1536
 v_add_f32_dpp v26, v26, v26 row_ror:8 row_mask:0xf bank_mask:0xf
 v_mov_b32 v27, v26
 MF 72,48,208
 TR 164,10,13312
 TR 166,10,13824
 v_permlane16_swap_b32 v26, v27
 MF 76,48,216
 TR 168,11,1024
 WL 8,1024
 MF 76,56,220
 TR 170,11,1536
 TR 172,11,13312
 v_add_f32 v26, v26, v27
 MF 124,60,220
 TR 174,11,13824
 v_mov_b32 v27, v26
 s_nop 1
 v_permlane32_swap_b32 v26, v27
 MF 124,52,216
 TR 176,12,1024
 TR 178,12,1536
 WL 9,2048
 MF 128,224,248
 TR 180,12,13312
 v_add_f32 v26, v26, v27
 v_mul_f32 v26, 0x3a800000, v26
 MF 128,228,252
 TR 182,12,13824
 v_cvt_pk_bf16_f32 v25, v26, v26
 v_lshlrev_b32 v27, 16, v25
 MF 132,236,252
 v_sub_f32 v26, v26, v27
 v_cvt_pk_bf16_f32 v29, v26, v26
 MF 132,232,248
 s_add_u32 m0, s68, 4096
 s_add_u32 s67, s67, 256
 buffer_load_dwordx4 v202, s[36:39], s67 offen lds
 MF 136,248,240
 MF 136,252,244
 s_waitcnt vmcnt(30)
 s_mov_b32 s47, 0x100000
L_nonce:
 v_readfirstlane_b32 s96, v28
 s_cmp_lg_u32 s96, 0
 s_cbranch_scc1 L_nonce_ok
 s_sub_u32 s47, s47, 1
 s_cbranch_scc1 L_nonce_ok
 buffer_load_dword v28, v30, s[52:55], 0 offen sc0 sc1
 s_waitcnt vmcnt(0)
 s_branch L_nonce
L_nonce_ok:
 v_mov_b32 v31, s96
 s_add_u32 s52, s34, 4194304
 s_addc_u32 s53, s35, 0
 s_mov_b32 s54, 4194304
 s_waitcnt vmcnt(48) lgkmcnt(0)
 s_barrier
 MF 32,128,64
 TR 184,13,1024
 TR 186,13,1536
 MF 32,132,72
 TR 188,13,13312
 MF 80,132,76
 TR 190,13,13824
 TR 192,10,2048
 s_add_u32 m0, s72, 16384
 s_add_u32 s44, s44, 128
 buffer_load_dwordx4 v196, s[36:39], s44 offen offset:0 lds
 MF 80,128,68
 TR 194,10,2560
 MF 84,136,68
 TR 196,10,14336
 TR 198,10,14848
 MF 84,140,76
 TR 200,11,2048
 MF 36,140,72
 TR 202,11,2560
 buffer_load_dwordx4 v197, s[36:39], s44 offen offset:1024 lds
 MF 36,136,64
 TR 204,11,14336
 TR 206,11,14848
 MF 40,144,64
 TR 208,12,2048
 MF 40,148,72
 TR 210,12,2560
 TR 212,12,14336
 MF 88,148,76
 TR 214,12,14848
 MF 88,144,68
 TR 216,13,2048
 buffer_load_dwordx4 v198, s[36:39], s44 offen offset:2048 lds
 MF 92,152,68
 TR 218,13,2560
 TR 220,13,14336
 MF 92,156,76
 TR 222,13,14848
 MF 44,156,72
 s_movk_i32 s74, 8192
 v_mad_u32_u24 v18, v20, s74, v200
 ds_read_b128 a[248:251], v18
 s_movk_i32 s74, 8192
 v_mad_u32_u24 v18, v20, s74, v201
 ds_read_b128 a[252:255], v18
 MF 44,152,64
 TR 224,21,0
 buffer_load_dwordx4 v199, s[36:39], s44 offen offset:3072 lds
 MF 48,160,64
 TR 226,21,512
 TR 228,21,12288
 MF 48,164,72
 TR 230,21,12800
 MF 96,164,76
 TR 232,21,1024
 MF 96,160,68
 TR 234,21,1536
 TR 236,21,13312
 MF 100,168,68
 TR 238,21,13824
 buffer_store_short v25, v30, s[56:59], s64 offen sc0 sc1
 MF 100,172,76
 TR 240,21,2048
 TR 242,21,2560
 MF 52,172,72
 TR 244,21,14336
 MF 52,168,64
 TR 246,21,14848
 MF 56,176,64
 buffer_store_short v29, v30, s[56:59], s64 offen offset:2048 sc0 sc1
 MF 56,180,72
 MF 104,180,76
 MF 104,176,68
 s_waitcnt vmcnt(23) lgkmcnt(0)
 s_barrier
 MF 60,184,64
 ds_read_b128 a[80:83], v2 offset:32768
 ds_read_b128 a[84:87], v2 offset:34816
 MF 60,188,72
 ds_read_b128 a[88:91], v6 offset:32768
 MF 108,188,76
 ds_read_b128 a[92:95], v6 offset:34816
 TR 128,10,24576
 s_add_u32 m0, s46, 0
 s_add_u32 s45, s45, 196608
 WL 7,0
 MF 108,184,68
 TR 130,10,25088
 MF 112,68,192
 TR 132,10,36864
 TR 134,10,37376
 MF 112,76,196
 TR 136,11,24576
 MF 64,72,196
 TR 138,11,25088
 TR 140,11,36864
 WL 8,1024
 MF 64,64,192
 TR 142,11,37376
 MF 68,64,200
 TR 144,12,24576
 TR 146,12,25088
 MF 68,72,204
 TR 148,12,36864
 MF 116,76,204
 TR 150,12,37376
 WL 9,2048
 MF 116,68,200
 TR 152,13,24576
 TR 154,13,25088
 MF 120,68,208
 TR 156,13,36864
 MF 120,76,212
 TR 158,13,37376
 TR 160,10,25600
 MF 72,72,212
 TR 162,10,26112
 s_add_u32 m0, s46, 12288
 s_add_u32 s45, s45, 196608
 WL 7,0
 MF 72,64,208
 TR 164,10,37888
 TR 166,10,38400
 MF 76,64,216
 TR 168,11,25600
 MF 76,72,220
 TR 170,11,26112
 TR 172,11,37888
 MF 124,76,220
 TR 174,11,38400
 WL 8,1024
 MF 124,68,216
 TR 176,12,25600
 TR 178,12,26112
 MF 128,224,248
 TR 180,12,37888
 MF 128,228,252
 TR 182,12,38400
 MF 132,236,252
 WL 9,2048
 MF 132,232,248
 MF 136,248,240
 MF 136,252,244
 s_waitcnt lgkmcnt(0)
 MF 32,128,80
 TR 184,13,25600
 TR 186,13,26112
 MF 32,132,88
 TR 188,13,37888
 MF 80,132,92
 TR 190,13,38400
 TR 192,10,26624
 MF 80,128,84
 TR 194,10,27136
 s_add_u32 m0, s72, 32768
 s_add_u32 s44, s44, 128
 buffer_load_dwordx4 v196, s[36:39], s44 offen offset:0 lds
 MF 84,136,84
 TR 196,10,38912
 TR 198,10,39424
 MF 84,140,92
 TR 200,11,26624
 MF 36,140,88
 TR 202,11,27136
 MF 36,136,80
 TR 204,11,38912
 TR 206,11,39424
 MF 40,144,80
 TR 208,12,26624
 MF 40,148,88
 TR 210,12,27136
 TR 212,12,38912
 MF 88,148,92
 TR 214,12,39424
 buffer_load_dwordx4 v197, s[36:39], s44 offen offset:1024 lds
 MF 88,144,84
 TR 216,13,26624
 MF 92,152,84
 TR 218,13,27136
 TR 220,13,38912
 MF 92,156,92
 TR 222,13,39424
 MF 44,156,88
 s_movk_i32 s74, 10240
 v_mad_u32_u24 v18, v20, s74, v200
 ds_read_b128 a[248:251], v18
 s_movk_i32 s74, 10240
 v_mad_u32_u24 v18, v20, s74, v201
 ds_read_b128 a[252:255], v18
 MF 44,152,80
 TR 224,21,24576
 MF 48,160,80
 TR 226,21,25088
 TR 228,21,36864
 buffer_load_dwordx4 v198, s[36:39], s44 offen offset:2048 lds
 MF 48,164,88
 TR 230,21,37376
 MF 96,164,92
 TR 232,21,25600
 MF 96,160,84
 TR 234,21,26112
 TR 236,21,37888
 MF 100,168,84
 TR 238,21,38400
 MF 100,172,92
 TR 240,21,26624
 TR 242,21,27136
 MF 52,172,88
 TR 244,21,38912
 MF 52,168,80
 TR 246,21,39424
 buffer_load_dwordx4 v199, s[36:39], s44 offen offset:3072 lds
 MF 56,176,80
 MF 56,180,88
 MF 104,180,92
 MF 104,176,84
 s_waitcnt vmcnt(10) lgkmcnt(0)
 s_barrier
 MF 60,184,80
 ds_read_b128 a[96:99], v2 offset:0
 ds_read_b128 a[100:103], v2 offset:2048
 MF 60,188,88
 ds_read_b128 a[104:107], v6 offset:0
 s_add_u32 m0, s46, 24576
 s_add_u32 s45, s45, 196608
 WL 7,0
 MF 108,188,92
 ds_read_b128 a[108:111], v6 offset:2048
 TR 128,14,0
 MF 108,184,84
 TR 130,14,512
 MF 112,84,192
 TR 132,14,12288
 TR 134,14,12800
 MF 112,92,196
 TR 136,15,0
 WL 8,1024
 MF 64,88,196
 TR 138,15,512
 TR 140,15,12288
 MF 64,80,192
 TR 142,15,12800
 MF 68,80,200
 TR 144,16,0
 TR 146,16,512
 WL 9,2048
 MF 68,88,204
 TR 148,16,12288
 MF 116,92,204
 TR 150,16,12800
 MF 116,84,200
 TR 152,17,0
 TR 154,17,512
 MF 120,84,208
 TR 156,17,12288
 s_add_u32 m0, s46, 36864
 s_add_u32 s45, s45, 196608
 WL 7,0
 MF 120,92,212
 TR 158,17,12800
 TR 160,14,1024
 MF 72,88,212
 TR 162,14,1536
 MF 72,80,208
 TR 164,14,13312
 TR 166,14,13824
 MF 76,80,216
 TR 168,15,1024
 WL 8,1024
 MF 76,88,220
 TR 170,15,1536
 TR 172,15,13312
 MF 124,92,220
 TR 174,15,13824
 MF 124,84,216
 TR 176,16,1024
 TR 178,16,1536
 WL 9,2048
 MF 128,224,248
 TR 180,16,13312
 MF 128,228,252
 TR 182,16,13824
 MF 132,236,252
 MF 132,232,248
 s_add_u32 m0, s68, 8192
 s_add_u32 s67, s67, 256
 buffer_load_dwordx4 v202, s[36:39], s67 offen lds
 MF 136,248,240
 MF 136,252,244
 s_waitcnt vmcnt(45) lgkmcnt(0)
 s_barrier
 MF 32,128,96
 TR 184,17,1024
 TR 186,17,1536
 MF 32,132,104
 TR 188,17,13312
 MF 80,132,108
 TR 190,17,13824
 TR 192,14,2048
 s_add_u32 m0, s72, 0
 s_add_u32 s44, s44, 128
 buffer_load_dwordx4 v196, s[36:39], s44 offen offset:0 lds
 MF 80,128,100
 TR 194,14,2560
 MF 84,136,100
 TR 196,14,14336
 TR 198,14,14848
 MF 84,140,108
 TR 200,15,2048
 MF 36,140,104
 TR 202,15,2560
 MF 36,136,96
 TR 204,15,14336
 TR 206,15,14848
 MF 40,144,96
 TR 208,16,2048
 buffer_load_dwordx4 v197, s[36:39], s44 offen offset:1024 lds
 MF 40,148,104
 TR 210,16,2560
 TR 212,16,14336
 MF 88,148,108
 TR 214,16,14848
 MF 88,144,100
 TR 216,17,2048
 MF 92,152,100
 TR 218,17,2560
 TR 220,17,14336
 MF 92,156,108
 TR 222,17,14848
 buffer_load_dwordx4 v198, s[36:39], s44 offen offset:2048 lds
 MF 44,156,104
 s_movk_i32 s74, 0
 v_mad_u32_u24 v18, v20, s74, v200
 ds_read_b128 a[248:251], v18
 s_movk_i32 s74, 0
 v_mad_u32_u24 v18, v20, s74, v201
 ds_read_b128 a[252:255], v18
 MF 44,152,96
 TR 224,22,0
 MF 48,160,96
 TR 226,22,512
 TR 228,22,12288
 MF 48,164,104
 TR 230,22,12800
 MF 96,164,108
 TR 232,22,1024
 buffer_load_dwordx4 v199, s[36:39], s44 offen offset:3072 lds
 MF 96,160,100
 TR 234,22,1536
 TR 236,22,13312
 MF 100,168,100
 TR 238,22,13824
 MF 100,172,108
 TR 240,22,2048
 TR 242,22,2560
 MF 52,172,104
 TR 244,22,14336
 MF 52,168,96
 TR 246,22,14848
 MF 56,176,96
 buffer_store_dword v31, v30, s[60:63], s97 offen sc0 sc1
 MF 56,180,104
 MF 104,180,108
 MF 104,176,100
 s_waitcnt vmcnt(24) lgkmcnt(0)
 s_barrier
 MF 60,184,96
 ds_read_b128 a[112:115], v2 offset:16384
 ds_read_b128 a[116:119], v2 offset:18432
 MF 60,188,104
 ds_read_b128 a[120:123], v6 offset:16384
 MF 108,188,108
 ds_read_b128 a[124:127], v6 offset:18432
 TR 128,14,24576
 s_add_u32 m0, s46, 49152
 s_add_u32 s45, s45, 196608
 WL 7,0
 MF 108,184,100
 TR 130,14,25088
 MF 112,100,192
 TR 132,14,36864
 TR 134,14,37376
 MF 112,108,196
 TR 136,15,24576
 MF 64,104,196
 TR 138,15,25088
 TR 140,15,36864
 WL 8,1024
 MF 64,96,192
 TR 142,15,37376
 MF 68,96,200
 TR 144,16,24576
 TR 146,16,25088
 MF 68,104,204
 TR 148,16,36864
 MF 116,108,204
 TR 150,16,37376
 WL 9,2048
 MF 116,100,200
 TR 152,17,24576
 TR 154,17,25088
 MF 120,100,208
 TR 156,17,36864
 MF 120,108,212
 TR 158,17,37376
 TR 160,14,25600
 MF 72,104,212
 TR 162,14,26112
 s_add_u32 m0, s46, 61440
 s_add_u32 s45, s45, 196608
 WL 7,0
 MF 72,96,208
 TR 164,14,37888
 TR 166,14,38400
 MF 76,96,216
 TR 168,15,25600
 MF 76,104,220
 TR 170,15,26112
 TR 172,15,37888
 MF 124,108,220
 TR 174,15,38400
 WL 8,1024
 MF 124,100,216
 TR 176,16,25600
 TR 178,16,26112
 MF 128,224,248
 TR 180,16,37888
 MF 128,228,252
 TR 182,16,38400
 MF 132,236,252
 WL 9,2048
 MF 132,232,248
 MF 136,248,240
 MF 136,252,244
 s_waitcnt lgkmcnt(0)
 MF 32,128,112
 TR 184,17,25600
 TR 186,17,26112
 MF 32,132,120
 TR 188,17,37888
 MF 80,132,124
 TR 190,17,38400
 TR 192,14,26624
 s_add_u32 m0, s72, 16384
 s_add_u32 s44, s44, 128
 buffer_load_dwordx4 v196, s[36:39], s44 offen offset:0 lds
 MF 80,128,116
 TR 194,14,27136
 MF 84,136,116
 TR 196,14,38912
 TR 198,14,39424
 MF 84,140,124
 TR 200,15,26624
 MF 36,140,120
 TR 202,15,27136
 MF 36,136,112
 TR 204,15,38912
 s_branch L_sequential_preLN__sliding_local_dilated__geglu_ffn__prompt_kernel_pg2_skip
.p2align 12
L_sequential_preLN__sliding_local_dilated__geglu_ffn__prompt_kernel_pg2:
 s_branch L_sequential_preLN__sliding_local_dilated__geglu_ffn__prompt_kernel_pg6
L_sequential_preLN__sliding_local_dilated__geglu_ffn__prompt_kernel_pg2b:
 s_branch L_sequential_preLN__sliding_local_dilated__geglu_ffn__prompt_kernel_sp_ret
L_sequential_preLN__sliding_local_dilated__geglu_ffn__prompt_kernel_pg2_skip:
 TR 206,15,39424
 MF 40,144,112
 TR 208,16,26624
 buffer_load_dwordx4 v197, s[36:39], s44 offen offset:1024 lds
 MF 40,148,120
 TR 210,16,27136
 TR 212,16,38912
 MF 88,148,124
 TR 214,16,39424
 MF 88,144,116
 TR 216,17,26624
 MF 92,152,116
 TR 218,17,27136
 TR 220,17,38912
 MF 92,156,124
 TR 222,17,39424
 buffer_load_dwordx4 v198, s[36:39], s44 offen offset:2048 lds
 MF 44,156,120
 s_movk_i32 s74, 2048
 v_mad_u32_u24 v18, v20, s74, v200
 ds_read_b128 a[248:251], v18
 s_movk_i32 s74, 2048
 v_mad_u32_u24 v18, v20, s74, v201
 ds_read_b128 a[252:255], v18
 MF 44,152,112
 TR 224,22,24576
 MF 48,160,112
 TR 226,22,25088
 TR 228,22,36864
 MF 48,164,120
 TR 230,22,37376
 MF 96,164,124
 TR 232,22,25600
 buffer_load_dwordx4 v199, s[36:39], s44 offen offset:3072 lds
 MF 96,160,116
 TR 234,22,26112
 TR 236,22,37888
 MF 100,168,116
 TR 238,22,38400
 MF 100,172,124
 TR 240,22,26624
 TR 242,22,27136
 MF 52,172,120
 TR 244,22,38912
 MF 52,168,112
 TR 246,22,39424
 MF 56,176,112
 buffer_load_dword v151, v19, s[48:51], s12 offen
 s_add_u32 s12, s12, 3584
 MF 56,180,120
 MF 104,180,124
 MF 104,176,116
 s_waitcnt vmcnt(23) lgkmcnt(0)
 s_barrier
 MF 60,184,112
 ds_read_b128 a[0:3], v2 offset:32768
 ds_read_b128 a[4:7], v2 offset:34816
 MF 60,188,120
 ds_read_b128 a[8:11], v6 offset:32768
 s_add_u32 m0, s46, 73728
 s_add_u32 s45, s45, 196608
 WL 7,0
 MF 108,188,124
 ds_read_b128 a[12:15], v6 offset:34816
 TR 128,10,0
 MF 108,184,116
 TR 130,10,512
 MF 112,116,192
 TR 132,10,12288
 TR 134,10,12800
 MF 112,124,196
 TR 136,11,0
 WL 8,1024
 MF 64,120,196
 TR 138,11,512
 TR 140,11,12288
 MF 64,112,192
 TR 142,11,12800
 MF 68,112,200
 TR 144,12,0
 TR 146,12,512
 WL 9,2048
 MF 68,120,204
 TR 148,12,12288
 MF 116,124,204
 TR 150,12,12800
 MF 116,116,200
 TR 152,13,0
 TR 154,13,512
 MF 120,116,208
 TR 156,13,12288
 s_add_u32 m0, s46, 86016
 s_add_u32 s45, s45, 196608
 WL 7,0
 MF 120,124,212
 TR 158,13,12800
 TR 160,10,1024
 MF 72,120,212
 TR 162,10,1536
 MF 72,112,208
 TR 164,10,13312
 TR 166,10,13824
 MF 76,112,216
 TR 168,11,1024
 WL 8,1024
 MF 76,120,220
 TR 170,11,1536
 TR 172,11,13312
 MF 124,124,220
 TR 174,11,13824
 MF 124,116,216
 TR 176,12,1024
 TR 178,12,1536
 WL 9,2048
 MF 128,224,248
 TR 180,12,13312
 MF 128,228,252
 TR 182,12,13824
 MF 132,236,252
 MF 132,232,248
 s_add_u32 m0, s68, 0
 s_add_u32 s67, s67, 256
 buffer_load_dwordx4 v202, s[36:39], s67 offen lds
 MF 136,248,240
 MF 136,252,244
 s_waitcnt vmcnt(46) lgkmcnt(0)
 s_barrier
 MF 32,128,0
 TR 184,13,1024
 TR 186,13,1536
 MF 32,132,8
 TR 188,13,13312
 MF 80,132,12
 TR 190,13,13824
 TR 192,10,2048
 MF 80,128,4
 TR 194,10,2560
 s_add_u32 m0, s72, 32768
 s_add_u32 s44, s44, 128
 buffer_load_dwordx4 v196, s[36:39], s44 offen offset:0 lds
 MF 84,136,4
 TR 196,10,14336
 TR 198,10,14848
 MF 84,140,12
 TR 200,11,2048
 MF 36,140,8
 TR 202,11,2560
 MF 36,136,0
 TR 204,11,14336
 TR 206,11,14848
 MF 40,144,0
 TR 208,12,2048
 MF 40,148,8
 TR 210,12,2560
 TR 212,12,14336
 MF 88,148,12
 TR 214,12,14848
 buffer_load_dwordx4 v197, s[36:39], s44 offen offset:1024 lds
 MF 88,144,4
 TR 216,13,2048
 MF 92,152,4
 TR 218,13,2560
 TR 220,13,14336
 MF 92,156,12
 TR 222,13,14848
 MF 44,156,8
 s_movk_i32 s74, 4096
 v_mad_u32_u24 v18, v20, s74, v200
 ds_read_b128 a[248:251], v18
 s_movk_i32 s74, 4096
 v_mad_u32_u24 v18, v20, s74, v201
 ds_read_b128 a[252:255], v18
 MF 44,152,0
 TR 224,21,0
 MF 48,160,0
 TR 226,21,512
 TR 228,21,12288
 buffer_load_dwordx4 v198, s[36:39], s44 offen offset:2048 lds
 MF 48,164,8
 TR 230,21,12800
 MF 96,164,12
 TR 232,21,1024
 MF 96,160,4
 TR 234,21,1536
 TR 236,21,13312
 MF 100,168,4
 TR 238,21,13824
 MF 100,172,12
 TR 240,21,2048
 TR 242,21,2560
 MF 52,172,8
 TR 244,21,14336
 MF 52,168,0
 TR 246,21,14848
 buffer_load_dwordx4 v199, s[36:39], s44 offen offset:3072 lds
 MF 56,176,0
 MF 56,180,8
 MF 104,180,12
 MF 104,176,4
 s_waitcnt vmcnt(23) lgkmcnt(0)
 s_barrier
 MF 60,184,0
 ds_read_b128 a[16:19], v2 offset:0
 ds_read_b128 a[20:23], v2 offset:2048
 MF 60,188,8
 ds_read_b128 a[24:27], v6 offset:0
 MF 108,188,12
 ds_read_b128 a[28:31], v6 offset:2048
 TR 128,10,24576
 s_add_u32 m0, s46, 0
 s_add_u32 s45, s45, 196608
 WL 7,0
 MF 108,184,4
 TR 130,10,25088
 MF 112,4,192
 TR 132,10,36864
 TR 134,10,37376
 MF 112,12,196
 TR 136,11,24576
 MF 64,8,196
 TR 138,11,25088
 TR 140,11,36864
 WL 8,1024
 MF 64,0,192
 TR 142,11,37376
 MF 68,0,200
 TR 144,12,24576
 TR 146,12,25088
 MF 68,8,204
 TR 148,12,36864
 MF 116,12,204
 TR 150,12,37376
 WL 9,2048
 MF 116,4,200
 TR 152,13,24576
 TR 154,13,25088
 MF 120,4,208
 TR 156,13,36864
 MF 120,12,212
 TR 158,13,37376
 TR 160,10,25600
 MF 72,8,212
 TR 162,10,26112
 s_add_u32 m0, s46, 12288
 s_add_u32 s45, s45, 196608
 WL 7,0
 MF 72,0,208
 TR 164,10,37888
 TR 166,10,38400
 MF 76,0,216
 TR 168,11,25600
 MF 76,8,220
 TR 170,11,26112
 TR 172,11,37888
 MF 124,12,220
 TR 174,11,38400
 WL 8,1024
 MF 124,4,216
 TR 176,12,25600
 TR 178,12,26112
 MF 128,224,248
 TR 180,12,37888
 MF 128,228,252
 TR 182,12,38400
 MF 132,236,252
 WL 9,2048
 MF 132,232,248
 MF 136,248,240
 MF 136,252,244
 s_waitcnt lgkmcnt(0)
 MF 32,128,16
 TR 184,13,25600
 TR 186,13,26112
 MF 32,132,24
 TR 188,13,37888
 MF 80,132,28
 TR 190,13,38400
 TR 192,10,26624
 s_add_u32 m0, s72, 0
 s_add_u32 s44, s44, 128
 buffer_load_dwordx4 v196, s[36:39], s44 offen offset:0 lds
 MF 80,128,20
 TR 194,10,27136
 MF 84,136,20
 TR 196,10,38912
 TR 198,10,39424
 MF 84,140,28
 TR 200,11,26624
 MF 36,140,24
 TR 202,11,27136
 MF 36,136,16
 TR 204,11,38912
 TR 206,11,39424
 MF 40,144,16
 TR 208,12,26624
 buffer_load_dwordx4 v197, s[36:39], s44 offen offset:1024 lds
 MF 40,148,24
 TR 210,12,27136
 TR 212,12,38912
 MF 88,148,28
 TR 214,12,39424
 MF 88,144,20
 TR 216,13,26624
 MF 92,152,20
 TR 218,13,27136
 TR 220,13,38912
 MF 92,156,28
 TR 222,13,39424
 buffer_load_dwordx4 v198, s[36:39], s44 offen offset:2048 lds
 MF 44,156,24
 s_movk_i32 s74, 6144
 v_mad_u32_u24 v18, v20, s74, v200
 ds_read_b128 a[248:251], v18
 s_movk_i32 s74, 6144
 v_mad_u32_u24 v18, v20, s74, v201
 ds_read_b128 a[252:255], v18
 MF 44,152,16
 TR 224,21,24576
 MF 48,160,16
 TR 226,21,25088
 TR 228,21,36864
 MF 48,164,24
 TR 230,21,37376
 MF 96,164,28
 TR 232,21,25600
 buffer_load_dwordx4 v199, s[36:39], s44 offen offset:3072 lds
 MF 96,160,20
 TR 234,21,26112
 TR 236,21,37888
 MF 100,168,20
 TR 238,21,38400
 MF 100,172,28
 TR 240,21,26624
 TR 242,21,27136
 MF 52,172,24
 TR 244,21,38912
 MF 52,168,16
 TR 246,21,39424
 MF 56,176,16
 buffer_load_dword v151, v19, s[48:51], s12 offen
 s_add_u32 s12, s12, 3584
 MF 56,180,24
 MF 104,180,28
 MF 104,176,20
 s_waitcnt vmcnt(23) lgkmcnt(0)
 s_barrier
 MF 60,184,16
 ds_read_b128 a[32:35], v2 offset:16384
 ds_read_b128 a[36:39], v2 offset:18432
 MF 60,188,24
 ds_read_b128 a[40:43], v6 offset:16384
 s_add_u32 m0, s46, 24576
 s_add_u32 s45, s45, 196608
 WL 7,0
 MF 108,188,28
 ds_read_b128 a[44:47], v6 offset:18432
 TR 128,14,0
 MF 108,184,20
 TR 130,14,512
 MF 112,20,192
 TR 132,14,12288
 TR 134,14,12800
 MF 112,28,196
 TR 136,15,0
 WL 8,1024
 MF 64,24,196
 TR 138,15,512
 TR 140,15,12288
 MF 64,16,192
 TR 142,15,12800
 MF 68,16,200
 TR 144,16,0
 TR 146,16,512
 WL 9,2048
 MF 68,24,204
 TR 148,16,12288
 MF 116,28,204
 TR 150,16,12800
 MF 116,20,200
 TR 152,17,0
 TR 154,17,512
 MF 120,20,208
 TR 156,17,12288
 s_add_u32 m0, s46, 36864
 s_add_u32 s45, s45, 196608
 WL 7,0
 MF 120,28,212
 TR 158,17,12800
 TR 160,14,1024
 MF 72,24,212
 TR 162,14,1536
 MF 72,16,208
 TR 164,14,13312
 TR 166,14,13824
 MF 76,16,216
 TR 168,15,1024
 WL 8,1024
 MF 76,24,220
 TR 170,15,1536
 TR 172,15,13312
 MF 124,28,220
 TR 174,15,13824
 MF 124,20,216
 TR 176,16,1024
 TR 178,16,1536
 WL 9,2048
 MF 128,224,248
 TR 180,16,13312
 MF 128,228,252
 TR 182,16,13824
 MF 132,236,252
 MF 132,232,248
 s_add_u32 m0, s68, 4096
 s_add_u32 s67, s67, 256
 buffer_load_dwordx4 v202, s[36:39], s67 offen lds
 MF 136,248,240
 MF 136,252,244
 s_waitcnt vmcnt(45) lgkmcnt(0)
 s_barrier
 MF 32,128,32
 TR 184,17,1024
 TR 186,17,1536
 MF 32,132,40
 TR 188,17,13312
 MF 80,132,44
 TR 190,17,13824
 TR 192,14,2048
 MF 80,128,36
 TR 194,14,2560
 s_add_u32 m0, s72, 16384
 s_add_u32 s44, s44, 128
 buffer_load_dwordx4 v196, s[36:39], s44 offen offset:0 lds
 MF 84,136,36
 TR 196,14,14336
 TR 198,14,14848
 MF 84,140,44
 TR 200,15,2048
 MF 36,140,40
 TR 202,15,2560
 MF 36,136,32
 TR 204,15,14336
 TR 206,15,14848
 MF 40,144,32
 TR 208,16,2048
 MF 40,148,40
 TR 210,16,2560
 TR 212,16,14336
 MF 88,148,44
 TR 214,16,14848
 buffer_load_dwordx4 v197, s[36:39], s44 offen offset:1024 lds
 MF 88,144,36
 TR 216,17,2048
 MF 92,152,36
 TR 218,17,2560
 TR 220,17,14336
 MF 92,156,44
 TR 222,17,14848
 MF 44,156,40
 s_movk_i32 s74, 8192
 v_mad_u32_u24 v18, v20, s74, v200
 ds_read_b128 a[248:251], v18
 s_movk_i32 s74, 8192
 v_mad_u32_u24 v18, v20, s74, v201
 ds_read_b128 a[252:255], v18
 MF 44,152,32
 TR 224,22,0
 MF 48,160,32
 TR 226,22,512
 TR 228,22,12288
 buffer_load_dwordx4 v198, s[36:39], s44 offen offset:2048 lds
 MF 48,164,40
 TR 230,22,12800
 MF 96,164,44
 TR 232,22,1024
 MF 96,160,36
 TR 234,22,1536
 TR 236,22,13312
 MF 100,168,36
 TR 238,22,13824
 MF 100,172,44
 TR 240,22,2048
 TR 242,22,2560
 MF 52,172,40
 TR 244,22,14336
 MF 52,168,32
 TR 246,22,14848
 buffer_load_dwordx4 v199, s[36:39], s44 offen offset:3072 lds
 MF 56,176,32
 MF 56,180,40
 MF 104,180,44
 MF 104,176,36
 s_waitcnt vmcnt(22) lgkmcnt(0)
 s_barrier
 MF 60,184,32
 ds_read_b128 a[48:51], v2 offset:32768
 ds_read_b128 a[52:55], v2 offset:34816
 MF 60,188,40
 ds_read_b128 a[56:59], v6 offset:32768
 MF 108,188,44
 ds_read_b128 a[60:63], v6 offset:34816
 TR 128,14,24576
 s_add_u32 m0, s46, 49152
 s_add_u32 s45, s45, 196608
 WL 7,0
 MF 108,184,36
 TR 130,14,25088
 MF 112,36,192
 TR 132,14,36864
 TR 134,14,37376
 MF 112,44,196
 TR 136,15,24576
 MF 64,40,196
 TR 138,15,25088
 TR 140,15,36864
 WL 8,1024
 MF 64,32,192
 TR 142,15,37376
 MF 68,32,200
 TR 144,16,24576
 TR 146,16,25088
 MF 68,40,204
 TR 148,16,36864
 s_branch L_sequential_preLN__sliding_local_dilated__geglu_ffn__prompt_kernel_pg3_skip
.p2align 12
L_sequential_preLN__sliding_local_dilated__geglu_ffn__prompt_kernel_pg3:
 s_branch L_sequential_preLN__sliding_local_dilated__geglu_ffn__prompt_kernel_pg7
L_sequential_preLN__sliding_local_dilated__geglu_ffn__prompt_kernel_pg3b:
 s_branch L_sequential_preLN__sliding_local_dilated__geglu_ffn__prompt_kernel_sp_ret
L_sequential_preLN__sliding_local_dilated__geglu_ffn__prompt_kernel_pg3_skip:
 MF 116,44,204
 TR 150,16,37376
 WL 9,2048
 MF 116,36,200
 TR 152,17,24576
 TR 154,17,25088
 MF 120,36,208
 TR 156,17,36864
 MF 120,44,212
 TR 158,17,37376
 TR 160,14,25600
 MF 72,40,212
 TR 162,14,26112
 s_add_u32 m0, s46, 61440
 s_add_u32 s45, s45, 196608
 WL 7,0
 MF 72,32,208
 TR 164,14,37888
 TR 166,14,38400
 MF 76,32,216
 TR 168,15,25600
 MF 76,40,220
 TR 170,15,26112
 TR 172,15,37888
 MF 124,44,220
 TR 174,15,38400
 WL 8,1024
 MF 124,36,216
 TR 176,16,25600
 TR 178,16,26112
 MF 128,224,248
 TR 180,16,37888
 MF 128,228,252
 TR 182,16,38400
 MF 132,236,252
 WL 9,2048
 MF 132,232,248
 MF 136,248,240
 MF 136,252,244
 s_waitcnt lgkmcnt(0)
 MF 32,128,48
 TR 184,17,25600
 TR 186,17,26112
 MF 32,132,56
 TR 188,17,37888
 MF 80,132,60
 TR 190,17,38400
 TR 192,14,26624
 s_add_u32 m0, s72, 32768
 s_add_u32 s44, s44, 128
 buffer_load_dwordx4 v196, s[36:39], s44 offen offset:0 lds
 MF 80,128,52
 TR 194,14,27136
 MF 84,136,52
 TR 196,14,38912
 TR 198,14,39424
 MF 84,140,60
 TR 200,15,26624
 MF 36,140,56
 TR 202,15,27136
 MF 36,136,48
 TR 204,15,38912
 TR 206,15,39424
 MF 40,144,48
 TR 208,16,26624
 buffer_load_dwordx4 v197, s[36:39], s44 offen offset:1024 lds
 MF 40,148,56
 TR 210,16,27136
 TR 212,16,38912
 MF 88,148,60
 TR 214,16,39424
 MF 88,144,52
 TR 216,17,26624
 MF 92,152,52
 TR 218,17,27136
 TR 220,17,38912
 MF 92,156,60
 TR 222,17,39424
 buffer_load_dwordx4 v198, s[36:39], s44 offen offset:2048 lds
 MF 44,156,56
 s_movk_i32 s74, 10240
 v_mad_u32_u24 v18, v20, s74, v200
 ds_read_b128 a[248:251], v18
 s_movk_i32 s74, 10240
 v_mad_u32_u24 v18, v20, s74, v201
 ds_read_b128 a[252:255], v18
 MF 44,152,48
 TR 224,22,24576
 MF 48,160,48
 TR 226,22,25088
 TR 228,22,36864
 MF 48,164,56
 TR 230,22,37376
 MF 96,164,60
 TR 232,22,25600
 buffer_load_dwordx4 v199, s[36:39], s44 offen offset:3072 lds
 MF 96,160,52
 TR 234,22,26112
 TR 236,22,37888
 MF 100,168,52
 TR 238,22,38400
 MF 100,172,60
 TR 240,22,26624
 TR 242,22,27136
 MF 52,172,56
 TR 244,22,38912
 MF 52,168,48
 TR 246,22,39424
 MF 56,176,48
 buffer_load_dwordx4 v[252:255], v5, s[60:63], s13 offen sc0 sc1
 MF 56,180,56
 MF 104,180,60
 MF 104,176,52
 s_waitcnt vmcnt(23) lgkmcnt(0)
 s_barrier
 MF 60,184,48
 ds_read_b128 a[64:67], v2 offset:0
 MF 60,188,56
 ds_read_b128 a[68:71], v2 offset:2048
 MF 108,188,60
 ds_read_b128 a[72:75], v6 offset:0
 s_add_u32 m0, s46, 73728
 s_add_u32 s45, s45, 196608
 WL 7,0
 MF 108,184,52
 ds_read_b128 a[76:79], v6 offset:2048
 MF 112,52,192
 TR 128,10,0
 MF 112,60,196
 TR 130,10,512
 MF 64,56,196
 TR 132,10,12288
 WL 8,1024
 MF 64,48,192
 TR 134,10,12800
 MF 68,48,200
 TR 136,11,0
 MF 68,56,204
 TR 138,11,512
 MF 116,60,204
 TR 140,11,12288
 WL 9,2048
 MF 116,52,200
 TR 142,11,12800
 MF 120,52,208
 TR 144,10,1024
 MF 120,60,212
 TR 146,10,1536
 MF 72,56,212
 TR 148,10,13312
 s_add_u32 m0, s46, 86016
 s_add_u32 s45, s45, 196608
 WL 7,0
 MF 72,48,208
 TR 150,10,13824
 MF 76,48,216
 TR 152,11,1024
 MF 76,56,220
 TR 154,11,1536
 MF 124,60,220
 TR 156,11,13312
 WL 8,1024
 MF 124,52,216
 TR 158,11,13824
 MF 128,224,248
 MF 128,228,252
 MF 132,236,252
 WL 9,2048
 MF 132,232,248
 MF 136,248,240
 MF 136,252,244
 s_waitcnt vmcnt(43) lgkmcnt(0)
 s_barrier
 MF 32,128,64
 TR 184,10,2048
 TR 186,10,2560
 MF 32,132,72
 TR 188,10,14336
 TR 190,10,14848
 s_add_u32 m0, s72, 0
 s_add_u32 s44, s44, 128
 buffer_load_dwordx4 v196, s[36:39], s44 offen offset:0 lds
 MF 80,132,76
 TR 192,11,2048
 TR 194,11,2560
 MF 80,128,68
 TR 196,11,14336
 MF 84,136,68
 TR 198,11,14848
 s_movk_i32 s74, 0
 v_mad_u32_u24 v18, v20, s74, v200
 ds_read_b128 a[224:227], v18
 MF 84,140,76
 s_movk_i32 s74, 0
 v_mad_u32_u24 v18, v20, s74, v201
 ds_read_b128 a[228:231], v18
 TR 200,21,0
 buffer_load_dwordx4 v197, s[36:39], s44 offen offset:1024 lds
 MF 36,140,72
 TR 202,21,512
 MF 36,136,64
 TR 204,21,12288
 TR 206,21,12800
 MF 48,144,64
 TR 208,21,1024
 TR 210,21,1536
 MF 48,148,72
 TR 212,21,13312
 buffer_load_dwordx4 v198, s[36:39], s44 offen offset:2048 lds
 MF 96,148,76
 TR 214,21,13824
 TR 216,21,2048
 MF 96,144,68
 TR 218,21,2560
 TR 220,21,14336
 MF 100,152,68
 TR 222,21,14848
 MF 100,156,76
 buffer_load_dwordx4 v199, s[36:39], s44 offen offset:3072 lds
 MF 52,156,72
 MF 52,152,64
 s_waitcnt vmcnt(21) lgkmcnt(0)
 s_barrier
 MF 64,64,184
 ds_read_b128 a[80:83], v2 offset:16384
 ds_read_b128 a[84:87], v2 offset:18432
 MF 64,72,188
 ds_read_b128 a[88:91], v6 offset:16384
 ds_read_b128 a[92:95], v6 offset:18432
 MF 112,76,188
 TR 128,10,24576
 TR 130,10,25088
 MF 112,68,184
 TR 132,10,36864
 TR 134,10,37376
 MF 116,68,192
 TR 136,11,24576
 TR 138,11,25088
 MF 116,76,196
 TR 140,11,36864
 MF 68,72,196
 TR 142,11,37376
 TR 144,10,25600
 MF 68,64,192
 TR 146,10,26112
 TR 148,10,37888
 MF 128,200,224
 TR 150,10,38400
 TR 152,11,25600
 MF 128,204,228
 TR 154,11,26112
 TR 156,11,37888
 MF 132,212,228
 TR 158,11,38400
 MF 132,208,224
 MF 136,224,216
 MF 136,228,220
 s_waitcnt vmcnt(10)
 s_mov_b32 s47, 0x100000
L_chkall:
 v_xor_b32 v252, s96, v252
 v_xor_b32 v253, s96, v253
 v_xor_b32 v254, s96, v254
 v_xor_b32 v255, s96, v255
 v_or3_b32 v252, v252, v253, v254
 v_or_b32 v252, v252, v255
 v_cmp_ne_u32 vcc, 0, v252
 s_nop 1
 s_cmp_eq_u64 vcc, 0
 s_cbranch_scc1 L_chkall_ok
 s_sub_u32 s47, s47, 1
 s_cbranch_scc1 L_chkall_ok
 buffer_load_dwordx4 v[252:255], v5, s[60:63], s13 offen sc0 sc1
 s_waitcnt vmcnt(0)
 s_branch L_chkall
L_chkall_ok:
 s_waitcnt lgkmcnt(0)
 MF 32,128,80
 TR 184,10,26624
 TR 186,10,27136
 MF 32,132,88
 TR 188,10,38912
 TR 190,10,39424
 buffer_load_dword v248, v228, s[56:59], 0 offen
 MF 80,132,92
 TR 192,11,26624
 TR 194,11,27136
 MF 80,128,84
 TR 196,11,38912
 MF 84,136,84
 TR 198,11,39424
 s_movk_i32 s74, 2048
 v_mad_u32_u24 v18, v20, s74, v200
 ds_read_b128 a[224:227], v18
 buffer_load_dword v250, v228, s[56:59], 0 offen offset:128
 MF 84,140,92
 s_movk_i32 s74, 2048
 v_mad_u32_u24 v18, v20, s74, v201
 ds_read_b128 a[228:231], v18
 TR 200,21,24576
 MF 36,140,88
 TR 202,21,25088
 MF 36,136,80
 TR 204,21,36864
 TR 206,21,37376
 buffer_load_dwordx4 v[156:159], v23, s[56:59], s65 offen offset:0
 MF 48,144,80
 TR 208,21,25600
 TR 210,21,26112
 MF 48,148,88
 TR 212,21,37888
 MF 96,148,92
 TR 214,21,38400
 TR 216,21,26624
 buffer_load_dwordx4 v[168:171], v23, s[56:59], s65 offen offset:64
 MF 96,144,84
 TR 218,21,27136
 TR 220,21,38912
 MF 100,152,84
 TR 222,21,39424
 MF 100,156,92
 buffer_load_dword v140, v24, s[56:59], s65 offen offset:0
 MF 52,156,88
 MF 52,152,80
 s_waitcnt vmcnt(16) lgkmcnt(0)
 s_barrier
 MF 64,80,184
 ds_read_b128 a[96:99], v2 offset:32768
 ds_read_b128 a[100:103], v2 offset:34816
 ds_read_b128 a[104:107], v6 offset:32768
 MF 64,88,188
 ds_read_b128 a[108:111], v6 offset:34816
 TR 128,14,0
 TR 130,14,512
 buffer_load_dword v141, v24, s[56:59], s65 offen offset:64
 MF 112,92,188
 TR 132,14,12288
 TR 134,14,12800
 TR 136,15,0
 MF 112,84,184
 TR 138,15,512
 TR 140,15,12288
 buffer_load_dwordx4 v[160:163], v23, s[56:59], s65 offen offset:128
 MF 116,84,192
 TR 142,15,12800
 TR 144,14,1024
 TR 146,14,1536
 MF 116,92,196
 TR 148,14,13312
 TR 150,14,13824
 s_movk_i32 s74, 4096
 v_mad_u32_u24 v18, v20, s74, v200
 ds_read_b128 a[176:179], v18
 MF 68,88,196
 s_movk_i32 s74, 4096
 v_mad_u32_u24 v18, v20, s74, v201
 ds_read_b128 a[180:183], v18
 TR 152,22,0
 TR 154,22,512
 buffer_load_dwordx4 v[172:175], v23, s[56:59], s65 offen offset:192
 MF 68,80,192
 TR 156,22,12288
 TR 158,22,12800
 MF 128,200,224
 TR 160,22,1024
 TR 162,22,1536
 TR 164,22,13312
 MF 128,204,228
 TR 166,22,13824
 TR 168,22,2048
 TR 170,22,2560
 buffer_load_dword v142, v24, s[56:59], s65 offen offset:128
 MF 132,212,228
 TR 172,22,14336
 TR 174,22,14848
 MF 132,208,224
 buffer_load_dword v143, v24, s[56:59], s65 offen offset:192
 MF 136,224,216
 MF 136,228,220
 s_waitcnt vmcnt(14) lgkmcnt(0)
 s_barrier
 MF 32,128,96
 TR 184,15,1024
 TR 186,15,1536
 MF 32,132,104
 TR 188,15,13312
 TR 190,15,13824
 MF 80,132,108
 TR 192,14,2048
 TR 194,14,2560
 buffer_load_dwordx4 v[164:167], v23, s[56:59], s66 offen offset:0
 MF 80,128,100
 TR 196,14,14336
 TR 198,14,14848
 MF 84,136,100
 TR 200,15,2048
 TR 202,15,2560
 MF 84,140,108
 TR 204,15,14336
 TR 206,15,14848
 MF 36,140,104
 s_movk_i32 s74, 6144
 v_mad_u32_u24 v18, v20, s74, v200
 ds_read_b128 a[232:235], v18
 buffer_load_dwordx4 v[176:179], v23, s[56:59], s66 offen offset:64
 MF 36,136,96
 s_movk_i32 s74, 6144
 v_mad_u32_u24 v18, v20, s74, v201
 ds_read_b128 a[236:239], v18
 TR 208,22,24576
 MF 48,144,96
 TR 210,22,25088
 TR 212,22,36864
 MF 48,148,104
 TR 214,22,37376
 TR 216,22,25600
 MF 96,148,108
 TR 218,22,26112
 TR 220,22,37888
 buffer_load_dword v144, v24, s[56:59], s66 offen offset:0
 MF 96,144,100
 TR 222,22,38400
 TR 224,22,26624
 MF 128,152,176
 TR 226,22,27136
 TR 228,22,38912
 MF 128,156,180
 TR 230,22,39424
 MF 132,164,180
 buffer_load_dword v145, v24, s[56:59], s66 offen offset:64
 MF 132,160,176
 MF 136,176,168
 MF 136,180,172
 s_waitcnt vmcnt(14) lgkmcnt(0)
 s_barrier
 MF 52,184,96
 ds_read_b128 a[112:115], v2 offset:0
 ds_read_b128 a[116:119], v2 offset:2048
 MF 52,188,104
 ds_read_b128 a[120:123], v6 offset:0
 v_mov_b32 v26, 0
 MF 100,188,108
 ds_read_b128 a[124:127], v6 offset:2048
 v_mov_b32 v27, 0
 s_lshl_b32 s9, s7, 9
 MF 100,184,100
 TR 128,14,24576
 s_add_u32 s9, s9, 135168
 v_lshlrev_b32 v28, 3, v1
 MF 112,100,192
 TR 130,14,25088
 v_add_u32 v28, s9, v28
 MF 112,108,196
 TR 132,14,36864
 ds_write_b64 v28, v[26:27]
 MF 64,104,196
 TR 134,14,37376
 ds_write_b64 v28, v[26:27] offset:2048
 MF 64,96,192
 TR 136,15,24576
 TR 138,15,25088
 MF 68,96,200
 TR 140,15,36864
 MF 68,104,204
 TR 142,15,37376
 MF 116,108,204
 TR 144,14,25600
 MF 116,100,200
 TR 146,14,26112
 MF 128,208,232
 TR 148,14,37888
 MF 128,212,236
 TR 150,14,38400
 MF 132,220,236
 MF 132,216,232
 MF 136,232,224
 MF 136,236,228
 s_lshl_b32 s9, s7, 10
 s_add_u32 m0, s9, 131072
 s_add_u32 s9, s9, 131072
 buffer_load_dwordx4 v5, s[56:59], s9 offen lds
 s_waitcnt lgkmcnt(0)
 MF 32,128,112
 TR 184,15,25600
 TR 186,15,26112
 MF 32,132,120
 TR 188,15,37888
 s_add_u32 m0, s72, 0
 s_mov_b32 s44, s73
 buffer_load_dwordx4 v196, s[36:39], s44 offen offset:0 lds
 MF 80,132,124
 TR 190,15,38400
 MF 80,128,116
 TR 192,14,26624
 TR 194,14,27136
 MF 84,136,116
 TR 196,14,38912
 buffer_load_dwordx4 v197, s[36:39], s44 offen offset:1024 lds
 MF 84,140,124
 TR 198,14,39424
 ds_write_b128 v229, v[128:131]
 MF 36,140,120
 TR 200,15,26624
 TR 202,15,27136
 buffer_load_dwordx4 v198, s[36:39], s44 offen offset:2048 lds
 MF 36,136,112
 TR 204,15,38912
 ds_write_b128 v229, v[132:135] offset:256
 MF 48,144,112
 TR 206,15,39424
 ds_write_b32 v0, v136
 MF 48,148,120
 buffer_load_dwordx4 v199, s[36:39], s44 offen offset:3072 lds
 MF 96,148,124
 MF 96,144,116
 s_waitcnt lgkmcnt(0)
 s_barrier
 MF 52,184,112
 TR 128,12,0
 TR 130,12,512
 MF 52,188,120
 TR 132,12,12288
 s_mov_b32 s40, s20
 s_mov_b32 s41, s21
 s_mov_b32 s42, 2097152
 s_mov_b32 s45, 0
 s_lshl_b32 s46, s7, 11
 MF 100,188,124
 TR 134,12,12800
 ds_read_b128 v[188:191], v230 offset:256
 ds_read_b128 v[192:195], v230 offset:320
 MF 100,184,116
 TR 136,13,0
 TR 138,13,512
 s_add_u32 m0, s46, 98304
 s_add_u32 s45, s45, 0x0
 WL 224,0
 MF 112,116,192
 TR 140,13,12288
 ds_read_b128 v[180:183], v230 offset:0
 s_branch L_sequential_preLN__sliding_local_dilated__geglu_ffn__prompt_kernel_pg4_skip
.p2align 12
L_sequential_preLN__sliding_local_dilated__geglu_ffn__prompt_kernel_pg4:
 s_branch L_sequential_preLN__sliding_local_dilated__geglu_ffn__prompt_kernel_hop0_ret
L_sequential_preLN__sliding_local_dilated__geglu_ffn__prompt_kernel_pg4b:
 s_branch L_sequential_preLN__sliding_local_dilated__geglu_ffn__prompt_kernel_sp_ret
L_sequential_preLN__sliding_local_dilated__geglu_ffn__prompt_kernel_pg4_skip:
 ds_read_b128 v[184:187], v230 offset:64
 MF 112,124,196
 TR 142,13,12800
 WL 225,1024
 v_add_u32 v26, 160256, v24
 MF 64,120,196
 TR 144,12,1024
 TR 146,12,1536
 ds_read_b32 v152, v26 offset:0
 MF 64,112,192
 TR 148,12,13312
 s_add_u32 m0, s46, 106496
 s_add_u32 s45, s45, 0x40000
 WL 224,0
 MF 68,112,200
 TR 150,12,13824
 ds_read_b32 v153, v26 offset:64
 ds_read_b32 v154, v26 offset:128
 MF 68,120,204
 WL 225,1024
 ds_read_b32 v155, v26 offset:192
 s_lshl_b32 s9, s7, 6
 MF 116,124,204
 v_add_u32 v26, s9, v26
 v_add_u32 v27, s9, v230
 ds_read_b32 v150, v26
 ds_read_b128 v[146:149], v27 offset:256
 MF 116,116,200
 s_waitcnt vmcnt(9) lgkmcnt(0)
 MF 40,128,64
 TR 184,13,1024
 TR 186,13,1536
 MF 40,132,72
 TR 188,13,13312
 MF 88,132,76
 TR 190,13,13824
 MF 88,128,68
 TR 192,12,2048
 TR 194,12,2560
 v_pk_fma_f32 v[96:97], v[188:189], v[142:143], v[96:97] op_sel_hi:[1,0,1] neg_lo:[0,1,0] neg_hi:[0,1,0]
 v_pk_fma_f32 v[98:99], v[190:191], v[142:143], v[98:99] op_sel_hi:[1,0,1] neg_lo:[0,1,0] neg_hi:[0,1,0]
 v_pk_fma_f32 v[100:101], v[192:193], v[142:143], v[100:101] op_sel_hi:[1,0,1] neg_lo:[0,1,0] neg_hi:[0,1,0]
 v_pk_fma_f32 v[102:103], v[194:195], v[142:143], v[102:103] op_sel_hi:[1,0,1] neg_lo:[0,1,0] neg_hi:[0,1,0]
 v_pk_mul_f32 v[96:97], v[96:97], v[142:143] op_sel:[0,1] op_sel_hi:[1,1]
 v_pk_mul_f32 v[98:99], v[98:99], v[142:143] op_sel:[0,1] op_sel_hi:[1,1]
 v_pk_mul_f32 v[100:101], v[100:101], v[142:143] op_sel:[0,1] op_sel_hi:[1,1]
 v_pk_mul_f32 v[102:103], v[102:103], v[142:143] op_sel:[0,1] op_sel_hi:[1,1]
 v_pk_fma_f32 v[112:113], v[160:161], v[152:153], v[112:113] op_sel:[0,0,0] op_sel_hi:[1,0,1] neg_lo:[1,0,0] neg_hi:[1,0,0]
 v_pk_fma_f32 v[114:115], v[162:163], v[152:153], v[114:115] op_sel:[0,0,0] op_sel_hi:[1,0,1] neg_lo:[1,0,0] neg_hi:[1,0,0]
 v_pk_fma_f32 v[116:117], v[160:161], v[152:153], v[116:117] op_sel:[0,1,0] op_sel_hi:[1,1,1] neg_lo:[1,0,0] neg_hi:[1,0,0]
 v_pk_fma_f32 v[118:119], v[162:163], v[152:153], v[118:119] op_sel:[0,1,0] op_sel_hi:[1,1,1] neg_lo:[1,0,0] neg_hi:[1,0,0]
 v_pk_mul_f32 v[112:113], v[112:113], v[172:173]
 v_pk_mul_f32 v[114:115], v[114:115], v[174:175]
 v_pk_mul_f32 v[116:117], v[116:117], v[172:173]
 v_pk_mul_f32 v[118:119], v[118:119], v[174:175]
 v_cvt_pk_bf16_f32 v96, v96, v97
 v_cvt_pk_bf16_f32 v97, v98, v99
 MF 92,136,68
 TR 196,12,14336
 v_cvt_pk_bf16_f32 v98, v100, v101
 v_cvt_pk_bf16_f32 v99, v102, v103
 v_cvt_pk_bf16_f32 v200, v112, v113
 MF 92,140,76
 TR 198,12,14848
 v_cvt_pk_bf16_f32 v201, v114, v115
 v_cvt_pk_bf16_f32 v206, v116, v117
 v_cvt_pk_bf16_f32 v207, v118, v119
 MF 44,140,72
 TR 200,13,2048
 TR 202,13,2560
 ds_write_b128 v231, v[96:99] offset:4096
 MF 44,136,64
 TR 204,13,14336
 ds_write_b64 v231, v[200:201] offset:5120
 ds_write_b64 v231, v[206:207] offset:5128
 v_pk_fma_f32 v[132:133], v[146:147], v[144:145], v[132:133] op_sel_hi:[1,0,1] neg_lo:[0,1,0] neg_hi:[0,1,0]
 v_pk_fma_f32 v[134:135], v[148:149], v[144:145], v[134:135] op_sel_hi:[1,0,1] neg_lo:[0,1,0] neg_hi:[0,1,0]
 v_pk_mul_f32 v[132:133], v[132:133], v[144:145] op_sel:[0,1] op_sel_hi:[1,1]
 v_pk_mul_f32 v[134:135], v[134:135], v[144:145] op_sel:[0,1] op_sel_hi:[1,1]
 v_pk_fma_f32 v[136:137], v[164:165], v[150:151], v[136:137] op_sel:[0,0,0] op_sel_hi:[1,0,1] neg_lo:[1,0,0] neg_hi:[1,0,0]
 v_pk_fma_f32 v[138:139], v[166:167], v[150:151], v[138:139] op_sel:[0,0,0] op_sel_hi:[1,0,1] neg_lo:[1,0,0] neg_hi:[1,0,0]
 v_pk_mul_f32 v[136:137], v[136:137], v[176:177]
 v_pk_mul_f32 v[138:139], v[138:139], v[178:179]
 v_cvt_pk_bf16_f32 v132, v132, v133
 s_nop 0
 MF 56,144,64
 TR 206,13,14848
 v_cvt_pk_bf16_f32 v133, v134, v135
 v_cvt_pk_bf16_f32 v134, v136, v137
 v_cvt_pk_bf16_f32 v135, v138, v139
 s_lshr_b32 s9, s7, 1
 MF 56,148,72
 s_lshl_b32 s9, s9, 11
 s_and_b32 s10, s7, 1
 s_lshl_b32 s10, s10, 3
 s_add_u32 s9, s9, s10
 s_add_u32 s9, s9, 139264
 v_add_u32 v26, s9, v5
 ds_write_b64 v26, v[132:133]
 MF 104,148,76
 ds_write_b64 v26, v[134:135] offset:1024
 MF 104,144,68
 s_waitcnt vmcnt(4) lgkmcnt(0)
 s_barrier
 MF 60,184,64
 TR 128,12,24576
 TR 130,12,25088
 MF 60,188,72
 TR 132,12,36864
 TR 134,12,37376
 s_add_u32 m0, s46, 0
 s_add_u32 s45, s45, 0x40000
 WL 224,0
 MF 108,188,76
 TR 136,13,24576
 TR 138,13,25088
 ds_read_b128 v[208:211], v231 offset:0
 ds_read_b64 v[196:197], v231 offset:1024
 MF 108,184,68
 TR 140,13,36864
 TR 142,13,37376
 WL 225,1024
 ds_read_b64 v[202:203], v231 offset:1032
 v_pk_fma_f32 v[80:81], v[180:181], v[142:143], v[80:81] op_sel_hi:[1,0,1] neg_lo:[0,1,0] neg_hi:[0,1,0]
 v_pk_fma_f32 v[82:83], v[182:183], v[142:143], v[82:83] op_sel_hi:[1,0,1] neg_lo:[0,1,0] neg_hi:[0,1,0]
 v_pk_fma_f32 v[84:85], v[184:185], v[142:143], v[84:85] op_sel_hi:[1,0,1] neg_lo:[0,1,0] neg_hi:[0,1,0]
 v_pk_fma_f32 v[86:87], v[186:187], v[142:143], v[86:87] op_sel_hi:[1,0,1] neg_lo:[0,1,0] neg_hi:[0,1,0]
 v_pk_mul_f32 v[80:81], v[80:81], v[142:143] op_sel:[0,1] op_sel_hi:[1,1]
 v_pk_mul_f32 v[82:83], v[82:83], v[142:143] op_sel:[0,1] op_sel_hi:[1,1]
 v_pk_mul_f32 v[84:85], v[84:85], v[142:143] op_sel:[0,1] op_sel_hi:[1,1]
 v_pk_mul_f32 v[86:87], v[86:87], v[142:143] op_sel:[0,1] op_sel_hi:[1,1]
 v_pk_fma_f32 v[32:33], v[180:181], v[140:141], v[32:33] op_sel_hi:[1,0,1] neg_lo:[0,1,0] neg_hi:[0,1,0]
 v_pk_fma_f32 v[34:35], v[182:183], v[140:141], v[34:35] op_sel_hi:[1,0,1] neg_lo:[0,1,0] neg_hi:[0,1,0]
 v_pk_fma_f32 v[36:37], v[184:185], v[140:141], v[36:37] op_sel_hi:[1,0,1] neg_lo:[0,1,0] neg_hi:[0,1,0]
 v_pk_fma_f32 v[38:39], v[186:187], v[140:141], v[38:39] op_sel_hi:[1,0,1] neg_lo:[0,1,0] neg_hi:[0,1,0]
 v_pk_mul_f32 v[32:33], v[32:33], v[140:141] op_sel:[0,1] op_sel_hi:[1,1]
 v_pk_mul_f32 v[34:35], v[34:35], v[140:141] op_sel:[0,1] op_sel_hi:[1,1]
 v_pk_mul_f32 v[36:37], v[36:37], v[140:141] op_sel:[0,1] op_sel_hi:[1,1]
 v_pk_mul_f32 v[38:39], v[38:39], v[140:141] op_sel:[0,1] op_sel_hi:[1,1]
 v_pk_fma_f32 v[48:49], v[188:189], v[140:141], v[48:49] op_sel_hi:[1,0,1] neg_lo:[0,1,0] neg_hi:[0,1,0]
 v_pk_fma_f32 v[50:51], v[190:191], v[140:141], v[50:51] op_sel_hi:[1,0,1] neg_lo:[0,1,0] neg_hi:[0,1,0]
 v_pk_fma_f32 v[52:53], v[192:193], v[140:141], v[52:53] op_sel_hi:[1,0,1] neg_lo:[0,1,0] neg_hi:[0,1,0]
 v_pk_fma_f32 v[54:55], v[194:195], v[140:141], v[54:55] op_sel_hi:[1,0,1] neg_lo:[0,1,0] neg_hi:[0,1,0]
 v_pk_mul_f32 v[48:49], v[48:49], v[140:141] op_sel:[0,1] op_sel_hi:[1,1]
 v_pk_mul_f32 v[50:51], v[50:51], v[140:141] op_sel:[0,1] op_sel_hi:[1,1]
 v_pk_mul_f32 v[52:53], v[52:53], v[140:141] op_sel:[0,1] op_sel_hi:[1,1]
 v_pk_mul_f32 v[54:55], v[54:55], v[140:141] op_sel:[0,1] op_sel_hi:[1,1]
 v_pk_fma_f32 v[64:65], v[156:157], v[152:153], v[64:65] op_sel:[0,0,0] op_sel_hi:[1,0,1] neg_lo:[1,0,0] neg_hi:[1,0,0]
 v_pk_fma_f32 v[66:67], v[158:159], v[152:153], v[66:67] op_sel:[0,0,0] op_sel_hi:[1,0,1] neg_lo:[1,0,0] neg_hi:[1,0,0]
 v_pk_fma_f32 v[68:69], v[156:157], v[152:153], v[68:69] op_sel:[0,1,0] op_sel_hi:[1,1,1] neg_lo:[1,0,0] neg_hi:[1,0,0]
 v_pk_fma_f32 v[70:71], v[158:159], v[152:153], v[70:71] op_sel:[0,1,0] op_sel_hi:[1,1,1] neg_lo:[1,0,0] neg_hi:[1,0,0]
 v_pk_mul_f32 v[64:65], v[64:65], v[168:169]
 v_pk_mul_f32 v[66:67], v[66:67], v[170:171]
 v_pk_mul_f32 v[68:69], v[68:69], v[168:169]
 v_pk_mul_f32 v[70:71], v[70:71], v[170:171]
 s_nop 1
 MF 120,68,192
 TR 144,12,25600
 v_cvt_pk_bf16_f32 v80, v80, v81
 v_cvt_pk_bf16_f32 v81, v82, v83
 v_cvt_pk_bf16_f32 v82, v84, v85
 v_cvt_pk_bf16_f32 v83, v86, v87
 MF 120,76,196
 TR 146,12,26112
 TR 148,12,37888
 s_add_u32 m0, s46, 8192
 s_add_u32 s45, s45, 0x40000
 WL 224,0
 MF 72,72,196
 TR 150,12,38400
 v_xor_b32 v227, 0, v226
 ds_read_b64 v[232:233], v227 offset:0
 ds_read_b64 v[240:241], v227 offset:2048
 v_cvt_pk_bf16_f32 v48, v48, v49
 MF 72,64,192
 v_xor_b32 v227, 32, v226
 ds_read_b64 v[234:235], v227 offset:0
 ds_read_b64 v[242:243], v227 offset:2048
 v_xor_b32 v227, 64, v226
 ds_read_b64 v[236:237], v227 offset:0
 ds_read_b64 v[244:245], v227 offset:2048
 WL 225,1024
 MF 76,64,200
 v_xor_b32 v227, 96, v226
 ds_read_b64 v[238:239], v227 offset:0
 ds_read_b64 v[246:247], v227 offset:2048
 v_cvt_pk_bf16_f32 v49, v50, v51
 v_cvt_pk_bf16_f32 v50, v52, v53
 MF 76,72,204
 s_add_u32 m0, s46, 16384
 s_add_u32 s45, s45, 0x40000
 WL 224,0
 v_cvt_pk_bf16_f32 v51, v54, v55
 v_cvt_pk_bf16_f32 v32, v32, v33
 v_cvt_pk_bf16_f32 v33, v34, v35
 MF 124,76,204
 v_cvt_pk_bf16_f32 v34, v36, v37
 v_cvt_pk_bf16_f32 v35, v38, v39
 v_cvt_pk_bf16_f32 v198, v64, v65
 v_cvt_pk_bf16_f32 v199, v66, v67
 v_cvt_pk_bf16_f32 v204, v68, v69
 v_cvt_pk_bf16_f32 v205, v70, v71
 MF 124,68,200
 s_waitcnt lgkmcnt(0)
 s_barrier
 MF 40,128,80
 TR 184,13,25600
 TR 186,13,26112
 s_mov_b32 s9, 0x3e8293ee
 s_mov_b32 s10, 0x3e8293ee
 s_mov_b32 s11, 0x3e8293ee
 MF 40,132,88
 TR 188,13,37888
 WL 225,1024
 v_mfma_f32_16x16x32_bf16 v[116:119], v[96:99], v[80:83], v[220:223]
 MF 88,132,92
 TR 190,13,38400
 v_mfma_f32_16x16x32_bf16 v[68:71], v[48:51], v[32:35], v[220:223]
 v_mfma_f32_16x16x32_bf16 v[112:115], v[48:51], v[80:83], v[216:219]
 MF 88,128,84
 TR 192,12,26624
 TR 194,12,27136
 s_add_u32 m0, s46, 114688
 s_add_u32 s45, s45, 0x40000
 WL 224,0
 MF 92,136,84
 TR 196,12,38912
 v_mfma_f32_16x16x32_bf16 v[64:67], v[208:211], v[32:35], v[212:215]
 v_max3_f32 v182, v116, v117, v118
 v_max3_f32 v180, v68, v69, v70
 MF 92,140,92
 TR 198,12,39424
 WL 225,1024
 v_max3_f32 v182, v182, v119, v112
 v_max3_f32 v182, v182, v113, v114
 MF 44,140,88
 TR 200,13,26624
 TR 202,13,27136
 v_max_f32 v182, v182, v115
 v_max3_f32 v180, v180, v71, v64
 v_max3_f32 v180, v180, v65, v66
 MF 44,136,80
 TR 204,13,38912
 s_add_u32 m0, s46, 122880
 s_add_u32 s45, s45, 0x40000
 WL 224,0
 v_max_f32 v180, v180, v67
 MF 56,144,80
 TR 206,13,39424
 v_mov_b32 v184, v180
 v_mov_b32 v185, v182
 s_nop 0
 v_permlane16_swap_b32 v180, v184
 v_permlane16_swap_b32 v182, v185
 MF 56,148,88
 WL 225,1024
 v_max_f32 v180, v180, v184
 v_max_f32 v182, v182, v185
 v_mov_b32 v184, v180
 MF 104,148,92
 v_mov_b32 v185, v182
 v_permlane32_swap_b32 v180, v184
 s_nop 0
 v_permlane32_swap_b32 v182, v185
 v_max_f32 v180, v180, v184
 v_max_f32 v182, v182, v185
 MF 104,144,84
 v_mul_f32 v180, s9, v180
 v_mul_f32 v182, s9, v182
 v_pk_fma_f32 v[112:113], v[112:113], s[10:11], v[182:183] op_sel_hi:[1,1,0] neg_lo:[0,0,1] neg_hi:[0,0,1]
 v_pk_fma_f32 v[114:115], v[114:115], s[10:11], v[182:183] op_sel_hi:[1,1,0] neg_lo:[0,0,1] neg_hi:[0,0,1]
 v_pk_fma_f32 v[116:117], v[116:117], s[10:11], v[182:183] op_sel_hi:[1,1,0] neg_lo:[0,0,1] neg_hi:[0,0,1]
 v_pk_fma_f32 v[118:119], v[118:119], s[10:11], v[182:183] op_sel_hi:[1,1,0] neg_lo:[0,0,1] neg_hi:[0,0,1]
 v_pk_fma_f32 v[64:65], v[64:65], s[10:11], v[180:181] op_sel_hi:[1,1,0] neg_lo:[0,0,1] neg_hi:[0,0,1]
 v_pk_fma_f32 v[66:67], v[66:67], s[10:11], v[180:181] op_sel_hi:[1,1,0] neg_lo:[0,0,1] neg_hi:[0,0,1]
 v_pk_fma_f32 v[68:69], v[68:69], s[10:11], v[180:181] op_sel_hi:[1,1,0] neg_lo:[0,0,1] neg_hi:[0,0,1]
 v_pk_fma_f32 v[70:71], v[70:71], s[10:11], v[180:181] op_sel_hi:[1,1,0] neg_lo:[0,0,1] neg_hi:[0,0,1]
 s_waitcnt lgkmcnt(0)
 s_barrier
 MF 60,184,80
 TR 128,16,0
 TR 130,16,512
 v_exp_f32 v112, v112
 v_exp_f32 v113, v113
 MF 60,188,88
 TR 132,16,12288
 s_add_u32 m0, s46, 24576
 s_add_u32 s45, s45, 0x40000
 WL 224,0
 v_exp_f32 v114, v114
 MF 108,188,92
 TR 134,16,12800
 v_exp_f32 v115, v115
 v_exp_f32 v116, v116
 MF 108,184,84
 TR 136,17,0
 TR 138,17,512
 WL 225,1024
 v_exp_f32 v117, v117
 MF 120,84,192
 TR 140,17,12288
 v_exp_f32 v118, v118
 v_exp_f32 v119, v119
 v_cvt_pk_bf16_f32 v84, v112, v113
 MF 120,92,196
 TR 142,17,12800
 s_add_u32 m0, s46, 32768
 s_add_u32 s45, s45, 0xffe50000
 WL 224,0
 v_cvt_pk_bf16_f32 v85, v114, v115
 v_cvt_pk_bf16_f32 v86, v116, v117
 MF 72,88,196
 TR 144,16,1024
 TR 146,16,1536
 v_cvt_pk_bf16_f32 v87, v118, v119
 v_exp_f32 v64, v64
 MF 72,80,192
 TR 148,16,13312
 WL 225,1024
 v_exp_f32 v65, v65
 MF 76,80,200
 TR 150,16,13824
 v_exp_f32 v66, v66
 v_exp_f32 v67, v67
 MF 76,88,204
 s_add_u32 m0, s46, 40960
 s_add_u32 s45, s45, 0x40000
 WL 224,0
 v_exp_f32 v68, v68
 MF 124,92,204
 v_exp_f32 v69, v69
 v_exp_f32 v70, v70
 v_exp_f32 v71, v71
 MF 124,84,200
 v_cvt_pk_bf16_f32 v36, v64, v65
 v_cvt_pk_bf16_f32 v37, v66, v67
 v_cvt_pk_bf16_f32 v38, v68, v69
 v_cvt_pk_bf16_f32 v39, v70, v71
 s_waitcnt lgkmcnt(0)
 MF 40,128,96
 TR 184,17,1024
 TR 186,17,1536
 v_mfma_f32_16x16x32_bf16 v[100:103], v[198:201], v[84:87], 0
 MF 40,132,104
 TR 188,17,13312
 v_mfma_f32_16x16x32_bf16 v[80:83], v[204:207], v[84:87], 0
 v_mfma_f32_16x16x32_bf16 v[52:55], v[196:199], v[36:39], 0
 MF 88,132,108
 TR 190,17,13824
 v_mfma_f32_16x16x32_bf16 v[32:35], v[202:205], v[36:39], 0
 v_pk_add_f32 v[112:113], v[112:113], v[114:115]
 v_pk_add_f32 v[116:117], v[116:117], v[118:119]
 v_pk_add_f32 v[64:65], v[64:65], v[66:67]
 v_pk_add_f32 v[68:69], v[68:69], v[70:71]
 v_pk_add_f32 v[112:113], v[112:113], v[116:117]
 v_pk_add_f32 v[64:65], v[64:65], v[68:69]
 v_add_f32 v188, v112, v113
 v_add_f32 v186, v64, v65
 MF 88,128,100
 TR 192,16,2048
 TR 194,16,2560
 v_mov_b32 v184, v186
 v_mov_b32 v185, v188
 s_nop 0
 v_permlane16_swap_b32 v186, v184
 MF 92,136,100
 TR 196,16,14336
 v_permlane16_swap_b32 v188, v185
 v_add_f32 v186, v186, v184
 v_add_f32 v188, v188, v185
 v_mov_b32 v184, v186
 MF 92,140,108
 TR 198,16,14848
 WL 225,1024
 v_mov_b32 v185, v188
 v_permlane32_swap_b32 v186, v184
 MF 44,140,104
 TR 200,17,2048
 TR 202,17,2560
 v_permlane32_swap_b32 v188, v185
 v_add_f32 v186, v186, v184
 v_add_f32 v188, v188, v185
 MF 44,136,96
 TR 204,17,14336
 v_rcp_f32 v186, v186
 v_rcp_f32 v188, v188
 s_nop 0
 v_pk_mul_f32 v[100:101], v[100:101], v[188:189] op_sel_hi:[1,0]
 v_pk_mul_f32 v[102:103], v[102:103], v[188:189] op_sel_hi:[1,0]
 v_pk_mul_f32 v[80:81], v[80:81], v[188:189] op_sel_hi:[1,0]
 v_pk_mul_f32 v[82:83], v[82:83], v[188:189] op_sel_hi:[1,0]
 v_pk_mul_f32 v[52:53], v[52:53], v[186:187] op_sel_hi:[1,0]
 v_pk_mul_f32 v[54:55], v[54:55], v[186:187] op_sel_hi:[1,0]
 v_pk_mul_f32 v[32:33], v[32:33], v[186:187] op_sel_hi:[1,0]
 v_pk_mul_f32 v[34:35], v[34:35], v[186:187] op_sel_hi:[1,0]
 s_nop 1
 MF 56,144,96
 TR 206,17,14848
 v_cvt_pk_bf16_f32 v112, v100, v101
 v_cvt_pk_bf16_f32 v113, v102, v103
 v_cvt_pk_bf16_f32 v114, v80, v81
 v_cvt_pk_bf16_f32 v115, v82, v83
 MF 56,148,104
 buffer_store_dwordx4 v[112:115], v5, s[52:55], s70 offen offset:1024 sc0 sc1
 v_cvt_pk_bf16_f32 v64, v52, v53
 v_cvt_pk_bf16_f32 v65, v54, v55
 v_cvt_pk_bf16_f32 v66, v32, v33
 MF 104,148,108
 v_cvt_pk_bf16_f32 v67, v34, v35
 buffer_store_dwordx4 v[64:67], v5, s[52:55], s70 offen offset:0 sc0 sc1
 s_add_u32 s70, s70, 32768
 MF 104,144,100
 s_waitcnt lgkmcnt(0)
 s_barrier
 MF 60,184,96
 TR 128,16,24576
 TR 130,16,25088
 MF 60,188,104
 TR 132,16,36864
 s_add_u32 m0, s46, 49152
 s_add_u32 s45, s45, 0x40000
 WL 224,0
 MF 108,188,108
 TR 134,16,37376
 ds_read_b128 v[188:191], v230 offset:384
 MF 108,184,100
 TR 136,17,24576
 TR 138,17,25088
 WL 225,1024
 MF 120,100,192
 TR 140,17,36864
 ds_read_b128 v[192:195], v230 offset:448
 MF 120,108,196
 TR 142,17,37376
 s_add_u32 m0, s46, 57344
 s_add_u32 s45, s45, 0x40000
 WL 224,0
 MF 72,104,196
 TR 144,16,25600
 TR 146,16,26112
 MF 72,96,192
 TR 148,16,37888
 WL 225,1024
 MF 76,96,200
 TR 150,16,38400
 ds_read_b128 v[180:183], v230 offset:128
 MF 76,104,204
 s_add_u32 m0, s46, 65536
 s_add_u32 s45, s45, 0x40000
 WL 224,0
 MF 124,108,204
 ds_read_b128 v[184:187], v230 offset:192
 MF 124,100,200
 s_waitcnt vmcnt(5)
 v_add_u32 v31, 1, v31
 buffer_store_dword v31, v30, s[60:63], s69 offen sc0 sc1
 s_waitcnt lgkmcnt(0)
 MF 40,128,112
 TR 184,17,25600
 TR 186,17,26112
 MF 40,132,120
 TR 188,17,37888
 MF 88,132,124
 TR 190,17,38400
 MF 88,128,116
 TR 192,16,26624
 TR 194,16,27136
 MF 92,136,116
 TR 196,16,38912
 MF 92,140,124
 TR 198,16,39424
 WL 225,1024
 MF 44,140,120
 TR 200,17,26624
 TR 202,17,27136
 MF 44,136,112
 TR 204,17,38912
 MF 56,144,112
 TR 206,17,39424
 MF 56,148,120
 MF 104,148,124
 MF 104,144,116
 s_waitcnt lgkmcnt(0)
 s_barrier
 MF 60,184,112
 MF 60,188,120
 s_add_u32 m0, s46, 73728
 s_add_u32 s45, s45, 0x40000
 WL 224,0
 MF 108,188,124
 MF 108,184,116
 WL 225,1024
 MF 120,116,192
 MF 120,124,196
 s_add_u32 m0, s46, 81920
 s_add_u32 s45, s45, 0x40000
 WL 224,0
 MF 72,120,196
 MF 72,112,192
 WL 225,1024
 MF 76,112,200
 MF 76,120,204
 s_add_u32 m0, s46, 90112
 s_add_u32 s45, s45, 0x40000
 WL 224,0
 MF 124,124,204
 MF 124,116,200
 WL 225,1024
 s_mov_b32 s5, s14
 s_mov_b32 s6, s15
 s_lshl_b32 s8, s5, 3
 s_lshl_b32 s9, s7, 1
 s_add_u32 s8, s8, s9
 s_lshl_b32 s9, s8, 15
 v_add_u32 v6, s9, v5
 s_lshl_b32 s66, s8, 6
 v_lshlrev_b32 v21, 2, v3
 s_mov_b32 s44, 0
 s_waitcnt lgkmcnt(0)
 s_add_u32 s36, s34, 4194304
 s_addc_u32 s37, s35, 0
 s_mov_b32 s38, 4194304
 s_mov_b32 s39, 0x00020000
 v_pk_fma_f32 v[104:105], v[188:189], v[142:143], v[104:105] op_sel_hi:[1,0,1] neg_lo:[0,1,0] neg_hi:[0,1,0]
 v_pk_fma_f32 v[106:107], v[190:191], v[142:143], v[106:107] op_sel_hi:[1,0,1] neg_lo:[0,1,0] neg_hi:[0,1,0]
 v_pk_fma_f32 v[108:109], v[192:193], v[142:143], v[108:109] op_sel_hi:[1,0,1] neg_lo:[0,1,0] neg_hi:[0,1,0]
 v_pk_fma_f32 v[110:111], v[194:195], v[142:143], v[110:111] op_sel_hi:[1,0,1] neg_lo:[0,1,0] neg_hi:[0,1,0]
 v_pk_mul_f32 v[104:105], v[104:105], v[142:143] op_sel:[0,1] op_sel_hi:[1,1]
 v_pk_mul_f32 v[106:107], v[106:107], v[142:143] op_sel:[0,1] op_sel_hi:[1,1]
 v_pk_mul_f32 v[108:109], v[108:109], v[142:143] op_sel:[0,1] op_sel_hi:[1,1]
 v_pk_mul_f32 v[110:111], v[110:111], v[142:143] op_sel:[0,1] op_sel_hi:[1,1]
 v_pk_fma_f32 v[120:121], v[160:161], v[154:155], v[120:121] op_sel:[0,0,0] op_sel_hi:[1,0,1] neg_lo:[1,0,0] neg_hi:[1,0,0]
 v_pk_fma_f32 v[122:123], v[162:163], v[154:155], v[122:123] op_sel:[0,0,0] op_sel_hi:[1,0,1] neg_lo:[1,0,0] neg_hi:[1,0,0]
 v_pk_fma_f32 v[124:125], v[160:161], v[154:155], v[124:125] op_sel:[0,1,0] op_sel_hi:[1,1,1] neg_lo:[1,0,0] neg_hi:[1,0,0]
 v_pk_fma_f32 v[126:127], v[162:163], v[154:155], v[126:127] op_sel:[0,1,0] op_sel_hi:[1,1,1] neg_lo:[1,0,0] neg_hi:[1,0,0]
 v_pk_mul_f32 v[120:121], v[120:121], v[172:173]
 v_pk_mul_f32 v[122:123], v[122:123], v[174:175]
 v_pk_mul_f32 v[124:125], v[124:125], v[172:173]
 v_pk_mul_f32 v[126:127], v[126:127], v[174:175]
 v_cvt_pk_bf16_f32 v104, v104, v105
 v_cvt_pk_bf16_f32 v105, v106, v107
 v_cvt_pk_bf16_f32 v106, v108, v109
 v_cvt_pk_bf16_f32 v107, v110, v111
 v_cvt_pk_bf16_f32 v200, v120, v121
 v_cvt_pk_bf16_f32 v201, v122, v123
 v_cvt_pk_bf16_f32 v206, v124, v125
 v_cvt_pk_bf16_f32 v207, v126, v127
 ds_write_b128 v231, v[104:107] offset:6144
 ds_write_b64 v231, v[200:201] offset:7168
 ds_write_b64 v231, v[206:207] offset:7176
 v_pk_fma_f32 v[88:89], v[180:181], v[142:143], v[88:89] op_sel_hi:[1,0,1] neg_lo:[0,1,0] neg_hi:[0,1,0]
 v_pk_fma_f32 v[90:91], v[182:183], v[142:143], v[90:91] op_sel_hi:[1,0,1] neg_lo:[0,1,0] neg_hi:[0,1,0]
 v_pk_fma_f32 v[92:93], v[184:185], v[142:143], v[92:93] op_sel_hi:[1,0,1] neg_lo:[0,1,0] neg_hi:[0,1,0]
 v_pk_fma_f32 v[94:95], v[186:187], v[142:143], v[94:95] op_sel_hi:[1,0,1] neg_lo:[0,1,0] neg_hi:[0,1,0]
 v_pk_mul_f32 v[88:89], v[88:89], v[142:143] op_sel:[0,1] op_sel_hi:[1,1]
 v_pk_mul_f32 v[90:91], v[90:91], v[142:143] op_sel:[0,1] op_sel_hi:[1,1]
 v_pk_mul_f32 v[92:93], v[92:93], v[142:143] op_sel:[0,1] op_sel_hi:[1,1]
 v_pk_mul_f32 v[94:95], v[94:95], v[142:143] op_sel:[0,1] op_sel_hi:[1,1]
 s_branch L_sequential_preLN__sliding_local_dilated__geglu_ffn__prompt_kernel_pg5_skip
.p2align 12
L_sequential_preLN__sliding_local_dilated__geglu_ffn__prompt_kernel_pg5:
 s_branch L_sequential_preLN__sliding_local_dilated__geglu_ffn__prompt_kernel_hop0_ret
L_sequential_preLN__sliding_local_dilated__geglu_ffn__prompt_kernel_pg5b:
 s_branch L_sequential_preLN__sliding_local_dilated__geglu_ffn__prompt_kernel_sp_ret
L_sequential_preLN__sliding_local_dilated__geglu_ffn__prompt_kernel_pg5_skip:
 v_pk_fma_f32 v[40:41], v[180:181], v[140:141], v[40:41] op_sel_hi:[1,0,1] neg_lo:[0,1,0] neg_hi:[0,1,0]
 v_pk_fma_f32 v[42:43], v[182:183], v[140:141], v[42:43] op_sel_hi:[1,0,1] neg_lo:[0,1,0] neg_hi:[0,1,0]
 v_pk_fma_f32 v[44:45], v[184:185], v[140:141], v[44:45] op_sel_hi:[1,0,1] neg_lo:[0,1,0] neg_hi:[0,1,0]
 v_pk_fma_f32 v[46:47], v[186:187], v[140:141], v[46:47] op_sel_hi:[1,0,1] neg_lo:[0,1,0] neg_hi:[0,1,0]
 v_pk_mul_f32 v[40:41], v[40:41], v[140:141] op_sel:[0,1] op_sel_hi:[1,1]
 v_pk_mul_f32 v[42:43], v[42:43], v[140:141] op_sel:[0,1] op_sel_hi:[1,1]
 v_pk_mul_f32 v[44:45], v[44:45], v[140:141] op_sel:[0,1] op_sel_hi:[1,1]
 v_pk_mul_f32 v[46:47], v[46:47], v[140:141] op_sel:[0,1] op_sel_hi:[1,1]
 v_pk_fma_f32 v[56:57], v[188:189], v[140:141], v[56:57] op_sel_hi:[1,0,1] neg_lo:[0,1,0] neg_hi:[0,1,0]
 v_pk_fma_f32 v[58:59], v[190:191], v[140:141], v[58:59] op_sel_hi:[1,0,1] neg_lo:[0,1,0] neg_hi:[0,1,0]
 v_pk_fma_f32 v[60:61], v[192:193], v[140:141], v[60:61] op_sel_hi:[1,0,1] neg_lo:[0,1,0] neg_hi:[0,1,0]
 v_pk_fma_f32 v[62:63], v[194:195], v[140:141], v[62:63] op_sel_hi:[1,0,1] neg_lo:[0,1,0] neg_hi:[0,1,0]
 v_pk_mul_f32 v[56:57], v[56:57], v[140:141] op_sel:[0,1] op_sel_hi:[1,1]
 v_pk_mul_f32 v[58:59], v[58:59], v[140:141] op_sel:[0,1] op_sel_hi:[1,1]
 v_pk_mul_f32 v[60:61], v[60:61], v[140:141] op_sel:[0,1] op_sel_hi:[1,1]
 v_pk_mul_f32 v[62:63], v[62:63], v[140:141] op_sel:[0,1] op_sel_hi:[1,1]
 v_pk_fma_f32 v[72:73], v[156:157], v[154:155], v[72:73] op_sel:[0,0,0] op_sel_hi:[1,0,1] neg_lo:[1,0,0] neg_hi:[1,0,0]
 v_pk_fma_f32 v[74:75], v[158:159], v[154:155], v[74:75] op_sel:[0,0,0] op_sel_hi:[1,0,1] neg_lo:[1,0,0] neg_hi:[1,0,0]
 v_pk_fma_f32 v[76:77], v[156:157], v[154:155], v[76:77] op_sel:[0,1,0] op_sel_hi:[1,1,1] neg_lo:[1,0,0] neg_hi:[1,0,0]
 v_pk_fma_f32 v[78:79], v[158:159], v[154:155], v[78:79] op_sel:[0,1,0] op_sel_hi:[1,1,1] neg_lo:[1,0,0] neg_hi:[1,0,0]
 v_pk_mul_f32 v[72:73], v[72:73], v[168:169]
 v_pk_mul_f32 v[74:75], v[74:75], v[170:171]
 v_pk_mul_f32 v[76:77], v[76:77], v[168:169]
 v_pk_mul_f32 v[78:79], v[78:79], v[170:171]
 v_cvt_pk_bf16_f32 v88, v88, v89
 v_cvt_pk_bf16_f32 v89, v90, v91
 v_cvt_pk_bf16_f32 v90, v92, v93
 v_cvt_pk_bf16_f32 v91, v94, v95
 v_cvt_pk_bf16_f32 v56, v56, v57
 v_cvt_pk_bf16_f32 v57, v58, v59
 v_cvt_pk_bf16_f32 v58, v60, v61
 v_cvt_pk_bf16_f32 v59, v62, v63
 v_cvt_pk_bf16_f32 v40, v40, v41
 v_cvt_pk_bf16_f32 v41, v42, v43
 v_cvt_pk_bf16_f32 v42, v44, v45
 v_cvt_pk_bf16_f32 v43, v46, v47
 v_cvt_pk_bf16_f32 v198, v72, v73
 v_cvt_pk_bf16_f32 v199, v74, v75
 v_cvt_pk_bf16_f32 v204, v76, v77
 v_cvt_pk_bf16_f32 v205, v78, v79
 s_waitcnt lgkmcnt(0)
 s_barrier
 ds_read_b128 v[208:211], v231 offset:2048
 ds_read_b64 v[196:197], v231 offset:3072
 ds_read_b64 v[202:203], v231 offset:3080
 s_waitcnt lgkmcnt(0)
 s_mov_b32 s9, 0x3e8293ee
 s_mov_b32 s10, 0x3e8293ee
 s_mov_b32 s11, 0x3e8293ee
 v_mfma_f32_16x16x32_bf16 v[124:127], v[104:107], v[88:91], v[220:223]
 v_mfma_f32_16x16x32_bf16 v[76:79], v[56:59], v[40:43], v[220:223]
 v_mfma_f32_16x16x32_bf16 v[120:123], v[56:59], v[88:91], v[216:219]
 v_mfma_f32_16x16x32_bf16 v[72:75], v[208:211], v[40:43], v[212:215]
 s_nop 4
 v_max3_f32 v182, v124, v125, v126
 v_max3_f32 v180, v76, v77, v78
 v_max3_f32 v182, v182, v127, v120
 v_max3_f32 v182, v182, v121, v122
 v_max_f32 v182, v182, v123
 v_max3_f32 v180, v180, v79, v72
 v_max3_f32 v180, v180, v73, v74
 v_max_f32 v180, v180, v75
 v_mov_b32 v184, v180
 v_mov_b32 v185, v182
 s_nop 0
 v_permlane16_swap_b32 v180, v184
 v_permlane16_swap_b32 v182, v185
 v_max_f32 v180, v180, v184
 v_max_f32 v182, v182, v185
 v_mov_b32 v184, v180
 v_mov_b32 v185, v182
 s_nop 0
 v_permlane32_swap_b32 v180, v184
 v_permlane32_swap_b32 v182, v185
 v_max_f32 v180, v180, v184
 v_max_f32 v182, v182, v185
 v_mul_f32 v180, s9, v180
 v_mul_f32 v182, s9, v182
 v_pk_fma_f32 v[120:121], v[120:121], s[10:11], v[182:183] op_sel_hi:[1,1,0] neg_lo:[0,0,1] neg_hi:[0,0,1]
 v_pk_fma_f32 v[122:123], v[122:123], s[10:11], v[182:183] op_sel_hi:[1,1,0] neg_lo:[0,0,1] neg_hi:[0,0,1]
 v_pk_fma_f32 v[124:125], v[124:125], s[10:11], v[182:183] op_sel_hi:[1,1,0] neg_lo:[0,0,1] neg_hi:[0,0,1]
 v_pk_fma_f32 v[126:127], v[126:127], s[10:11], v[182:183] op_sel_hi:[1,1,0] neg_lo:[0,0,1] neg_hi:[0,0,1]
 v_pk_fma_f32 v[72:73], v[72:73], s[10:11], v[180:181] op_sel_hi:[1,1,0] neg_lo:[0,0,1] neg_hi:[0,0,1]
 v_pk_fma_f32 v[74:75], v[74:75], s[10:11], v[180:181] op_sel_hi:[1,1,0] neg_lo:[0,0,1] neg_hi:[0,0,1]
 v_pk_fma_f32 v[76:77], v[76:77], s[10:11], v[180:181] op_sel_hi:[1,1,0] neg_lo:[0,0,1] neg_hi:[0,0,1]
 v_pk_fma_f32 v[78:79], v[78:79], s[10:11], v[180:181] op_sel_hi:[1,1,0] neg_lo:[0,0,1] neg_hi:[0,0,1]
 buffer_load_dword v22, v21, s[60:63], s66 offen sc0 sc1
 v_exp_f32 v120, v120
 v_exp_f32 v121, v121
 v_exp_f32 v122, v122
 v_exp_f32 v123, v123
 v_exp_f32 v124, v124
 v_exp_f32 v125, v125
 v_exp_f32 v126, v126
 v_exp_f32 v127, v127
 v_cvt_pk_bf16_f32 v92, v120, v121
 v_cvt_pk_bf16_f32 v93, v122, v123
 v_cvt_pk_bf16_f32 v94, v124, v125
 v_cvt_pk_bf16_f32 v95, v126, v127
 v_exp_f32 v72, v72
 v_exp_f32 v73, v73
 v_exp_f32 v74, v74
 v_exp_f32 v75, v75
 v_exp_f32 v76, v76
 v_exp_f32 v77, v77
 v_exp_f32 v78, v78
 v_exp_f32 v79, v79
 v_cvt_pk_bf16_f32 v44, v72, v73
 v_cvt_pk_bf16_f32 v45, v74, v75
 v_cvt_pk_bf16_f32 v46, v76, v77
 v_cvt_pk_bf16_f32 v47, v78, v79
 v_mfma_f32_16x16x32_bf16 v[108:111], v[198:201], v[92:95], 0
 v_mfma_f32_16x16x32_bf16 v[88:91], v[204:207], v[92:95], 0
 v_mfma_f32_16x16x32_bf16 v[60:63], v[196:199], v[44:47], 0
 v_mfma_f32_16x16x32_bf16 v[40:43], v[202:205], v[44:47], 0
 v_pk_add_f32 v[120:121], v[120:121], v[122:123]
 v_pk_add_f32 v[124:125], v[124:125], v[126:127]
 v_pk_add_f32 v[72:73], v[72:73], v[74:75]
 v_pk_add_f32 v[76:77], v[76:77], v[78:79]
 v_pk_add_f32 v[120:121], v[120:121], v[124:125]
 v_pk_add_f32 v[72:73], v[72:73], v[76:77]
 v_add_f32 v188, v120, v121
 v_add_f32 v186, v72, v73
 v_mov_b32 v184, v186
 v_mov_b32 v185, v188
 s_nop 0
 v_permlane16_swap_b32 v186, v184
 v_permlane16_swap_b32 v188, v185
 v_add_f32 v186, v186, v184
 v_add_f32 v188, v188, v185
 v_mov_b32 v184, v186
 v_mov_b32 v185, v188
 s_nop 0
 v_permlane32_swap_b32 v186, v184
 v_permlane32_swap_b32 v188, v185
 v_add_f32 v186, v186, v184
 v_add_f32 v188, v188, v185
 v_rcp_f32 v186, v186
 v_rcp_f32 v188, v188
 s_nop 0
 v_pk_mul_f32 v[108:109], v[108:109], v[188:189] op_sel_hi:[1,0]
 v_pk_mul_f32 v[110:111], v[110:111], v[188:189] op_sel_hi:[1,0]
 v_pk_mul_f32 v[88:89], v[88:89], v[188:189] op_sel_hi:[1,0]
 v_pk_mul_f32 v[90:91], v[90:91], v[188:189] op_sel_hi:[1,0]
 v_pk_mul_f32 v[60:61], v[60:61], v[186:187] op_sel_hi:[1,0]
 v_pk_mul_f32 v[62:63], v[62:63], v[186:187] op_sel_hi:[1,0]
 v_pk_mul_f32 v[40:41], v[40:41], v[186:187] op_sel_hi:[1,0]
 v_pk_mul_f32 v[42:43], v[42:43], v[186:187] op_sel_hi:[1,0]
 v_cvt_pk_bf16_f32 v120, v108, v109
 v_cvt_pk_bf16_f32 v121, v110, v111
 v_cvt_pk_bf16_f32 v122, v88, v89
 v_cvt_pk_bf16_f32 v123, v90, v91
 buffer_store_dwordx4 v[120:123], v5, s[52:55], s70 offen offset:1024 sc0 sc1
 v_cvt_pk_bf16_f32 v72, v60, v61
 v_cvt_pk_bf16_f32 v73, v62, v63
 v_cvt_pk_bf16_f32 v74, v40, v41
 v_cvt_pk_bf16_f32 v75, v42, v43
 buffer_store_dwordx4 v[72:75], v5, s[52:55], s70 offen offset:0 sc0 sc1
 s_add_u32 s70, s70, 32768
 s_waitcnt vmcnt(2)
 s_cmp_eq_u32 s66, 262144
 s_cbranch_scc1 L_chk2a_ok
 s_add_u32 s71, s96, 1
 s_mov_b32 s47, 0x100000
L_chk2a:
 v_subrev_u32 v23, s71, v22
 v_cmp_lt_u32 vcc, 1, v23
 s_nop 1
 s_cmp_eq_u64 vcc, 0
 s_cbranch_scc1 L_chk2a_go
 s_sub_u32 s47, s47, 1
 s_cbranch_scc1 L_chk2a_go
 buffer_load_dword v22, v21, s[60:63], s66 offen sc0 sc1
 s_waitcnt vmcnt(0)
 s_branch L_chk2a
L_chk2a_go:
 v_cmp_ne_u32 vcc, 1, v23
 s_nop 1
 s_cmp_eq_u64 vcc, 0
 s_cselect_b32 s66, 262144, s66
L_chk2a_ok:
 XL 0,6,0
 XL 4,6,1024
 XL 8,6,2048
 XL 12,6,3072
 s_add_u32 s44, s44, 4096
 XL 16,6,0
 XL 20,6,1024
 XL 24,6,2048
 XL 28,6,3072
 s_add_u32 s44, s44, 4096
 XL 32,6,0
 XL 36,6,1024
 XL 40,6,2048
 XL 44,6,3072
 s_add_u32 s44, s44, 4096
 XL 48,6,0
 XL 52,6,1024
 XL 56,6,2048
 XL 60,6,3072
 s_add_u32 s44, s44, 4096
 s_lshl_b32 s11, s8, 6
 v_lshlrev_b32 v32, 16, v232
 v_and_b32 v33, 0xffff0000, v232
 v_lshlrev_b32 v34, 16, v233
 v_and_b32 v35, 0xffff0000, v233
 v_lshlrev_b32 v36, 16, v234
 v_and_b32 v37, 0xffff0000, v234
 v_lshlrev_b32 v38, 16, v235
 v_and_b32 v39, 0xffff0000, v235
 v_lshlrev_b32 v40, 16, v236
 v_and_b32 v41, 0xffff0000, v236
 v_lshlrev_b32 v42, 16, v237
 v_and_b32 v43, 0xffff0000, v237
 v_lshlrev_b32 v44, 16, v238
 v_and_b32 v45, 0xffff0000, v238
 v_lshlrev_b32 v46, 16, v239
 v_and_b32 v47, 0xffff0000, v239
 v_lshlrev_b32 v48, 16, v240
 v_and_b32 v49, 0xffff0000, v240
 v_lshlrev_b32 v50, 16, v241
 v_and_b32 v51, 0xffff0000, v241
 v_lshlrev_b32 v52, 16, v242
 v_and_b32 v53, 0xffff0000, v242
 v_lshlrev_b32 v54, 16, v243
 v_and_b32 v55, 0xffff0000, v243
 v_lshlrev_b32 v56, 16, v244
 v_and_b32 v57, 0xffff0000, v244
 v_lshlrev_b32 v58, 16, v245
 v_and_b32 v59, 0xffff0000, v245
 v_lshlrev_b32 v60, 16, v246
 v_and_b32 v61, 0xffff0000, v246
 v_lshlrev_b32 v62, 16, v247
 v_and_b32 v63, 0xffff0000, v247
 v_mov_b32 v80, v248
 v_mov_b32 v82, v250
 v_pk_add_f32 v[32:33], v[32:33], v[80:81] op_sel_hi:[1,0] neg_lo:[0,1] neg_hi:[0,1]
 v_pk_add_f32 v[34:35], v[34:35], v[80:81] op_sel_hi:[1,0] neg_lo:[0,1] neg_hi:[0,1]
 v_pk_add_f32 v[36:37], v[36:37], v[80:81] op_sel_hi:[1,0] neg_lo:[0,1] neg_hi:[0,1]
 v_pk_add_f32 v[38:39], v[38:39], v[80:81] op_sel_hi:[1,0] neg_lo:[0,1] neg_hi:[0,1]
 v_pk_add_f32 v[40:41], v[40:41], v[80:81] op_sel_hi:[1,0] neg_lo:[0,1] neg_hi:[0,1]
 v_pk_add_f32 v[42:43], v[42:43], v[80:81] op_sel_hi:[1,0] neg_lo:[0,1] neg_hi:[0,1]
 v_pk_add_f32 v[44:45], v[44:45], v[80:81] op_sel_hi:[1,0] neg_lo:[0,1] neg_hi:[0,1]
 v_pk_add_f32 v[46:47], v[46:47], v[80:81] op_sel_hi:[1,0] neg_lo:[0,1] neg_hi:[0,1]
 v_pk_add_f32 v[48:49], v[48:49], v[82:83] op_sel_hi:[1,0] neg_lo:[0,1] neg_hi:[0,1]
 v_pk_add_f32 v[50:51], v[50:51], v[82:83] op_sel_hi:[1,0] neg_lo:[0,1] neg_hi:[0,1]
 v_pk_add_f32 v[52:53], v[52:53], v[82:83] op_sel_hi:[1,0] neg_lo:[0,1] neg_hi:[0,1]
 v_pk_add_f32 v[54:55], v[54:55], v[82:83] op_sel_hi:[1,0] neg_lo:[0,1] neg_hi:[0,1]
 v_pk_add_f32 v[56:57], v[56:57], v[82:83] op_sel_hi:[1,0] neg_lo:[0,1] neg_hi:[0,1]
 v_pk_add_f32 v[58:59], v[58:59], v[82:83] op_sel_hi:[1,0] neg_lo:[0,1] neg_hi:[0,1]
 v_pk_add_f32 v[60:61], v[60:61], v[82:83] op_sel_hi:[1,0] neg_lo:[0,1] neg_hi:[0,1]
 v_pk_add_f32 v[62:63], v[62:63], v[82:83] op_sel_hi:[1,0] neg_lo:[0,1] neg_hi:[0,1]
 v_lshrrev_b32 v27, 2, v3
 v_and_b32 v23, 3, v3
 v_lshl_add_u32 v24, v4, 2, v27
 v_lshrrev_b32 v25, 1, v24
 v_and_b32 v25, 3, v25
 v_lshlrev_b32 v24, 7, v24
 v_lshl_add_u32 v24, v23, 3, v24
 v_xor_b32 v26, 0, v25
 v_lshl_add_u32 v10, v26, 5, v24
 v_add_u32 v14, 65536, v10
 v_xor_b32 v26, 1, v25
 v_lshl_add_u32 v11, v26, 5, v24
 v_add_u32 v15, 65536, v11
 v_xor_b32 v26, 2, v25
 v_lshl_add_u32 v12, v26, 5, v24
 v_add_u32 v16, 65536, v12
 v_xor_b32 v26, 3, v25
 v_lshl_add_u32 v13, v26, 5, v24
 v_add_u32 v17, 65536, v13
 v_min_u32 v27, 2, v23
 v_lshlrev_b32 v27, 11, v27
 v_lshl_add_u32 v27, v4, 4, v27
 v_add_u32 v9, 131072, v27
 s_waitcnt vmcnt(16)
 v_add_u32 v31, 1, v31
 buffer_store_dword v31, v30, s[60:63], s69 offen sc0 sc1
 s_waitcnt vmcnt(49)
 s_barrier
 TR 176,14,32768
 TR 178,14,34816
 TR 180,15,32768
 TR 182,15,34816
 ds_read_b128 a[184:187], v9 offset:0
 TR 188,14,36864
 TR 190,14,38912
 TR 192,15,36864
 TR 194,15,38912
 ds_read_b128 a[196:199], v9 offset:128
 TR 200,14,40960
 TR 202,14,43008
 TR 204,15,40960
 TR 206,15,43008
 ds_read_b128 a[208:211], v9 offset:256
 s_cmp_eq_u32 s7, 0
 s_cbranch_scc1 L_sequential_preLN__sliding_local_dilated__geglu_ffn__prompt_kernel_hop4_e0
 s_cmp_eq_u32 s7, 1
 s_cbranch_scc1 L_sequential_preLN__sliding_local_dilated__geglu_ffn__prompt_kernel_hop4_e1
 s_cmp_eq_u32 s7, 2
 s_cbranch_scc1 L_sequential_preLN__sliding_local_dilated__geglu_ffn__prompt_kernel_hop4_e2
 s_branch L_sequential_preLN__sliding_local_dilated__geglu_ffn__prompt_kernel_hop4_e3
L_sequential_preLN__sliding_local_dilated__geglu_ffn__prompt_kernel_hop4_ret:
 s_add_u32 s52, s34, 8388608
 s_addc_u32 s53, s35, 0
 s_mov_b32 s54, 4194304
 s_mov_b32 s55, 0x00020000
 s_add_u32 s56, s34, 12582912
 s_addc_u32 s57, s35, 0
 s_mov_b32 s58, 131072
 s_mov_b32 s59, 0x00020000
 s_add_u32 s48, s34, 13697024
 s_addc_u32 s49, s35, 0
 s_mov_b32 s50, 262144
 s_mov_b32 s51, 0x00020000
 s_and_b32 s15, s3, 1
 s_lshl_b32 s15, s15, 2
 s_and_b32 s9, s4, 3
 s_add_u32 s15, s15, s9
 s_lshr_b32 s14, s3, 1
 s_lshl_b32 s14, s14, 3
 s_lshr_b32 s9, s4, 2
 s_add_u32 s14, s14, s9
 s_and_b32 s15, s14, 1
 s_and_b32 s9, s7, 1
 s_mul_i32 s10, s14, 224
 s_mul_i32 s9, s9, 458752
 s_add_u32 s10, s10, s9
 s_movk_i32 s9, 7168
 s_mov_b32 s12, 0x4925
 v_mov_b32 v31, s96
 s_lshr_b32 s64, s8, 2
 s_lshl_b32 s64, s64, 17
 s_lshl_b32 s13, s6, 12
 s_add_u32 s64, s64, s13
 s_and_b32 s13, s8, 3
 s_lshl_b32 s13, s13, 10
 s_add_u32 s64, s64, s13
 s_lshl_b32 s65, s8, 6
 s_lshl_b32 s13, s6, 2
 s_add_u32 s65, s65, s13
 s_add_u32 s65, s65, 8192
 v_add_u32 v176, 0, v1
 v_mul_u32_u24 v177, s12, v176
 v_lshrrev_b32 v177, 18, v177
 v_mul_u32_u24 v178, 14, v177
 v_sub_u32 v178, v176, v178
 v_lshrrev_b32 v179, 1, v178
 v_add_u32 v179, s15, v179
 v_cmp_eq_u32 vcc, 7, v179
 v_and_b32 v178, 1, v178
 v_mul_u32_u24 v177, s9, v177
 v_cndmask_b32 v179, v179, 0, vcc
 v_lshlrev_b32 v179, 5, v179
 v_lshl_add_u32 v179, v178, 4, v179
 v_add3_u32 v225, v177, v179, s10
 v_subrev_u32 v225, 0, v225
 v_add_u32 v180, 64, v1
 v_mul_u32_u24 v181, s12, v180
 v_lshrrev_b32 v181, 18, v181
 v_mul_u32_u24 v182, 14, v181
 v_sub_u32 v182, v180, v182
 v_lshrrev_b32 v183, 1, v182
 v_add_u32 v183, s15, v183
 v_cmp_eq_u32 vcc, 7, v183
 v_and_b32 v182, 1, v182
 v_mul_u32_u24 v181, s9, v181
 v_cndmask_b32 v183, v183, 0, vcc
 v_lshlrev_b32 v183, 5, v183
 v_lshl_add_u32 v183, v182, 4, v183
 v_add3_u32 v226, v181, v183, s10
 v_subrev_u32 v226, 1024, v226
 v_add_u32 v184, 128, v1
 v_mul_u32_u24 v185, s12, v184
 v_lshrrev_b32 v185, 18, v185
 v_mul_u32_u24 v186, 14, v185
 v_sub_u32 v186, v184, v186
 v_lshrrev_b32 v187, 1, v186
 v_add_u32 v187, s15, v187
 v_cmp_eq_u32 vcc, 7, v187
 v_and_b32 v186, 1, v186
 v_mul_u32_u24 v185, s9, v185
 v_cndmask_b32 v187, v187, 0, vcc
 v_lshlrev_b32 v187, 5, v187
 v_lshl_add_u32 v187, v186, 4, v187
 v_add3_u32 v227, v185, v187, s10
 v_subrev_u32 v227, 2048, v227
 v_add_u32 v188, 192, v1
 v_mul_u32_u24 v189, s12, v188
 v_lshrrev_b32 v189, 18, v189
 v_mul_u32_u24 v190, 14, v189
 v_sub_u32 v190, v188, v190
 v_lshrrev_b32 v191, 1, v190
 v_add_u32 v191, s15, v191
 v_cmp_eq_u32 vcc, 7, v191
 v_and_b32 v190, 1, v190
 v_mul_u32_u24 v189, s9, v189
 v_cndmask_b32 v191, v191, 0, vcc
 v_lshlrev_b32 v191, 5, v191
 v_lshl_add_u32 v191, v190, 4, v191
 v_add3_u32 v228, v189, v191, s10
 v_subrev_u32 v228, 3072, v228
 v_add_u32 v192, 256, v1
 v_mul_u32_u24 v193, s12, v192
 v_lshrrev_b32 v193, 18, v193
 v_mul_u32_u24 v194, 14, v193
 v_sub_u32 v194, v192, v194
 v_lshrrev_b32 v195, 1, v194
 v_add_u32 v195, s15, v195
 v_cmp_eq_u32 vcc, 7, v195
 v_and_b32 v194, 1, v194
 v_mul_u32_u24 v193, s9, v193
 v_cndmask_b32 v195, v195, 0, vcc
 v_lshlrev_b32 v195, 5, v195
 v_lshl_add_u32 v195, v194, 4, v195
 v_add3_u32 v229, v193, v195, s10
 v_subrev_u32 v229, 0, v229
 v_add_u32 v196, 320, v1
 v_mul_u32_u24 v197, s12, v196
 v_lshrrev_b32 v197, 18, v197
 v_mul_u32_u24 v198, 14, v197
 v_sub_u32 v198, v196, v198
 v_lshrrev_b32 v199, 1, v198
 v_add_u32 v199, s15, v199
 v_cmp_eq_u32 vcc, 7, v199
 v_and_b32 v198, 1, v198
 v_mul_u32_u24 v197, s9, v197
 v_cndmask_b32 v199, v199, 0, vcc
 v_lshlrev_b32 v199, 5, v199
 v_lshl_add_u32 v199, v198, 4, v199
 v_add3_u32 v230, v197, v199, s10
 v_subrev_u32 v230, 1024, v230
 v_add_u32 v200, 384, v1
 v_mul_u32_u24 v201, s12, v200
 v_lshrrev_b32 v201, 18, v201
 v_mul_u32_u24 v202, 14, v201
 v_sub_u32 v202, v200, v202
 v_lshrrev_b32 v203, 1, v202
 v_add_u32 v203, s15, v203
 v_cmp_eq_u32 vcc, 7, v203
 v_and_b32 v202, 1, v202
 v_mul_u32_u24 v201, s9, v201
 v_cndmask_b32 v203, v203, 0, vcc
 v_lshlrev_b32 v203, 5, v203
 v_lshl_add_u32 v203, v202, 4, v203
 v_add3_u32 v231, v201, v203, s10
 v_subrev_u32 v231, 2048, v231
 s_waitcnt vmcnt(11) lgkmcnt(0)
 MF 32,176,0
 TR 216,14,45056
 TR 218,14,47104
 MF 32,188,8
 TR 220,15,45056
 XL 64,6,0
 MF 32,200,16
 TR 222,15,47104
 MF 48,200,20
 ds_read_b128 a[224:227], v9 offset:384
 XL 68,6,1024
 MF 48,188,12
 TR 228,10,0
 MF 48,176,4
 TR 230,10,2048
 MF 52,180,4
 TR 232,11,0
 TR 234,11,2048
 XL 72,6,2048
 MF 52,192,12
 ds_read_b128 a[236:239], v9 offset:512
 MF 52,204,20
 TR 240,10,4096
 XL 76,6,3072
 s_add_u32 s44, s44, 4096
 MF 36,204,16
 TR 242,10,6144
 MF 36,192,8
 TR 244,11,4096
 XL 80,6,0
 MF 36,180,0
 TR 246,11,6144
 v_mfma_f32_16x16x32_bf16 v[84:87], a[184:187], a[0:3], 0
 ds_read_b128 a[248:251], v9 offset:640
 MF 84,196,8
 XL 84,6,1024
 MF 84,208,16
 v_mfma_f32_16x16x32_bf16 v[88:91], a[208:211], a[20:23], 0
 buffer_load_dword v22, v21, s[60:63], s66 offen sc0 sc1
 MF 88,196,12
 MF 88,184,4
 s_waitcnt vmcnt(12) lgkmcnt(0)
 s_barrier
 MF 32,216,24
 TR 176,10,8192
 TR 178,10,10240
 MF 32,228,32
 TR 180,11,8192
 XL 88,6,2048
 MF 32,240,40
 TR 182,11,10240
 MF 48,240,44
 ds_read_b128 a[184:187], v9 offset:768
 MF 48,228,36
 TR 188,10,12288
 XL 92,6,3072
 s_add_u32 s44, s44, 4096
 MF 48,216,28
 TR 190,10,14336
 MF 52,220,28
 TR 192,11,12288
 TR 194,11,14336
 MF 52,232,36
 ds_read_b128 a[196:199], v9 offset:896
 XL 96,6,0
 MF 52,244,44
 TR 200,10,16384
 MF 36,244,40
 TR 202,10,18432
 XL 100,6,1024
 MF 36,232,32
 TR 204,11,16384
 MF 36,220,24
 TR 206,11,18432
 MF 84,224,24
 ds_read_b128 a[208:211], v9 offset:1024
 XL 104,6,2048
 MF 84,236,32
 MF 84,248,40
 MF 88,248,44
 XL 108,6,3072
 s_add_u32 s44, s44, 4096
 MF 88,236,36
 MF 88,224,28
 s_waitcnt vmcnt(11) lgkmcnt(0)
 s_barrier
 MF 32,176,48
 TR 216,10,20480
 TR 218,10,22528
 MF 32,188,56
 TR 220,11,20480
 MF 32,200,64
 TR 222,11,22528
 XL 112,6,0
 MF 48,200,68
 ds_read_b128 a[224:227], v9 offset:1152
 MF 48,188,60
 TR 228,14,49152
 MF 48,176,52
 TR 230,14,51200
 MF 52,180,52
 TR 232,15,49152
 TR 234,15,51200
 XL 116,6,1024
 MF 52,192,60
 ds_read_b128 a[236:239], v9 offset:1280
 MF 52,204,68
 TR 240,14,53248
 MF 36,204,64
 TR 242,14,55296
 MF 36,192,56
 TR 244,15,53248
 XL 120,6,2048
 MF 36,180,48
 TR 246,15,55296
 MF 84,184,48
 ds_read_b128 a[248:251], v9 offset:1408
 MF 84,196,56
 MF 84,208,64
 XL 124,6,3072
 s_add_u32 s44, s44, 4096
 MF 88,208,68
 MF 88,196,60
 MF 88,184,52
 s_waitcnt vmcnt(10)
 s_cmp_eq_u32 s66, 262144
 s_cbranch_scc1 L_chk2_ok
 s_add_u32 s71, s96, 2
 s_mov_b32 s47, 0x100000
L_chk2:
 v_subrev_u32 v23, s71, v22
 v_cmp_lt_u32 vcc, 0, v23
 s_nop 1
 s_cmp_eq_u64 vcc, 0
 s_cbranch_scc1 L_chk2_go
 s_sub_u32 s47, s47, 1
 s_cbranch_scc1 L_chk2_go
 buffer_load_dword v22, v21, s[60:63], s66 offen sc0 sc1
 s_waitcnt vmcnt(0)
 s_branch L_chk2
L_chk2_go:
 v_cmp_ne_u32 vcc, 0, v23
 s_nop 1
 s_cmp_eq_u64 vcc, 0
 s_cselect_b32 s66, 262144, s66
L_chk2_ok:
 s_waitcnt vmcnt(8) lgkmcnt(0)
 s_barrier
 MF 32,216,72
 TR 176,14,57344
 TR 178,14,59392
 MF 32,228,80
 TR 180,15,57344
 XL 128,6,0
 MF 32,240,88
 TR 182,15,59392
 MF 48,240,92
 ds_read_b128 a[184:187], v9 offset:1536
 MF 48,228,84
 TR 188,14,61440
 XL 132,6,1024
 MF 48,216,76
 TR 190,14,63488
 MF 52,220,76
 TR 192,15,61440
 TR 194,15,63488
 MF 52,232,84
 ds_read_b128 a[196:199], v9 offset:1664
 XL 136,6,2048
 MF 52,244,92
 TR 200,10,24576
 MF 36,244,88
 TR 202,10,26624
 XL 140,6,3072
 s_add_u32 s44, s44, 4096
 MF 36,232,80
 TR 204,11,24576
 MF 36,220,72
 TR 206,11,26624
 MF 84,224,72
 ds_read_b128 a[208:211], v9 offset:1792
 XL 144,6,0
 MF 84,236,80
 MF 84,248,88
 MF 88,248,92
 XL 148,6,1024
 MF 88,236,84
 s_branch L_sequential_preLN__sliding_local_dilated__geglu_ffn__prompt_kernel_pg6_skip
.p2align 12
L_sequential_preLN__sliding_local_dilated__geglu_ffn__prompt_kernel_pg6:
 s_branch L_sequential_preLN__sliding_local_dilated__geglu_ffn__prompt_kernel_hop0_ret
L_sequential_preLN__sliding_local_dilated__geglu_ffn__prompt_kernel_pg6b:
 s_branch L_sequential_preLN__sliding_local_dilated__geglu_ffn__prompt_kernel_sp_ret
L_sequential_preLN__sliding_local_dilated__geglu_ffn__prompt_kernel_pg6_skip:
 MF 88,224,76
 s_waitcnt vmcnt(8) lgkmcnt(0)
 s_barrier
 MF 32,176,96
 TR 216,10,28672
 TR 218,10,30720
 MF 32,188,104
 TR 220,11,28672
 XL 152,6,2048
 MF 32,200,112
 TR 222,11,30720
 MF 48,200,116
 ds_read_b128 a[224:227], v9 offset:1920
 MF 48,188,108
 TR 228,10,32768
 XL 156,6,3072
 s_add_u32 s44, s44, 4096
 MF 48,176,100
 TR 230,10,34816
 MF 52,180,100
 TR 232,11,32768
 TR 234,11,34816
 MF 52,192,108
 ds_read_b128 a[236:239], v9 offset:64
 XL 160,6,0
 MF 52,204,116
 TR 240,10,36864
 MF 36,204,112
 TR 242,10,38912
 XL 164,6,1024
 MF 36,192,104
 TR 244,11,36864
 MF 36,180,96
 TR 246,11,38912
 MF 84,184,96
 ds_read_b128 a[248:251], v9 offset:192
 XL 168,6,2048
 MF 84,196,104
 MF 84,208,112
 MF 88,208,116
 XL 172,6,3072
 s_add_u32 s44, s44, 4096
 MF 88,196,108
 MF 88,184,100
 s_waitcnt vmcnt(8) lgkmcnt(0)
 s_barrier
 MF 32,216,120
 TR 176,10,40960
 TR 178,10,43008
 MF 32,228,128
 TR 180,11,40960
 buffer_load_dwordx4 v[96:99], v6, s[36:39], s44 offen offset:0
 MF 32,240,136
 TR 182,11,43008
 MF 48,240,140
 ds_read_b128 a[184:187], v9 offset:320
 MF 48,228,132
 TR 188,10,45056
 buffer_load_dwordx4 v[100:103], v6, s[36:39], s44 offen offset:1024
 MF 48,216,124
 TR 190,10,47104
 MF 52,220,124
 TR 192,11,45056
 TR 194,11,47104
 MF 52,232,132
 ds_read_b128 a[196:199], v9 offset:448
 buffer_load_dwordx4 v[104:107], v6, s[36:39], s44 offen offset:2048
 MF 52,244,140
 TR 200,10,49152
 MF 36,244,136
 TR 202,10,51200
 buffer_load_dwordx4 v[108:111], v6, s[36:39], s44 offen offset:3072
 s_add_u32 s44, s44, 4096
 MF 36,232,128
 TR 204,11,49152
 MF 36,220,120
 TR 206,11,51200
 MF 84,224,120
 ds_read_b128 a[208:211], v9 offset:576
 buffer_load_dwordx4 v[112:115], v6, s[36:39], s44 offen offset:0
 MF 84,236,128
 MF 84,248,136
 MF 88,248,140
 buffer_load_dwordx4 v[116:119], v6, s[36:39], s44 offen offset:1024
 MF 88,236,132
 MF 88,224,124
 s_waitcnt vmcnt(8) lgkmcnt(0)
 s_barrier
 MF 32,176,144
 TR 216,10,53248
 TR 218,10,55296
 MF 32,188,152
 TR 220,11,53248
 buffer_load_dwordx4 v[120:123], v6, s[36:39], s44 offen offset:2048
 MF 32,200,160
 TR 222,11,55296
 MF 48,200,164
 ds_read_b128 a[224:227], v9 offset:704
 MF 48,188,156
 TR 228,10,57344
 buffer_load_dwordx4 v[124:127], v6, s[36:39], s44 offen offset:3072
 s_add_u32 s44, s44, 4096
 MF 48,176,148
 TR 230,10,59392
 MF 52,180,148
 TR 232,11,57344
 TR 234,11,59392
 MF 52,192,156
 ds_read_b128 a[236:239], v9 offset:832
 buffer_load_dwordx4 v[128:131], v6, s[36:39], s44 offen offset:0
 MF 52,204,164
 TR 240,10,61440
 MF 36,204,160
 TR 242,10,63488
 buffer_load_dwordx4 v[132:135], v6, s[36:39], s44 offen offset:1024
 MF 36,192,152
 TR 244,11,61440
 MF 36,180,144
 TR 246,11,63488
 MF 84,184,144
 ds_read_b128 a[248:251], v9 offset:960
 buffer_load_dwordx4 v[136:139], v6, s[36:39], s44 offen offset:2048
 MF 84,196,152
 MF 84,208,160
 MF 88,208,164
 buffer_load_dwordx4 v[140:143], v6, s[36:39], s44 offen offset:3072
 s_add_u32 s44, s44, 4096
 MF 88,196,156
 MF 88,184,148
 s_waitcnt vmcnt(8) lgkmcnt(0)
 s_barrier
 MF 32,216,168
 TR 176,14,0
 TR 178,14,2048
 v_mfma_f32_16x16x32_bf16 v[32:35], a[228:231], v[96:99], v[32:35]
 TR 180,15,0
 buffer_load_dwordx4 v[144:147], v6, s[36:39], s44 offen offset:0
 v_mfma_f32_16x16x32_bf16 v[32:35], a[240:243], v[104:107], v[32:35]
 TR 182,15,2048
 v_mfma_f32_16x16x32_bf16 v[48:51], a[240:243], v[108:111], v[48:51]
 ds_read_b128 a[184:187], v9 offset:1088
 v_mfma_f32_16x16x32_bf16 v[48:51], a[228:231], v[100:103], v[48:51]
 TR 188,14,4096
 buffer_load_dwordx4 v[148:151], v6, s[36:39], s44 offen offset:1024
 MF 48,216,172
 TR 190,14,6144
 MF 52,220,172
 TR 192,15,4096
 TR 194,15,6144
 v_mfma_f32_16x16x32_bf16 v[52:55], a[232:235], v[100:103], v[52:55]
 ds_read_b128 a[196:199], v9 offset:1216
 buffer_load_dwordx4 v[152:155], v6, s[36:39], s44 offen offset:2048
 v_mfma_f32_16x16x32_bf16 v[52:55], a[244:247], v[108:111], v[52:55]
 TR 200,14,8192
 v_mfma_f32_16x16x32_bf16 v[36:39], a[244:247], v[104:107], v[36:39]
 TR 202,14,10240
 buffer_load_dwordx4 v[156:159], v6, s[36:39], s44 offen offset:3072
 s_add_u32 s44, s44, 4096
 v_mfma_f32_16x16x32_bf16 v[36:39], a[232:235], v[96:99], v[36:39]
 TR 204,15,8192
 MF 36,220,168
 TR 206,15,10240
 MF 84,224,168
 ds_read_b128 a[208:211], v9 offset:1344
 buffer_load_dwordx4 v[160:163], v6, s[36:39], s44 offen offset:0
 v_mfma_f32_16x16x32_bf16 v[84:87], a[236:239], v[96:99], v[84:87]
 v_mfma_f32_16x16x32_bf16 v[84:87], a[248:251], v[104:107], v[84:87]
 v_mfma_f32_16x16x32_bf16 v[88:91], a[248:251], v[108:111], v[88:91]
 buffer_load_dwordx4 v[164:167], v6, s[36:39], s44 offen offset:1024
 v_mfma_f32_16x16x32_bf16 v[88:91], a[236:239], v[100:103], v[88:91]
 MF 88,224,172
 s_waitcnt vmcnt(8) lgkmcnt(0)
 s_barrier
 v_mfma_f32_16x16x32_bf16 v[32:35], a[176:179], v[112:115], v[32:35]
 TR 216,14,12288
 TR 218,14,14336
 buffer_load_dwordx4 v[168:171], v6, s[36:39], s44 offen offset:2048
 v_mfma_f32_16x16x32_bf16 v[32:35], a[188:191], v[120:123], v[32:35]
 TR 220,15,12288
 v_mfma_f32_16x16x32_bf16 v[32:35], a[200:203], v[128:131], v[32:35]
 TR 222,15,14336
 buffer_load_dwordx4 v[172:175], v6, s[36:39], s44 offen offset:3072
 s_add_u32 s44, s44, 4096
 v_mfma_f32_16x16x32_bf16 v[48:51], a[200:203], v[132:135], v[48:51]
 ds_read_b128 a[224:227], v9 offset:1472
 s_lshr_b32 s12, s7, 1
 s_mul_i32 s46, s7, 7168
 s_cmp_eq_u32 s12, 1
 s_cselect_b32 s40, s26, s24
 s_cselect_b32 s41, s27, s25
 s_mov_b32 s42, 7340032
 s_mov_b32 s45, 0
 v_mfma_f32_16x16x32_bf16 v[48:51], a[188:191], v[124:127], v[48:51]
 TR 228,14,16384
 v_mfma_f32_16x16x32_bf16 v[48:51], a[176:179], v[116:119], v[48:51]
 TR 230,14,18432
 s_and_b32 s67, s3, 1
 s_lshl_b32 s67, s67, 2
 s_and_b32 s69, s4, 3
 v_mfma_f32_16x16x32_bf16 v[52:55], a[180:183], v[116:119], v[52:55]
 TR 232,15,16384
 TR 234,15,18432
 s_add_u32 s67, s67, s69
 s_lshr_b32 s68, s3, 1
 s_lshl_b32 s68, s68, 3
 v_mfma_f32_16x16x32_bf16 v[52:55], a[192:195], v[124:127], v[52:55]
 ds_read_b128 a[236:239], v9 offset:1600
 v_mfma_f32_16x16x32_bf16 v[52:55], a[204:207], v[132:135], v[52:55]
 TR 240,14,20480
 s_lshr_b32 s69, s4, 2
 s_add_u32 s68, s68, s69
 s_lshl_b32 s67, s67, 4
 v_mfma_f32_16x16x32_bf16 v[36:39], a[204:207], v[128:131], v[36:39]
 TR 242,14,22528
 v_mfma_f32_16x16x32_bf16 v[36:39], a[192:195], v[120:123], v[36:39]
 TR 244,15,20480
 s_lshl_b32 s69, s7, 2
 s_add_u32 s67, s67, s69
 v_lshlrev_b32 v224, 4, v1
 v_mfma_f32_16x16x32_bf16 v[36:39], a[180:183], v[112:115], v[36:39]
 TR 246,15,22528
 v_lshlrev_b32 v236, 2, v3
 v_and_b32 v240, 1, v4
 v_lshl_add_u32 v240, v240, 7, v236
 v_mfma_f32_16x16x32_bf16 v[84:87], a[184:187], v[112:115], v[84:87]
 ds_read_b128 a[248:251], v9 offset:1728
 v_mfma_f32_16x16x32_bf16 v[84:87], a[196:199], v[120:123], v[84:87]
 s_lshl_b32 s77, s67, 6
 s_add_u32 s77, s77, 8192
 s_lshl_b32 s69, s67, 15
 v_mfma_f32_16x16x32_bf16 v[84:87], a[208:211], v[128:131], v[84:87]
 v_add_u32 v237, s69, v224
 s_mov_b32 s44, 0
 s_mov_b32 s36, s52
 v_mfma_f32_16x16x32_bf16 v[88:91], a[208:211], v[132:135], v[88:91]
 v_mfma_f32_16x16x32_bf16 v[88:91], a[196:199], v[124:127], v[88:91]
 s_mov_b32 s37, s53
 v_mfma_f32_16x16x32_bf16 v[88:91], a[184:187], v[116:119], v[88:91]
 s_waitcnt vmcnt(4) lgkmcnt(0)
 s_barrier
 v_mfma_f32_16x16x32_bf16 v[32:35], a[216:219], v[136:139], v[32:35]
 TR 176,14,24576
 v_mfma_f32_16x16x32_bf16 v[32:35], a[228:231], v[144:147], v[32:35]
 TR 178,14,26624
 v_mfma_f32_16x16x32_bf16 v[32:35], a[240:243], v[152:155], v[32:35]
 TR 180,15,24576
 v_mfma_f32_16x16x32_bf16 v[48:51], a[240:243], v[156:159], v[48:51]
 TR 182,15,26624
 v_mfma_f32_16x16x32_bf16 v[48:51], a[228:231], v[148:151], v[48:51]
 ds_read_b128 a[184:187], v9 offset:1856
 v_mfma_f32_16x16x32_bf16 v[48:51], a[216:219], v[140:143], v[48:51]
 TR 188,14,28672
 v_mfma_f32_16x16x32_bf16 v[52:55], a[220:223], v[140:143], v[52:55]
 TR 190,14,30720
 v_mfma_f32_16x16x32_bf16 v[52:55], a[232:235], v[148:151], v[52:55]
 TR 192,15,28672
 v_mfma_f32_16x16x32_bf16 v[52:55], a[244:247], v[156:159], v[52:55]
 TR 194,15,30720
 v_mfma_f32_16x16x32_bf16 v[36:39], a[244:247], v[152:155], v[36:39]
 ds_read_b128 a[196:199], v9 offset:1984
 v_mfma_f32_16x16x32_bf16 v[36:39], a[232:235], v[144:147], v[36:39]
 v_mfma_f32_16x16x32_bf16 v[36:39], a[220:223], v[136:139], v[36:39]
 v_mfma_f32_16x16x32_bf16 v[84:87], a[224:227], v[136:139], v[84:87]
 v_mfma_f32_16x16x32_bf16 v[84:87], a[236:239], v[144:147], v[84:87]
 v_mfma_f32_16x16x32_bf16 v[84:87], a[248:251], v[152:155], v[84:87]
 v_mfma_f32_16x16x32_bf16 v[88:91], a[248:251], v[156:159], v[88:91]
 v_mfma_f32_16x16x32_bf16 v[88:91], a[236:239], v[148:151], v[88:91]
 v_mfma_f32_16x16x32_bf16 v[88:91], a[224:227], v[140:143], v[88:91]
 s_waitcnt vmcnt(0) lgkmcnt(0)
 s_barrier
 v_mfma_f32_16x16x32_bf16 v[32:35], a[176:179], v[160:163], v[32:35]
 TR 216,16,32768
 TR 218,16,34816
 TR 220,17,32768
 v_mfma_f32_16x16x32_bf16 v[32:35], a[188:191], v[168:171], v[32:35]
 TR 222,17,34816
 TR 224,16,36864
 v_mfma_f32_16x16x32_bf16 v[48:51], a[188:191], v[172:175], v[48:51]
 TR 226,16,38912
 TR 228,17,36864
 v_mfma_f32_16x16x32_bf16 v[48:51], a[176:179], v[164:167], v[48:51]
 TR 230,17,38912
 TR 232,16,40960
 TR 234,16,43008
 v_mfma_f32_16x16x32_bf16 v[52:55], a[180:183], v[164:167], v[52:55]
 TR 236,17,40960
 TR 238,17,43008
 v_mfma_f32_16x16x32_bf16 v[52:55], a[192:195], v[172:175], v[52:55]
 TR 240,16,45056
 TR 242,16,47104
 v_mfma_f32_16x16x32_bf16 v[36:39], a[192:195], v[168:171], v[36:39]
 TR 244,17,45056
 TR 246,17,47104
 v_mfma_f32_16x16x32_bf16 v[36:39], a[180:183], v[160:163], v[36:39]
 v_mfma_f32_16x16x32_bf16 v[84:87], a[184:187], v[160:163], v[84:87]
 v_mfma_f32_16x16x32_bf16 v[84:87], a[196:199], v[168:171], v[84:87]
 v_mfma_f32_16x16x32_bf16 v[88:91], a[196:199], v[172:175], v[88:91]
 v_mfma_f32_16x16x32_bf16 v[88:91], a[184:187], v[164:167], v[88:91]
 s_waitcnt lgkmcnt(0)
 s_barrier
 MF 40,216,0
 TR 176,12,0
 TR 178,12,2048
 MF 40,224,8
 TR 180,13,0
 MF 40,232,16
 TR 182,13,2048
 TR 184,12,4096
 MF 40,240,24
 TR 186,12,6144
 v_add_f32 v24, v84, v85
 v_add_f32 v26, v88, v89
 v_pk_add_f32 v[32:33], v[32:33], v[24:25] op_sel_hi:[1,0] neg_lo:[0,1] neg_hi:[0,1]
 v_pk_add_f32 v[34:35], v[34:35], v[24:25] op_sel_hi:[1,0] neg_lo:[0,1] neg_hi:[0,1]
 v_pk_add_f32 v[36:37], v[36:37], v[24:25] op_sel_hi:[1,0] neg_lo:[0,1] neg_hi:[0,1]
 v_pk_add_f32 v[38:39], v[38:39], v[24:25] op_sel_hi:[1,0] neg_lo:[0,1] neg_hi:[0,1]
 v_pk_add_f32 v[48:49], v[48:49], v[26:27] op_sel_hi:[1,0] neg_lo:[0,1] neg_hi:[0,1]
 v_pk_add_f32 v[50:51], v[50:51], v[26:27] op_sel_hi:[1,0] neg_lo:[0,1] neg_hi:[0,1]
 v_pk_add_f32 v[52:53], v[52:53], v[26:27] op_sel_hi:[1,0] neg_lo:[0,1] neg_hi:[0,1]
 v_pk_add_f32 v[54:55], v[54:55], v[26:27] op_sel_hi:[1,0] neg_lo:[0,1] neg_hi:[0,1]
 s_nop 1
 MF 56,240,28
 TR 188,13,4096
 TR 190,13,6144
 v_cvt_pk_bf16_f32 v64, v32, v33
 MF 56,232,20
 TR 192,12,8192
 v_cvt_pk_bf16_f32 v65, v34, v35
 v_cvt_pk_bf16_f32 v66, v36, v37
 MF 56,224,12
 TR 194,12,10240
 TR 196,13,8192
 v_cvt_pk_bf16_f32 v67, v38, v39
 MF 56,216,4
 TR 198,13,10240
 buffer_store_dwordx4 v[64:67], v5, s[52:55], s64 offen offset:0 sc0 sc1
 MF 60,220,4
 TR 200,12,12288
 TR 202,12,14336
 v_cvt_pk_bf16_f32 v72, v48, v49
 MF 60,228,12
 TR 204,13,12288
 v_cvt_pk_bf16_f32 v73, v50, v51
 v_cvt_pk_bf16_f32 v74, v52, v53
 MF 60,236,20
 TR 206,13,14336
 v_cvt_pk_bf16_f32 v75, v54, v55
 MF 60,244,28
 buffer_store_dwordx4 v[72:75], v5, s[52:55], s64 offen offset:1024 sc0 sc1
 s_add_u32 s64, s64, 65536
 v_dot2_f32_bf16 v28, v64, v64, 0
 MF 44,244,24
 v_dot2_f32_bf16 v28, v65, v65, v28
 v_dot2_f32_bf16 v28, v66, v66, v28
 v_dot2_f32_bf16 v28, v67, v67, v28
 MF 44,236,16
 v_dot2_f32_bf16 v29, v72, v72, 0
 v_dot2_f32_bf16 v29, v73, v73, v29
 v_dot2_f32_bf16 v29, v74, v74, v29
 MF 44,228,8
 v_dot2_f32_bf16 v29, v75, v75, v29
 MF 44,220,0
 s_waitcnt lgkmcnt(0)
 s_barrier
 MF 40,176,32
 TR 216,12,16384
 TR 218,12,18432
 MF 40,184,40
 TR 220,13,16384
 s_add_u32 m0, s46, 131072
 s_add_u32 s45, s45, 0x0
 WL 225,0
 MF 40,192,48
 TR 222,13,18432
 TR 224,12,20480
 MF 40,200,56
 TR 226,12,22528
 WL 226,1024
 MF 56,200,60
 TR 228,13,20480
 TR 230,13,22528
 MF 56,192,52
 TR 232,16,49152
 MF 56,184,44
 TR 234,16,51200
 TR 236,17,49152
 WL 227,2048
 MF 56,176,36
 TR 238,17,51200
 MF 60,180,36
 TR 240,16,53248
 TR 242,16,55296
 WL 228,3072
 s_add_u32 m0, s46, 135168
 MF 60,188,44
 TR 244,17,53248
 MF 60,196,52
 TR 246,17,55296
 MF 60,204,60
 WL 229,0
 MF 44,204,56
 MF 44,196,48
 WL 230,1024
 MF 44,188,40
 MF 44,180,32
 s_waitcnt lgkmcnt(0)
 s_barrier
 MF 40,216,64
 TR 176,16,57344
 TR 178,16,59392
 MF 40,224,72
 TR 180,17,57344
 MF 40,232,80
 TR 182,17,59392
 TR 184,16,61440
 MF 40,240,88
 TR 186,16,63488
 MF 56,240,92
 TR 188,17,61440
 TR 190,17,63488
 MF 56,232,84
 TR 192,12,24576
 MF 56,224,76
 TR 194,12,26624
 TR 196,13,24576
 MF 56,216,68
 TR 198,13,26624
 WL 231,2048
 MF 60,220,68
 TR 200,12,28672
 TR 202,12,30720
 MF 60,228,76
 TR 204,13,28672
 MF 60,236,84
 TR 206,13,30720
 MF 60,244,92
 MF 44,244,88
 MF 44,236,80
 MF 44,228,72
 MF 44,220,64
 s_waitcnt lgkmcnt(0)
 s_barrier
 MF 40,176,96
 TR 216,12,32768
 TR 218,12,34816
 MF 40,184,104
 TR 220,13,32768
 s_add_u32 m0, s46, 98304
 s_add_u32 s45, s45, 0xe0000
 WL 225,0
 MF 40,192,112
 TR 222,13,34816
 TR 224,12,36864
 MF 40,200,120
 TR 226,12,38912
 WL 226,1024
 MF 56,200,124
 TR 228,13,36864
 TR 230,13,38912
 MF 56,192,116
 TR 232,12,40960
 MF 56,184,108
 TR 234,12,43008
 TR 236,13,40960
 WL 227,2048
 MF 56,176,100
 TR 238,13,43008
 MF 60,180,100
 TR 240,12,45056
 TR 242,12,47104
 WL 228,3072
 s_add_u32 m0, s46, 102400
 MF 60,188,108
 TR 244,13,45056
 MF 60,196,116
 TR 246,13,47104
 MF 60,204,124
 WL 229,0
 MF 44,204,120
 MF 44,196,112
 WL 230,1024
 MF 44,188,104
 MF 44,180,96
 s_waitcnt vmcnt(13)
 v_add_u32 v31, 1, v31
 buffer_store_dword v31, v30, s[60:63], s65 offen sc0 sc1
 s_waitcnt lgkmcnt(0)
 s_barrier
 MF 40,216,128
 TR 176,12,49152
 TR 178,12,51200
 MF 40,224,136
 TR 180,13,49152
 WL 231,2048
 MF 40,232,144
 TR 182,13,51200
 TR 184,12,53248
 MF 40,240,152
 TR 186,12,55296
 s_add_u32 m0, s46, 0
 s_add_u32 s45, s45, 0xe0000
 WL 225,0
 MF 56,240,156
 TR 188,13,53248
 TR 190,13,55296
 MF 56,232,148
 TR 192,12,57344
 MF 56,224,140
 TR 194,12,59392
 TR 196,13,57344
 WL 226,1024
 MF 56,216,132
 TR 198,13,59392
 MF 60,220,132
 TR 200,12,61440
 TR 202,12,63488
 WL 227,2048
 MF 60,228,140
 TR 204,13,61440
 MF 60,236,148
 TR 206,13,63488
 MF 60,244,156
 WL 228,3072
 s_add_u32 m0, s46, 4096
 MF 44,244,152
 MF 44,236,144
 WL 229,0
 MF 44,228,136
 MF 44,220,128
 s_waitcnt lgkmcnt(0)
 s_barrier
 MF 40,176,160
 TR 216,16,0
 TR 218,16,2048
 MF 40,184,168
 TR 220,17,0
 WL 230,1024
 v_mfma_f32_16x16x32_bf16 v[40:43], a[192:195], v[96:99], v[40:43]
 TR 222,17,2048
 s_branch L_sequential_preLN__sliding_local_dilated__geglu_ffn__prompt_kernel_pg7_skip
.p2align 12
L_sequential_preLN__sliding_local_dilated__geglu_ffn__prompt_kernel_pg7:
 s_branch L_sequential_preLN__sliding_local_dilated__geglu_ffn__prompt_kernel_hop0_ret
L_sequential_preLN__sliding_local_dilated__geglu_ffn__prompt_kernel_pg7b:
 s_branch L_sequential_preLN__sliding_local_dilated__geglu_ffn__prompt_kernel_sp_ret
L_sequential_preLN__sliding_local_dilated__geglu_ffn__prompt_kernel_pg7_skip:
 TR 224,16,4096
 v_mfma_f32_16x16x32_bf16 v[40:43], a[200:203], v[104:107], v[40:43]
 TR 226,16,6144
 WL 231,2048
 v_mfma_f32_16x16x32_bf16 v[56:59], a[200:203], v[108:111], v[56:59]
 TR 228,17,4096
 TR 230,17,6144
 v_mfma_f32_16x16x32_bf16 v[56:59], a[192:195], v[100:103], v[56:59]
 TR 232,16,8192
 MF 56,184,172
 TR 234,16,10240
 TR 236,17,8192
 s_add_u32 m0, s46, 28672
 s_add_u32 s45, s45, 0xe0000
 WL 225,0
 MF 56,176,164
 TR 238,17,10240
 MF 60,180,164
 TR 240,16,12288
 TR 242,16,14336
 WL 226,1024
 MF 60,188,172
 TR 244,17,12288
 v_mfma_f32_16x16x32_bf16 v[60:63], a[196:199], v[100:103], v[60:63]
 TR 246,17,14336
 v_mfma_f32_16x16x32_bf16 v[60:63], a[204:207], v[108:111], v[60:63]
 WL 227,2048
 v_mfma_f32_16x16x32_bf16 v[44:47], a[204:207], v[104:107], v[44:47]
 v_mfma_f32_16x16x32_bf16 v[44:47], a[196:199], v[96:99], v[44:47]
 WL 228,3072
 s_add_u32 m0, s46, 32768
 MF 44,188,168
 MF 44,180,160
 s_waitcnt lgkmcnt(0)
 v_mfma_f32_16x16x32_bf16 v[40:43], a[216:219], v[112:115], v[40:43]
 TR 176,16,16384
 TR 178,16,18432
 v_mfma_f32_16x16x32_bf16 v[40:43], a[224:227], v[120:123], v[40:43]
 TR 180,17,16384
 v_mfma_f32_16x16x32_bf16 v[40:43], a[232:235], v[128:131], v[40:43]
 TR 182,17,18432
 TR 184,16,20480
 WL 229,0
 v_mfma_f32_16x16x32_bf16 v[40:43], a[240:243], v[136:139], v[40:43]
 TR 186,16,22528
 v_mfma_f32_16x16x32_bf16 v[56:59], a[240:243], v[140:143], v[56:59]
 TR 188,17,20480
 TR 190,17,22528
 v_mfma_f32_16x16x32_bf16 v[56:59], a[232:235], v[132:135], v[56:59]
 TR 192,16,24576
 v_mfma_f32_16x16x32_bf16 v[56:59], a[224:227], v[124:127], v[56:59]
 TR 194,16,26624
 TR 196,17,24576
 v_mfma_f32_16x16x32_bf16 v[56:59], a[216:219], v[116:119], v[56:59]
 TR 198,17,26624
 WL 230,1024
 v_mfma_f32_16x16x32_bf16 v[60:63], a[220:223], v[116:119], v[60:63]
 TR 200,16,28672
 TR 202,16,30720
 v_mfma_f32_16x16x32_bf16 v[60:63], a[228:231], v[124:127], v[60:63]
 TR 204,17,28672
 v_mfma_f32_16x16x32_bf16 v[60:63], a[236:239], v[132:135], v[60:63]
 TR 206,17,30720
 v_mfma_f32_16x16x32_bf16 v[60:63], a[244:247], v[140:143], v[60:63]
 v_mfma_f32_16x16x32_bf16 v[44:47], a[244:247], v[136:139], v[44:47]
 WL 231,2048
 v_mfma_f32_16x16x32_bf16 v[44:47], a[236:239], v[128:131], v[44:47]
 v_mfma_f32_16x16x32_bf16 v[44:47], a[228:231], v[120:123], v[44:47]
 v_mfma_f32_16x16x32_bf16 v[44:47], a[220:223], v[112:115], v[44:47]
 s_waitcnt lgkmcnt(0)
 v_mfma_f32_16x16x32_bf16 v[40:43], a[176:179], v[144:147], v[40:43]
 v_mfma_f32_16x16x32_bf16 v[40:43], a[184:187], v[152:155], v[40:43]
 v_mfma_f32_16x16x32_bf16 v[40:43], a[192:195], v[160:163], v[40:43]
 v_mfma_f32_16x16x32_bf16 v[40:43], a[200:203], v[168:171], v[40:43]
 v_mfma_f32_16x16x32_bf16 v[56:59], a[200:203], v[172:175], v[56:59]
 v_mfma_f32_16x16x32_bf16 v[56:59], a[192:195], v[164:167], v[56:59]
 v_mfma_f32_16x16x32_bf16 v[56:59], a[184:187], v[156:159], v[56:59]
 v_mfma_f32_16x16x32_bf16 v[56:59], a[176:179], v[148:151], v[56:59]
 buffer_load_dword v241, v240, s[60:63], s77 offen sc0 sc1
 v_mfma_f32_16x16x32_bf16 v[60:63], a[180:183], v[148:151], v[60:63]
 v_mfma_f32_16x16x32_bf16 v[60:63], a[188:191], v[156:159], v[60:63]
 v_mfma_f32_16x16x32_bf16 v[60:63], a[196:199], v[164:167], v[60:63]
 v_mfma_f32_16x16x32_bf16 v[60:63], a[204:207], v[172:175], v[60:63]
 v_mfma_f32_16x16x32_bf16 v[44:47], a[204:207], v[168:171], v[44:47]
 v_mfma_f32_16x16x32_bf16 v[44:47], a[196:199], v[160:163], v[44:47]
 v_mfma_f32_16x16x32_bf16 v[44:47], a[188:191], v[152:155], v[44:47]
 v_mfma_f32_16x16x32_bf16 v[44:47], a[180:183], v[144:147], v[44:47]
 s_barrier
 s_waitcnt vmcnt(0)
 s_cmp_eq_u32 s77, 262144
 s_cbranch_scc1 L_chk3a_ok
 s_add_u32 s71, s96, 1
 s_mov_b32 s47, 0x100000
L_chk3a:
 v_subrev_u32 v242, s71, v241
 v_cmp_lt_u32 vcc, 1, v242
 s_nop 1
 s_cmp_eq_u64 vcc, 0
 s_cbranch_scc1 L_chk3a_go
 s_sub_u32 s47, s47, 1
 s_cbranch_scc1 L_chk3a_go
 buffer_load_dword v241, v240, s[60:63], s77 offen sc0 sc1
 s_waitcnt vmcnt(0)
 s_branch L_chk3a
L_chk3a_go:
 v_cmp_ne_u32 vcc, 1, v242
 s_nop 1
 s_cmp_eq_u64 vcc, 0
 s_cselect_b32 s77, 262144, s77
L_chk3a_ok:
 XL 0,237,0
 XL 4,237,1024
 XL 8,237,2048
 XL 12,237,3072
 s_add_u32 s44, s44, 4096
 XL 16,237,0
 XL 20,237,1024
 XL 24,237,2048
 XL 28,237,3072
 s_add_u32 s44, s44, 4096
 XL 32,237,0
 XL 36,237,1024
 XL 40,237,2048
 XL 44,237,3072
 s_add_u32 s44, s44, 4096
 XL 48,237,0
 XL 52,237,1024
 XL 56,237,2048
 XL 60,237,3072
 s_add_u32 s44, s44, 4096
 v_pk_add_f32 v[40:41], v[40:41], v[24:25] op_sel_hi:[1,0] neg_lo:[0,1] neg_hi:[0,1]
 v_pk_add_f32 v[42:43], v[42:43], v[24:25] op_sel_hi:[1,0] neg_lo:[0,1] neg_hi:[0,1]
 v_pk_add_f32 v[44:45], v[44:45], v[24:25] op_sel_hi:[1,0] neg_lo:[0,1] neg_hi:[0,1]
 v_pk_add_f32 v[46:47], v[46:47], v[24:25] op_sel_hi:[1,0] neg_lo:[0,1] neg_hi:[0,1]
 v_pk_add_f32 v[56:57], v[56:57], v[26:27] op_sel_hi:[1,0] neg_lo:[0,1] neg_hi:[0,1]
 v_pk_add_f32 v[58:59], v[58:59], v[26:27] op_sel_hi:[1,0] neg_lo:[0,1] neg_hi:[0,1]
 v_pk_add_f32 v[60:61], v[60:61], v[26:27] op_sel_hi:[1,0] neg_lo:[0,1] neg_hi:[0,1]
 v_pk_add_f32 v[62:63], v[62:63], v[26:27] op_sel_hi:[1,0] neg_lo:[0,1] neg_hi:[0,1]
 v_cvt_pk_bf16_f32 v68, v40, v41
 v_cvt_pk_bf16_f32 v69, v42, v43
 v_cvt_pk_bf16_f32 v70, v44, v45
 v_cvt_pk_bf16_f32 v71, v46, v47
 buffer_store_dwordx4 v[68:71], v5, s[52:55], s64 offen offset:0 sc0 sc1
 v_cvt_pk_bf16_f32 v76, v56, v57
 v_cvt_pk_bf16_f32 v77, v58, v59
 v_cvt_pk_bf16_f32 v78, v60, v61
 v_cvt_pk_bf16_f32 v79, v62, v63
 buffer_store_dwordx4 v[76:79], v5, s[52:55], s64 offen offset:1024 sc0 sc1
 s_add_u32 s64, s64, 65536
 v_dot2_f32_bf16 v28, v68, v68, v28
 v_dot2_f32_bf16 v28, v69, v69, v28
 v_dot2_f32_bf16 v28, v70, v70, v28
 v_dot2_f32_bf16 v28, v71, v71, v28
 v_dot2_f32_bf16 v29, v76, v76, v29
 v_dot2_f32_bf16 v29, v77, v77, v29
 v_dot2_f32_bf16 v29, v78, v78, v29
 v_dot2_f32_bf16 v29, v79, v79, v29
 v_add_f32 v24, v24, v80
 v_add_f32 v26, v26, v82
 v_mov_b32 v22, v28
 v_mov_b32 v23, v29
 s_nop 0
 v_permlane16_swap_b32 v28, v22
 v_permlane16_swap_b32 v29, v23
 v_add_f32 v28, v28, v22
 v_add_f32 v29, v29, v23
 v_mov_b32 v22, v28
 v_mov_b32 v23, v29
 s_nop 0
 v_permlane32_swap_b32 v28, v22
 v_permlane32_swap_b32 v29, v23
 v_add_f32 v28, v28, v22
 v_add_f32 v29, v29, v23
 v_cmp_gt_u32 vcc, 16, v1
 v_lshlrev_b32 v22, 2, v1
 s_lshl_b32 s9, s8, 10
 s_lshl_b32 s10, s6, 7
 s_add_u32 s9, s9, s10
 v_cndmask_b32 v28, v29, v28, vcc
 v_cndmask_b32 v24, v26, v24, vcc
 s_cmp_lg_u32 s6, 0
 s_cselect_b32 s50, 0, 8192
 s_mov_b32 exec_hi, 0
 buffer_store_dword v28, v22, s[56:59], s9 offen sc0 sc1
 buffer_store_dword v24, v22, s[48:51], s11 offen sc0 sc1
 s_mov_b64 exec, -1
 s_and_b32 s5, s3, 1
 s_lshl_b32 s5, s5, 2
 s_and_b32 s9, s4, 3
 s_add_u32 s5, s5, s9
 s_lshr_b32 s6, s3, 1
 s_lshl_b32 s6, s6, 3
 s_lshr_b32 s9, s4, 2
 s_add_u32 s6, s6, s9
 s_mov_b32 s10, s15
 s_mov_b32 s8, s67
 v_lshrrev_b32 v8, 2, v3
 v_and_b32 v9, 3, v3
 v_lshl_add_u32 v8, v4, 2, v8
 v_mul_u32_u24 v8, 224, v8
 v_lshl_add_u32 v232, v9, 3, v8
 v_add_u32 v233, 98304, v232
 v_lshlrev_b32 v234, 7, v1
 v_mov_b32 v8, 0x7fffffff
 s_lshr_b32 s69, s4, 3
 s_lshl_b32 s69, s69, 2
 s_and_b32 s68, s4, 3
 s_add_u32 s69, s69, s68
 s_lshl_b32 s69, s69, 3
 s_add_u32 s69, s69, s3
 s_add_u32 s68, s6, 1
 s_bitcmp1_b32 s68, 1
 s_cselect_b32 s68, 0, 32
 v_cmp_gt_u32 vcc, s68, v1
 v_cmp_gt_u32 vcc, 16, v1
 v_lshrrev_b32 v9, 5, v1
 v_and_b32 v235, 31, v1
 v_lshlrev_b32 v235, 2, v235
 v_lshl_add_u32 v235, v9, 11, v235
 v_cndmask_b32 v234, v8, v234, vcc
 s_lshl_b32 s9, s8, 10
 s_lshl_b32 s12, s2, 2
 s_add_u32 s12, s12, s7
 s_lshr_b32 s13, s12, 6
 s_mul_i32 s13, s13, 7
 s_add_u32 s76, s13, 3
 s_bfe_u32 s11, s12, 0x10005
 s_lshl_b32 s11, s11, 2
 s_add_u32 s13, s13, s11
 s_and_b32 s12, s12, 31
 s_lshl_b32 s12, s12, 11
 s_lshl_b32 s13, s13, 16
 s_lshl_b32 s76, s76, 16
 s_add_u32 s76, s76, s12
 s_add_u32 s12, s12, s13
 s_lshl_b32 s11, s11, 30
 s_add_u32 s76, s76, s11
 v_lshlrev_b32 v238, 7, v1
 s_min_u32 s68, s68, 7
 v_cmp_gt_u32 vcc, s68, v1
 s_lshl_b32 s11, s69, 1
 s_and_b32 s13, s7, 1
 s_add_u32 s11, s11, s13
 s_mul_i32 s11, s11, 896
 v_cndmask_b32 v238, v8, v238, vcc
 s_add_u32 s11, s11, 229376
 s_lshr_b32 s79, s28, 7
 s_sub_u32 s79, 3, s79
 s_and_b32 s79, s79, 7
 s_lshl_b32 s79, s79, 7
 s_lshr_b32 s13, s3, 2
 s_mul_i32 s13, s13, 3670016
 s_add_u32 s79, s79, s13
 s_lshl_b32 s13, s4, 2
 s_add_u32 s13, s13, s7
 s_mul_i32 s13, s13, 28672
 s_add_u32 s79, s79, s13
 v_lshlrev_b32 v244, 10, v1
 v_cmp_gt_u32 vcc, 28, v1
 s_nop 1
 v_cndmask_b32 v244, v8, v244, vcc
 s_waitcnt vmcnt(43)
 s_barrier
 TR 128,233,32768
 TR 130,233,36352
 TR 132,233,39936
 TR 134,233,43520
 TR 136,233,32800
 TR 138,233,36384
 TR 140,233,39968
 TR 142,233,43552
 TR 144,233,32832
 TR 146,233,36416
 TR 148,233,40000
 TR 150,233,43584
 TR 152,233,32864
 TR 154,233,36448
 TR 156,233,40032
 TR 158,233,43616
 TR 160,233,32896
 TR 162,233,36480
 TR 164,233,40064
 TR 166,233,43648
 TR 168,233,32928
 TR 170,233,36512
 TR 172,233,40096
 TR 174,233,43680
 TR 176,233,32960
 TR 178,233,36544
 TR 180,233,40128
 TR 182,233,43712
 s_cmp_eq_u32 s7, 0
 s_cbranch_scc1 L_sequential_preLN__sliding_local_dilated__geglu_ffn__prompt_kernel_hop5_e0
 s_cmp_eq_u32 s7, 1
 s_cbranch_scc1 L_sequential_preLN__sliding_local_dilated__geglu_ffn__prompt_kernel_hop5_e1
 s_cmp_eq_u32 s7, 2
 s_cbranch_scc1 L_sequential_preLN__sliding_local_dilated__geglu_ffn__prompt_kernel_hop5_e2
 s_branch L_sequential_preLN__sliding_local_dilated__geglu_ffn__prompt_kernel_hop5_e3
L_sequential_preLN__sliding_local_dilated__geglu_ffn__prompt_kernel_hop5_ret:
 v_mov_b32 v246, v31
 v_mov_b32 v247, 0
 s_add_u32 s48, s34, 12582912
 s_addc_u32 s49, s35, 0
 s_mov_b32 s50, 131072
 s_mov_b32 s51, 0x00020000
 s_mov_b32 s52, s28
 s_mov_b32 s53, s29
 s_mov_b32 s54, 7340032
 s_mov_b32 s55, 0x00020000
 s_add_u32 s56, s34, 16777216
 s_addc_u32 s57, s35, 0
 s_mov_b32 s58, 25165824
 s_mov_b32 s59, 0x00020000
 s_waitcnt vmcnt(12) lgkmcnt(0)
 v_mfma_f32_16x16x32_bf16 v[0:3], a[128:131], a[0:3], 0
 TR 184,233,47104
 TR 186,233,50688
 MF 0,132,16
 XL 64,237,0
 v_mfma_f32_16x16x32_bf16 v[4:7], a[140:143], a[16:19], 0
 TR 188,233,54272
 MF 4,136,0
 v_mfma_f32_16x16x32_bf16 v[8:11], a[144:147], a[0:3], 0
 TR 190,233,57856
 MF 8,148,16
 XL 68,237,1024
 v_mfma_f32_16x16x32_bf16 v[12:15], a[156:159], a[16:19], 0
 TR 192,233,47136
 MF 12,152,0
 v_mfma_f32_16x16x32_bf16 v[16:19], a[160:163], a[0:3], 0
 TR 194,233,50720
 MF 16,164,16
 XL 72,237,2048
 v_mfma_f32_16x16x32_bf16 v[20:23], a[172:175], a[16:19], 0
 TR 196,233,54304
 MF 20,168,0
 v_mfma_f32_16x16x32_bf16 v[24:27], a[176:179], a[0:3], 0
 TR 198,233,57888
 MF 24,180,16
 XL 76,237,3072
 s_add_u32 s44, s44, 4096
 v_mfma_f32_16x16x32_bf16 v[80:83], a[180:183], a[20:23], 0
 TR 200,233,47168
 MF 80,176,4
 v_mfma_f32_16x16x32_bf16 v[76:79], a[168:171], a[4:7], 0
 TR 202,233,50752
 TR 204,233,54336
 MF 76,172,20
 XL 80,237,0
 v_mfma_f32_16x16x32_bf16 v[72:75], a[164:167], a[20:23], 0
 TR 206,233,57920
 MF 72,160,4
 v_mfma_f32_16x16x32_bf16 v[68:71], a[152:155], a[4:7], 0
 TR 208,233,47200
 MF 68,156,20
 XL 84,237,1024
 v_mfma_f32_16x16x32_bf16 v[64:67], a[148:151], a[20:23], 0
 TR 210,233,50784
 MF 64,144,4
 v_mfma_f32_16x16x32_bf16 v[60:63], a[136:139], a[4:7], 0
 TR 212,233,54368
 MF 60,140,20
 XL 88,237,2048
 v_mfma_f32_16x16x32_bf16 v[56:59], a[132:135], a[20:23], 0
 TR 214,233,57952
 MF 56,128,4
 v_mfma_f32_16x16x32_bf16 v[112:115], a[128:131], a[8:11], 0
 TR 216,233,47232
 MF 112,132,24
 XL 92,237,3072
 s_add_u32 s44, s44, 4096
 v_mfma_f32_16x16x32_bf16 v[116:119], a[140:143], a[24:27], 0
 TR 218,233,50816
 MF 116,136,8
 XL 96,237,0
 v_mfma_f32_16x16x32_bf16 v[120:123], a[144:147], a[8:11], 0
 TR 220,233,54400
 TR 222,233,57984
 MF 120,148,24
 v_mfma_f32_16x16x32_bf16 v[124:127], a[156:159], a[24:27], 0
 TR 224,233,47264
 MF 124,152,8
 XL 100,237,1024
 v_mfma_f32_16x16x32_bf16 v[128:131], a[160:163], a[8:11], 0
 TR 226,233,50848
 MF 128,164,24
 v_mfma_f32_16x16x32_bf16 v[132:135], a[172:175], a[24:27], 0
 TR 228,233,54432
 MF 132,168,8
 XL 104,237,2048
 v_mfma_f32_16x16x32_bf16 v[136:139], a[176:179], a[8:11], 0
 TR 230,233,58016
 MF 136,180,24
 v_mfma_f32_16x16x32_bf16 v[192:195], a[180:183], a[28:31], 0
 TR 232,233,47296
 MF 192,176,12
 XL 108,237,3072
 s_add_u32 s44, s44, 4096
 v_mfma_f32_16x16x32_bf16 v[188:191], a[168:171], a[12:15], 0
 TR 234,233,50880
 MF 188,172,28
 v_mfma_f32_16x16x32_bf16 v[184:187], a[164:167], a[28:31], 0
 TR 236,233,54464
 MF 184,160,12
 XL 112,237,0
 v_mfma_f32_16x16x32_bf16 v[180:183], a[152:155], a[12:15], 0
 TR 238,233,58048
 MF 180,156,28
 v_mfma_f32_16x16x32_bf16 v[176:179], a[148:151], a[28:31], 0
 MF 176,144,12
 XL 116,237,1024
 v_mfma_f32_16x16x32_bf16 v[172:175], a[136:139], a[12:15], 0
 MF 172,140,28
 v_mfma_f32_16x16x32_bf16 v[168:171], a[132:135], a[28:31], 0
 MF 168,128,12
 XL 120,237,2048
 s_waitcnt vmcnt(15)
 v_add_u32 v246, 1, v246
 buffer_store_dword v246, v247, s[60:63], s65 offen sc0 sc1
 s_waitcnt vmcnt(51) lgkmcnt(0)
 s_barrier
 v_mfma_f32_16x16x32_bf16 v[28:31], a[184:187], a[0:3], 0
 TR 128,233,0
 TR 130,233,3584
 MF 28,188,16
 v_mfma_f32_16x16x32_bf16 v[32:35], a[196:199], a[16:19], 0
 TR 132,233,7168
 MF 32,192,0
 XL 124,237,3072
 s_add_u32 s44, s44, 4096
 v_mfma_f32_16x16x32_bf16 v[36:39], a[200:203], a[0:3], 0
 TR 134,233,10752
 MF 36,204,16
 v_mfma_f32_16x16x32_bf16 v[40:43], a[212:215], a[16:19], 0
 TR 136,233,32
 MF 40,208,0
 v_mfma_f32_16x16x32_bf16 v[44:47], a[216:219], a[0:3], 0
 TR 138,233,3616
 MF 44,220,16
 v_mfma_f32_16x16x32_bf16 v[48:51], a[228:231], a[16:19], 0
 TR 140,233,7200
 MF 48,224,0
 s_add_u32 m0, s46, 131072
 s_add_u32 s45, s45, 0xe0000
 WL 225,0
 v_mfma_f32_16x16x32_bf16 v[52:55], a[232:235], a[0:3], 0
 TR 142,233,10784
 MF 52,236,16
 v_mfma_f32_16x16x32_bf16 v[108:111], a[236:239], a[20:23], 0
 TR 144,233,64
 MF 108,232,4
 v_mfma_f32_16x16x32_bf16 v[104:107], a[224:227], a[4:7], 0
 TR 146,233,3648
 TR 148,233,7232
 MF 104,228,20
 WL 226,1024
 v_mfma_f32_16x16x32_bf16 v[100:103], a[220:223], a[20:23], 0
 TR 150,233,10816
 MF 100,216,4
 v_mfma_f32_16x16x32_bf16 v[96:99], a[208:211], a[4:7], 0
 TR 152,233,96
 MF 96,212,20
 v_mfma_f32_16x16x32_bf16 v[92:95], a[204:207], a[20:23], 0
 TR 154,233,3680
 MF 92,200,4
 v_mfma_f32_16x16x32_bf16 v[88:91], a[192:195], a[4:7], 0
 TR 156,233,7264
 MF 88,196,20
 WL 227,2048
 v_mfma_f32_16x16x32_bf16 v[84:87], a[188:191], a[20:23], 0
 TR 158,233,10848
 MF 84,184,4
 v_mfma_f32_16x16x32_bf16 v[140:143], a[184:187], a[8:11], 0
 TR 160,233,128
 MF 140,188,24
 v_mfma_f32_16x16x32_bf16 v[144:147], a[196:199], a[24:27], 0
 TR 162,233,3712
 MF 144,192,8
 WL 228,3072
 s_add_u32 m0, s46, 135168
 v_mfma_f32_16x16x32_bf16 v[148:151], a[200:203], a[8:11], 0
 TR 164,233,7296
 TR 166,233,10880
 MF 148,204,24
 v_mfma_f32_16x16x32_bf16 v[152:155], a[212:215], a[24:27], 0
 TR 168,233,160
 MF 152,208,8
 v_mfma_f32_16x16x32_bf16 v[156:159], a[216:219], a[8:11], 0
 TR 170,233,3744
 MF 156,220,24
 v_mfma_f32_16x16x32_bf16 v[160:163], a[228:231], a[24:27], 0
 TR 172,233,7328
 MF 160,224,8
 WL 229,0
 v_mfma_f32_16x16x32_bf16 v[164:167], a[232:235], a[8:11], 0
 TR 174,233,10912
 MF 164,236,24
 v_mfma_f32_16x16x32_bf16 v[220:223], a[236:239], a[28:31], 0
 TR 176,233,192
 MF 220,232,12
 v_mfma_f32_16x16x32_bf16 v[216:219], a[224:227], a[12:15], 0
 TR 178,233,3776
 MF 216,228,28
 WL 230,1024
 v_mfma_f32_16x16x32_bf16 v[212:215], a[220:223], a[28:31], 0
 TR 180,233,7360
 MF 212,216,12
 v_mfma_f32_16x16x32_bf16 v[208:211], a[208:211], a[12:15], 0
 TR 182,233,10944
 MF 208,212,28
 v_mfma_f32_16x16x32_bf16 v[204:207], a[204:207], a[28:31], 0
 MF 204,200,12
 v_mfma_f32_16x16x32_bf16 v[200:203], a[192:195], a[12:15], 0
 MF 200,196,28
 WL 231,2048
 v_mfma_f32_16x16x32_bf16 v[196:199], a[188:191], a[28:31], 0
 MF 196,184,12
 s_waitcnt vmcnt(28) lgkmcnt(0)
 MF 0,128,32
 TR 184,233,14336
 TR 186,233,17920
 MF 0,132,48
 MF 4,140,48
 TR 188,233,21504
 MF 4,136,32
 XL 0,237,0
 MF 8,144,32
 TR 190,233,25088
 MF 8,148,48
 MF 12,156,48
 TR 192,233,14368
 MF 12,152,32
 MF 16,160,32
 TR 194,233,17952
 MF 16,164,48
 MF 20,172,48
 TR 196,233,21536
 MF 20,168,32
 XL 4,237,1024
 MF 24,176,32
 TR 198,233,25120
 MF 24,180,48
 MF 80,180,52
 TR 200,233,14400
 MF 80,176,36
 MF 76,168,36
 TR 202,233,17984
 TR 204,233,21568
 MF 76,172,52
 XL 8,237,2048
 MF 72,164,52
 TR 206,233,25152
 MF 72,160,36
 MF 68,152,36
 TR 208,233,14432
 MF 68,156,52
 MF 64,148,52
 TR 210,233,18016
 MF 64,144,36
 MF 60,136,36
 TR 212,233,21600
 MF 60,140,52
 XL 12,237,3072
 s_add_u32 s44, s44, 4096
 MF 56,132,52
 TR 214,233,25184
 MF 56,128,36
 MF 112,128,40
 TR 216,233,14464
 MF 112,132,56
 MF 116,140,56
 TR 218,233,18048
 MF 116,136,40
 XL 16,237,0
 MF 120,144,40
 TR 220,233,21632
 TR 222,233,25216
 MF 120,148,56
 MF 124,156,56
 s_branch L_sequential_preLN__sliding_local_dilated__geglu_ffn__prompt_kernel_pg8_skip
.p2align 12
L_sequential_preLN__sliding_local_dilated__geglu_ffn__prompt_kernel_pg8:
 s_branch L_sequential_preLN__sliding_local_dilated__geglu_ffn__prompt_kernel_hop4_ret
L_sequential_preLN__sliding_local_dilated__geglu_ffn__prompt_kernel_pg8b:
 s_branch L_sequential_preLN__sliding_local_dilated__geglu_ffn__prompt_kernel_sp_ret
L_sequential_preLN__sliding_local_dilated__geglu_ffn__prompt_kernel_pg8_skip:
 TR 224,233,14496
 MF 124,152,40
 MF 128,160,40
 TR 226,233,18080
 MF 128,164,56
 MF 132,172,56
 TR 228,233,21664
 MF 132,168,40
 XL 20,237,1024
 MF 136,176,40
 TR 230,233,25248
 MF 136,180,56
 MF 192,180,60
 TR 232,233,14528
 MF 192,176,44
 MF 188,168,44
 TR 234,233,18112
 MF 188,172,60
 XL 24,237,2048
 MF 184,164,60
 TR 236,233,21696
 MF 184,160,44
 MF 180,152,44
 TR 238,233,25280
 MF 180,156,60
 MF 176,148,60
 MF 176,144,44
 MF 172,136,44
 MF 172,140,60
 XL 28,237,3072
 s_add_u32 s44, s44, 4096
 MF 168,132,60
 MF 168,128,44
 s_waitcnt vmcnt(60) lgkmcnt(0)
 s_barrier
 MF 28,184,32
 TR 128,232,0
 TR 130,232,3584
 MF 28,188,48
 MF 32,196,48
 TR 132,232,7168
 MF 32,192,32
 s_add_u32 m0, s46, 98304
 s_add_u32 s45, s45, 0xe0000
 WL 225,0
 MF 36,200,32
 TR 134,232,10752
 MF 36,204,48
 MF 40,212,48
 TR 136,232,32
 MF 40,208,32
 MF 44,216,32
 TR 138,232,3616
 MF 44,220,48
 MF 48,228,48
 TR 140,232,7200
 MF 48,224,32
 WL 226,1024
 MF 52,232,32
 TR 142,232,10784
 MF 52,236,48
 MF 108,236,52
 TR 144,232,64
 MF 108,232,36
 MF 104,224,36
 TR 146,232,3648
 TR 148,232,7232
 MF 104,228,52
 WL 227,2048
 MF 100,220,52
 TR 150,232,10816
 MF 100,216,36
 MF 96,208,36
 TR 152,232,96
 MF 96,212,52
 MF 92,204,52
 TR 154,232,3680
 MF 92,200,36
 MF 88,192,36
 TR 156,232,7264
 MF 88,196,52
 WL 228,3072
 s_add_u32 m0, s46, 102400
 MF 84,188,52
 TR 158,232,10848
 MF 84,184,36
 MF 140,184,40
 TR 160,232,128
 MF 140,188,56
 MF 144,196,56
 TR 162,232,3712
 MF 144,192,40
 WL 229,0
 MF 148,200,40
 TR 164,232,7296
 TR 166,232,10880
 MF 148,204,56
 MF 152,212,56
 TR 168,232,160
 MF 152,208,40
 MF 156,216,40
 TR 170,232,3744
 MF 156,220,56
 MF 160,228,56
 TR 172,232,7328
 MF 160,224,40
 WL 230,1024
 MF 164,232,40
 TR 174,232,10912
 MF 164,236,56
 MF 220,236,60
 TR 176,232,192
 MF 220,232,44
 MF 216,224,44
 TR 178,232,3776
 MF 216,228,60
 WL 231,2048
 MF 212,220,60
 TR 180,232,7360
 MF 212,216,44
 MF 208,208,44
 TR 182,232,10944
 MF 208,212,60
 MF 204,204,60
 MF 204,200,44
 MF 200,192,44
 MF 200,196,60
 buffer_load_dword v241, v240, s[60:63], s77 offen sc0 sc1
 MF 196,188,60
 MF 196,184,44
 s_waitcnt vmcnt(32) lgkmcnt(0)
 MF 0,128,64
 TR 184,232,14336
 TR 186,232,17920
 MF 0,132,80
 MF 4,140,80
 TR 188,232,21504
 MF 4,136,64
 XL 32,237,0
 MF 8,144,64
 TR 190,232,25088
 MF 8,148,80
 MF 12,156,80
 TR 192,232,14368
 MF 12,152,64
 MF 16,160,64
 TR 194,232,17952
 MF 16,164,80
 XL 36,237,1024
 MF 20,172,80
 TR 196,232,21536
 MF 20,168,64
 MF 24,176,64
 TR 198,232,25120
 MF 24,180,80
 MF 80,180,84
 TR 200,232,14400
 MF 80,176,68
 XL 40,237,2048
 MF 76,168,68
 TR 202,232,17984
 TR 204,232,21568
 MF 76,172,84
 MF 72,164,84
 TR 206,232,25152
 MF 72,160,68
 MF 68,152,68
 TR 208,232,14432
 MF 68,156,84
 XL 44,237,3072
 s_add_u32 s44, s44, 4096
 MF 64,148,84
 TR 210,232,18016
 MF 64,144,68
 MF 60,136,68
 TR 212,232,21600
 MF 60,140,84
 MF 56,132,84
 TR 214,232,25184
 MF 56,128,68
 MF 112,128,72
 TR 216,232,14464
 MF 112,132,88
 XL 48,237,0
 MF 116,140,88
 TR 218,232,18048
 MF 116,136,72
 MF 120,144,72
 TR 220,232,21632
 TR 222,232,25216
 MF 120,148,88
 MF 124,156,88
 TR 224,232,14496
 MF 124,152,72
 XL 52,237,1024
 MF 128,160,72
 TR 226,232,18080
 MF 128,164,88
 MF 132,172,88
 TR 228,232,21664
 MF 132,168,72
 MF 136,176,72
 TR 230,232,25248
 MF 136,180,88
 XL 56,237,2048
 MF 192,180,92
 TR 232,232,14528
 MF 192,176,76
 MF 188,168,76
 TR 234,232,18112
 MF 188,172,92
 MF 184,164,92
 TR 236,232,21696
 MF 184,160,76
 XL 60,237,3072
 s_add_u32 s44, s44, 4096
 MF 180,152,76
 TR 238,232,25280
 MF 180,156,92
 MF 176,148,92
 MF 176,144,76
 MF 172,136,76
 MF 172,140,92
 buffer_load_dword v239, v238, s[40:43], s11 offen
 s_add_u32 s11, s11, 458752
 MF 168,132,92
 MF 168,128,76
 s_waitcnt vmcnt(63) lgkmcnt(0)
 s_barrier
 MF 28,184,64
 TR 128,232,28672
 TR 130,232,32256
 MF 28,188,80
 MF 32,196,80
 TR 132,232,35840
 MF 32,192,64
 s_add_u32 m0, s46, 0
 s_add_u32 s45, s45, 0xe0000
 WL 225,0
 MF 36,200,64
 TR 134,232,39424
 MF 36,204,80
 MF 40,212,80
 TR 136,232,28704
 MF 40,208,64
 MF 44,216,64
 TR 138,232,32288
 MF 44,220,80
 MF 48,228,80
 TR 140,232,35872
 MF 48,224,64
 WL 226,1024
 MF 52,232,64
 TR 142,232,39456
 MF 52,236,80
 MF 108,236,84
 TR 144,232,28736
 MF 108,232,68
 MF 104,224,68
 TR 146,232,32320
 TR 148,232,35904
 MF 104,228,84
 WL 227,2048
 MF 100,220,84
 TR 150,232,39488
 MF 100,216,68
 MF 96,208,68
 TR 152,232,28768
 MF 96,212,84
 MF 92,204,84
 TR 154,232,32352
 MF 92,200,68
 MF 88,192,68
 TR 156,232,35936
 MF 88,196,84
 WL 228,3072
 s_add_u32 m0, s46, 4096
 MF 84,188,84
 TR 158,232,39520
 MF 84,184,68
 MF 140,184,72
 TR 160,232,28800
 MF 140,188,88
 MF 144,196,88
 TR 162,232,32384
 MF 144,192,72
 WL 229,0
 MF 148,200,72
 TR 164,232,35968
 TR 166,232,39552
 MF 148,204,88
 MF 152,212,88
 TR 168,232,28832
 MF 152,208,72
 MF 156,216,72
 TR 170,232,32416
 MF 156,220,88
 MF 160,228,88
 TR 172,232,36000
 MF 160,224,72
 WL 230,1024
 MF 164,232,72
 TR 174,232,39584
 MF 164,236,88
 MF 220,236,92
 TR 176,232,28864
 MF 220,232,76
 MF 216,224,76
 TR 178,232,32448
 MF 216,228,92
 WL 231,2048
 MF 212,220,92
 TR 180,232,36032
 MF 212,216,76
 MF 208,208,76
 TR 182,232,39616
 MF 208,212,92
 MF 204,204,92
 MF 204,200,76
 MF 200,192,76
 MF 200,196,92
 buffer_load_dword v239, v238, s[40:43], s11 offen
 s_add_u32 s11, s11, 458752
 MF 196,188,92
 MF 196,184,76
 s_waitcnt vmcnt(17)
 s_cmp_eq_u32 s77, 262144
 s_cbranch_scc1 L_chk3_ok
 s_add_u32 s71, s96, 2
 s_mov_b32 s47, 0x100000
L_chk3:
 v_subrev_u32 v242, s71, v241
 v_cmp_lt_u32 vcc, 0, v242
 s_nop 1
 s_cmp_eq_u64 vcc, 0
 s_cbranch_scc1 L_chk3_go
 s_sub_u32 s47, s47, 1
 s_cbranch_scc1 L_chk3_go
 buffer_load_dword v241, v240, s[60:63], s77 offen sc0 sc1
 s_waitcnt vmcnt(0)
 s_branch L_chk3
L_chk3_go:
 v_cmp_ne_u32 vcc, 0, v242
 s_nop 1
 s_cmp_eq_u64 vcc, 0
 s_cselect_b32 s77, 262144, s77
L_chk3_ok:
 s_waitcnt vmcnt(40) lgkmcnt(0)
 MF 0,128,96
 TR 184,232,43008
 TR 186,232,46592
 MF 0,132,112
 MF 4,140,112
 TR 188,232,50176
 MF 4,136,96
 XL 64,237,0
 MF 8,144,96
 TR 190,232,53760
 MF 8,148,112
 MF 12,156,112
 TR 192,232,43040
 MF 12,152,96
 MF 16,160,96
 TR 194,232,46624
 MF 16,164,112
 XL 68,237,1024
 MF 20,172,112
 TR 196,232,50208
 MF 20,168,96
 MF 24,176,96
 TR 198,232,53792
 MF 24,180,112
 MF 80,180,116
 TR 200,232,43072
 MF 80,176,100
 XL 72,237,2048
 MF 76,168,100
 TR 202,232,46656
 TR 204,232,50240
 MF 76,172,116
 MF 72,164,116
 TR 206,232,53824
 MF 72,160,100
 MF 68,152,100
 TR 208,232,43104
 MF 68,156,116
 XL 76,237,3072
 s_add_u32 s44, s44, 4096
 MF 64,148,116
 TR 210,232,46688
 MF 64,144,100
 MF 60,136,100
 TR 212,232,50272
 MF 60,140,116
 MF 56,132,116
 TR 214,232,53856
 MF 56,128,100
 MF 112,128,104
 TR 216,232,43136
 MF 112,132,120
 XL 80,237,0
 MF 116,140,120
 TR 218,232,46720
 MF 116,136,104
 MF 120,144,104
 TR 220,232,50304
 TR 222,232,53888
 MF 120,148,120
 MF 124,156,120
 TR 224,232,43168
 MF 124,152,104
 XL 84,237,1024
 MF 128,160,104
 TR 226,232,46752
 MF 128,164,120
 MF 132,172,120
 TR 228,232,50336
 MF 132,168,104
 MF 136,176,104
 TR 230,232,53920
 MF 136,180,120
 XL 88,237,2048
 MF 192,180,124
 TR 232,232,43200
 MF 192,176,108
 MF 188,168,108
 TR 234,232,46784
 MF 188,172,124
 MF 184,164,124
 TR 236,232,50368
 MF 184,160,108
 XL 92,237,3072
 s_add_u32 s44, s44, 4096
 MF 180,152,108
 TR 238,232,53952
 MF 180,156,124
 MF 176,148,124
 MF 176,144,108
 MF 172,136,108
 MF 172,140,124
 buffer_load_dword v239, v238, s[40:43], s11 offen
 s_add_u32 s11, s11, 458752
 MF 168,132,124
 MF 168,128,108
 s_waitcnt vmcnt(42) lgkmcnt(0)
 s_barrier
 MF 28,184,96
 TR 128,233,32768
 TR 130,233,36352
 MF 28,188,112
 s_and_b32 s72, s3, 3
 s_lshl_b32 s72, s72, 2
 s_and_b32 s71, s4, 3
 s_add_u32 s72, s72, s71
 s_lshr_b32 s73, s3, 2
 MF 32,196,112
 TR 132,233,39936
 s_lshl_b32 s73, s73, 3
 s_lshr_b32 s71, s4, 2
 s_add_u32 s73, s73, s71
 MF 32,192,96
 s_add_u32 m0, s46, 28672
 s_add_u32 s45, s45, 0xe0000
 WL 225,0
 MF 36,200,96
 TR 134,233,43520
 s_lshr_b32 s74, s73, 3
 s_and_b32 s73, s73, 7
 s_lshl_b32 s75, s72, 3
 MF 36,204,112
 s_lshl_b32 s71, s7, 1
 s_add_u32 s75, s75, s71
 s_lshr_b32 s71, s6, 4
 s_mul_i32 s71, s71, 56
 s_and_b32 s64, s6, 15
 MF 40,212,112
 TR 136,233,32800
 s_lshr_b32 s66, s64, 1
 s_add_u32 s64, s64, s71
 s_add_u32 s66, s66, s71
 MF 40,208,96
 s_add_u32 s66, s66, 48
 s_lshl_b32 s64, s64, 11
 s_lshl_b32 s66, s66, 11
 s_mul_i32 s71, s8, 114688
 s_add_u32 s64, s64, s71
 MF 44,216,96
 TR 138,233,36384
 s_add_u32 s66, s66, s71
 s_lshl_b32 s71, s10, 9
 s_add_u32 s66, s66, s71
 MF 44,220,112
 s_add_u32 s65, s64, 229376
 s_add_u32 s67, s66, 229376
 s_lshl_b32 s68, s8, 5
 s_lshl_b32 s71, s6, 2
 s_add_u32 s68, s68, s71
 MF 48,228,112
 TR 140,233,39968
 s_add_u32 s68, s68, 16384
 s_lshr_b32 s69, s7, 1
 s_mul_i32 s69, s69, 196608
 MF 48,224,96
 WL 226,1024
 s_lshr_b32 s70, s75, 2
 MF 52,232,96
 TR 142,233,43552
 s_lshl_b32 s70, s70, 7
 s_lshl_b32 s71, s74, 6
 s_add_u32 s70, s70, s71
 MF 52,236,112
 s_add_u32 s70, s70, 16384
 MF 108,236,116
 TR 144,233,32832
 MF 108,232,100
 MF 104,224,100
 TR 146,233,36416
 TR 148,233,40000
 MF 104,228,116
 WL 227,2048
 MF 100,220,116
 TR 150,233,43584
 MF 100,216,100
 MF 96,208,100
 TR 152,233,32864
 MF 96,212,116
 MF 92,204,116
 TR 154,233,36448
 MF 92,200,100
 MF 88,192,100
 TR 156,233,40032
 MF 88,196,116
 WL 228,3072
 s_add_u32 m0, s46, 32768
 MF 84,188,116
 TR 158,233,43616
 MF 84,184,100
 MF 140,184,104
 TR 160,233,32896
 MF 140,188,120
 MF 144,196,120
 TR 162,233,36480
 s_branch L_sequential_preLN__sliding_local_dilated__geglu_ffn__prompt_kernel_pg9_skip
.p2align 12
L_sequential_preLN__sliding_local_dilated__geglu_ffn__prompt_kernel_pg9:
 s_branch L_sequential_preLN__sliding_local_dilated__geglu_ffn__prompt_kernel_hop4_ret
L_sequential_preLN__sliding_local_dilated__geglu_ffn__prompt_kernel_pg9b:
 s_branch L_sequential_preLN__sliding_local_dilated__geglu_ffn__prompt_kernel_sp_ret
L_sequential_preLN__sliding_local_dilated__geglu_ffn__prompt_kernel_pg9_skip:
 MF 144,192,104
 WL 229,0
 MF 148,200,104
 TR 164,233,40064
 TR 166,233,43648
 MF 148,204,120
 MF 152,212,120
 TR 168,233,32928
 MF 152,208,104
 MF 156,216,104
 TR 170,233,36512
 MF 156,220,120
 MF 160,228,120
 TR 172,233,40096
 MF 160,224,104
 WL 230,1024
 MF 164,232,104
 TR 174,233,43680
 MF 164,236,120
 MF 220,236,124
 TR 176,233,32960
 MF 220,232,108
 MF 216,224,108
 TR 178,233,36544
 MF 216,228,124
 WL 231,2048
 MF 212,220,124
 TR 180,233,40128
 MF 212,216,108
 MF 208,208,108
 TR 182,233,43712
 MF 208,212,124
 MF 204,204,124
 MF 204,200,108
 MF 200,192,108
 MF 200,196,124
 buffer_load_dword v239, v238, s[40:43], s11 offen
 s_add_u32 s11, s11, 458752
 MF 196,188,124
 MF 196,184,108
 s_waitcnt vmcnt(42) lgkmcnt(0)
 MF 0,128,0
 TR 184,233,47104
 TR 186,233,50688
 MF 0,132,16
 MF 4,140,16
 TR 188,233,54272
 MF 4,136,0
 XL 96,237,0
 MF 8,144,0
 TR 190,233,57856
 MF 8,148,16
 MF 12,156,16
 TR 192,233,47136
 MF 12,152,0
 MF 16,160,0
 TR 194,233,50720
 MF 16,164,16
 XL 100,237,1024
 MF 20,172,16
 TR 196,233,54304
 MF 20,168,0
 MF 24,176,0
 TR 198,233,57888
 MF 24,180,16
 MF 80,180,20
 TR 200,233,47168
 MF 80,176,4
 XL 104,237,2048
 MF 76,168,4
 TR 202,233,50752
 TR 204,233,54336
 MF 76,172,20
 MF 72,164,20
 TR 206,233,57920
 MF 72,160,4
 MF 68,152,4
 TR 208,233,47200
 MF 68,156,20
 XL 108,237,3072
 s_add_u32 s44, s44, 4096
 MF 64,148,20
 TR 210,233,50784
 MF 64,144,4
 MF 60,136,4
 TR 212,233,54368
 MF 60,140,20
 MF 56,132,20
 TR 214,233,57952
 MF 56,128,4
 MF 112,128,8
 TR 216,233,47232
 MF 112,132,24
 XL 112,237,0
 MF 116,140,24
 TR 218,233,50816
 MF 116,136,8
 MF 120,144,8
 TR 220,233,54400
 TR 222,233,57984
 MF 120,148,24
 MF 124,156,24
 TR 224,233,47264
 MF 124,152,8
 XL 116,237,1024
 MF 128,160,8
 TR 226,233,50848
 MF 128,164,24
 MF 132,172,24
 TR 228,233,54432
 MF 132,168,8
 MF 136,176,8
 TR 230,233,58016
 MF 136,180,24
 XL 120,237,2048
 MF 192,180,28
 TR 232,233,47296
 MF 192,176,12
 MF 188,168,12
 TR 234,233,50880
 MF 188,172,28
 MF 184,164,28
 TR 236,233,54464
 MF 184,160,12
 XL 124,237,3072
 s_add_u32 s44, s44, 4096
 MF 180,152,12
 TR 238,233,58048
 MF 180,156,28
 MF 176,148,28
 MF 176,144,12
 MF 172,136,12
 MF 172,140,28
 buffer_load_dword v239, v238, s[40:43], s11 offen
 s_add_u32 s11, s11, 458752
 MF 168,132,28
 MF 168,128,12
 s_waitcnt vmcnt(44) lgkmcnt(0)
 s_barrier
 MF 28,184,0
 TR 128,233,0
 TR 130,233,3584
 MF 28,188,16
 MF 32,196,16
 TR 132,233,7168
 MF 32,192,0
 s_add_u32 m0, s46, 131072
 s_add_u32 s45, s45, 0xffa18000
 WL 225,0
 MF 36,200,0
 TR 134,233,10752
 MF 36,204,16
 MF 40,212,16
 TR 136,233,32
 MF 40,208,0
 MF 44,216,0
 TR 138,233,3616
 MF 44,220,16
 MF 48,228,16
 TR 140,233,7200
 MF 48,224,0
 WL 226,1024
 MF 52,232,0
 TR 142,233,10784
 MF 52,236,16
 MF 108,236,20
 TR 144,233,64
 MF 108,232,4
 MF 104,224,4
 TR 146,233,3648
 TR 148,233,7232
 MF 104,228,20
 WL 227,2048
 MF 100,220,20
 TR 150,233,10816
 MF 100,216,4
 MF 96,208,4
 TR 152,233,96
 MF 96,212,20
 MF 92,204,20
 TR 154,233,3680
 MF 92,200,4
 MF 88,192,4
 TR 156,233,7264
 MF 88,196,20
 WL 228,3072
 s_add_u32 m0, s46, 135168
 MF 84,188,20
 TR 158,233,10848
 MF 84,184,4
 MF 140,184,8
 TR 160,233,128
 MF 140,188,24
 MF 144,196,24
 TR 162,233,3712
 MF 144,192,8
 WL 229,0
 MF 148,200,8
 TR 164,233,7296
 TR 166,233,10880
 MF 148,204,24
 MF 152,212,24
 TR 168,233,160
 MF 152,208,8
 MF 156,216,8
 TR 170,233,3744
 MF 156,220,24
 MF 160,228,24
 TR 172,233,7328
 MF 160,224,8
 WL 230,1024
 MF 164,232,8
 TR 174,233,10912
 MF 164,236,24
 MF 220,236,28
 TR 176,233,192
 MF 220,232,12
 MF 216,224,12
 TR 178,233,3776
 MF 216,228,28
 WL 231,2048
 MF 212,220,28
 TR 180,233,7360
 MF 212,216,12
 MF 208,208,12
 TR 182,233,10944
 MF 208,212,28
 MF 204,204,28
 MF 204,200,12
 MF 200,192,12
 MF 200,196,28
 buffer_load_dword v239, v238, s[40:43], s11 offen
 s_add_u32 s11, s11, 458752
 MF 196,188,28
 MF 196,184,12
 s_waitcnt vmcnt(43) lgkmcnt(0)
 MF 0,128,32
 TR 184,233,14336
 TR 186,233,17920
 MF 0,132,48
 MF 4,140,48
 TR 188,233,21504
 MF 4,136,32
 XL 0,237,0
 MF 8,144,32
 TR 190,233,25088
 MF 8,148,48
 MF 12,156,48
 TR 192,233,14368
 MF 12,152,32
 MF 16,160,32
 TR 194,233,17952
 MF 16,164,48
 XL 4,237,1024
 MF 20,172,48
 TR 196,233,21536
 MF 20,168,32
 MF 24,176,32
 TR 198,233,25120
 MF 24,180,48
 MF 80,180,52
 TR 200,233,14400
 MF 80,176,36
 XL 8,237,2048
 MF 76,168,36
 TR 202,233,17984
 TR 204,233,21568
 MF 76,172,52
 MF 72,164,52
 TR 206,233,25152
 MF 72,160,36
 MF 68,152,36
 TR 208,233,14432
 MF 68,156,52
 XL 12,237,3072
 s_add_u32 s44, s44, 4096
 MF 64,148,52
 TR 210,233,18016
 MF 64,144,36
 MF 60,136,36
 TR 212,233,21600
 MF 60,140,52
 MF 56,132,52
 TR 214,233,25184
 MF 56,128,36
 MF 112,128,40
 TR 216,233,14464
 MF 112,132,56
 XL 16,237,0
 MF 116,140,56
 TR 218,233,18048
 MF 116,136,40
 MF 120,144,40
 TR 220,233,21632
 TR 222,233,25216
 MF 120,148,56
 MF 124,156,56
 TR 224,233,14496
 MF 124,152,40
 XL 20,237,1024
 MF 128,160,40
 TR 226,233,18080
 MF 128,164,56
 MF 132,172,56
 TR 228,233,21664
 MF 132,168,40
 MF 136,176,40
 TR 230,233,25248
 MF 136,180,56
 XL 24,237,2048
 MF 192,180,60
 TR 232,233,14528
 MF 192,176,44
 MF 188,168,44
 TR 234,233,18112
 MF 188,172,60
 MF 184,164,60
 TR 236,233,21696
 MF 184,160,44
 XL 28,237,3072
 s_add_u32 s44, s44, 4096
 MF 180,152,44
 TR 238,233,25280
 MF 180,156,60
 MF 176,148,60
 MF 176,144,44
 MF 172,136,44
 MF 172,140,60
 buffer_load_dword v239, v238, s[40:43], s11 offen
 s_add_u32 s11, s11, 458752
 MF 168,132,60
 MF 168,128,44
 s_waitcnt vmcnt(44) lgkmcnt(0)
 s_barrier
 MF 28,184,32
 TR 128,232,0
 TR 130,232,3584
 MF 28,188,48
 MF 32,196,48
 TR 132,232,7168
 MF 32,192,32
 s_add_u32 m0, s46, 98304
 s_add_u32 s45, s45, 0xe0000
 WL 225,0
 MF 36,200,32
 TR 134,232,10752
 MF 36,204,48
 MF 40,212,48
 TR 136,232,32
 MF 40,208,32
 MF 44,216,32
 TR 138,232,3616
 MF 44,220,48
 MF 48,228,48
 TR 140,232,7200
 MF 48,224,32
 WL 226,1024
 MF 52,232,32
 TR 142,232,10784
 MF 52,236,48
 MF 108,236,52
 TR 144,232,64
 MF 108,232,36
 MF 104,224,36
 TR 146,232,3648
 TR 148,232,7232
 MF 104,228,52
 WL 227,2048
 MF 100,220,52
 TR 150,232,10816
 MF 100,216,36
 MF 96,208,36
 TR 152,232,96
 MF 96,212,52
 MF 92,204,52
 TR 154,232,3680
 MF 92,200,36
 MF 88,192,36
 TR 156,232,7264
 MF 88,196,52
 WL 228,3072
 s_add_u32 m0, s46, 102400
 MF 84,188,52
 TR 158,232,10848
 MF 84,184,36
 MF 140,184,40
 TR 160,232,128
 MF 140,188,56
 MF 144,196,56
 TR 162,232,3712
 MF 144,192,40
 WL 229,0
 MF 148,200,40
 TR 164,232,7296
 TR 166,232,10880
 MF 148,204,56
 MF 152,212,56
 TR 168,232,160
 MF 152,208,40
 MF 156,216,40
 TR 170,232,3744
 MF 156,220,56
 MF 160,228,56
 TR 172,232,7328
 MF 160,224,40
 WL 230,1024
 MF 164,232,40
 TR 174,232,10912
 MF 164,236,56
 MF 220,236,60
 TR 176,232,192
 MF 220,232,44
 MF 216,224,44
 TR 178,232,3776
 MF 216,228,60
 WL 231,2048
 MF 212,220,60
 TR 180,232,7360
 MF 212,216,44
 MF 208,208,44
 TR 182,232,10944
 MF 208,212,60
 MF 204,204,60
 MF 204,200,44
 MF 200,192,44
 MF 200,196,60
 buffer_load_dword v239, v238, s[40:43], s11 offen
 s_add_u32 s11, s11, 458752
 MF 196,188,60
 MF 196,184,44
 s_waitcnt vmcnt(43) lgkmcnt(0)
 MF 0,128,64
 TR 184,232,14336
 TR 186,232,17920
 MF 0,132,80
 MF 4,140,80
 TR 188,232,21504
 MF 4,136,64
 XL 32,237,0
 MF 8,144,64
 TR 190,232,25088
 MF 8,148,80
 MF 12,156,80
 TR 192,232,14368
 MF 12,152,64
 MF 16,160,64
 TR 194,232,17952
 MF 16,164,80
 XL 36,237,1024
 MF 20,172,80
 TR 196,232,21536
 MF 20,168,64
 MF 24,176,64
 TR 198,232,25120
 MF 24,180,80
 MF 80,180,84
 TR 200,232,14400
 MF 80,176,68
 XL 40,237,2048
 MF 76,168,68
 TR 202,232,17984
 TR 204,232,21568
 MF 76,172,84
 MF 72,164,84
 TR 206,232,25152
 MF 72,160,68
 MF 68,152,68
 TR 208,232,14432
 MF 68,156,84
 XL 44,237,3072
 s_add_u32 s44, s44, 4096
 MF 64,148,84
 TR 210,232,18016
 MF 64,144,68
 MF 60,136,68
 TR 212,232,21600
 MF 60,140,84
 MF 56,132,84
 TR 214,232,25184
 MF 56,128,68
 MF 112,128,72
 TR 216,232,14464
 MF 112,132,88
 XL 48,237,0
 MF 116,140,88
 TR 218,232,18048
 MF 116,136,72
 MF 120,144,72
 TR 220,232,21632
 TR 222,232,25216
 MF 120,148,88
 MF 124,156,88
 TR 224,232,14496
 MF 124,152,72
 XL 52,237,1024
 MF 128,160,72
 TR 226,232,18080
 MF 128,164,88
 MF 132,172,88
 TR 228,232,21664
 MF 132,168,72
 MF 136,176,72
 TR 230,232,25248
 MF 136,180,88
 XL 56,237,2048
 MF 192,180,92
 TR 232,232,14528
 MF 192,176,76
 MF 188,168,76
 TR 234,232,18112
 MF 188,172,92
 MF 184,164,92
 TR 236,232,21696
 MF 184,160,76
 s_branch L_sequential_preLN__sliding_local_dilated__geglu_ffn__prompt_kernel_pg10_skip
.p2align 12
L_sequential_preLN__sliding_local_dilated__geglu_ffn__prompt_kernel_pg10:
 s_branch L_sequential_preLN__sliding_local_dilated__geglu_ffn__prompt_kernel_hop4_ret
L_sequential_preLN__sliding_local_dilated__geglu_ffn__prompt_kernel_pg10b:
 s_branch L_sequential_preLN__sliding_local_dilated__geglu_ffn__prompt_kernel_sp_ret
L_sequential_preLN__sliding_local_dilated__geglu_ffn__prompt_kernel_pg10_skip:
 XL 60,237,3072
 s_add_u32 s44, s44, 4096
 MF 180,152,76
 TR 238,232,25280
 MF 180,156,92
 MF 176,148,92
 MF 176,144,76
 MF 172,136,76
 MF 172,140,92
 buffer_load_dword v239, v238, s[40:43], s11 offen
 s_add_u32 s11, s11, 458752
 MF 168,132,92
 MF 168,128,76
 s_waitcnt vmcnt(44) lgkmcnt(0)
 s_barrier
 MF 28,184,64
 TR 128,232,28672
 TR 130,232,32256
 MF 28,188,80
 MF 32,196,80
 TR 132,232,35840
 MF 32,192,64
 s_add_u32 m0, s46, 0
 s_add_u32 s45, s45, 0xe0000
 WL 225,0
 MF 36,200,64
 TR 134,232,39424
 MF 36,204,80
 MF 40,212,80
 TR 136,232,28704
 MF 40,208,64
 MF 44,216,64
 TR 138,232,32288
 MF 44,220,80
 MF 48,228,80
 TR 140,232,35872
 MF 48,224,64
 WL 226,1024
 MF 52,232,64
 TR 142,232,39456
 MF 52,236,80
 MF 108,236,84
 TR 144,232,28736
 MF 108,232,68
 MF 104,224,68
 TR 146,232,32320
 TR 148,232,35904
 MF 104,228,84
 WL 227,2048
 MF 100,220,84
 TR 150,232,39488
 MF 100,216,68
 MF 96,208,68
 TR 152,232,28768
 MF 96,212,84
 MF 92,204,84
 TR 154,232,32352
 MF 92,200,68
 MF 88,192,68
 TR 156,232,35936
 MF 88,196,84
 WL 228,3072
 s_add_u32 m0, s46, 4096
 MF 84,188,84
 TR 158,232,39520
 MF 84,184,68
 MF 140,184,72
 TR 160,232,28800
 MF 140,188,88
 MF 144,196,88
 TR 162,232,32384
 MF 144,192,72
 WL 229,0
 MF 148,200,72
 TR 164,232,35968
 TR 166,232,39552
 MF 148,204,88
 MF 152,212,88
 TR 168,232,28832
 MF 152,208,72
 MF 156,216,72
 TR 170,232,32416
 MF 156,220,88
 MF 160,228,88
 TR 172,232,36000
 MF 160,224,72
 WL 230,1024
 MF 164,232,72
 TR 174,232,39584
 MF 164,236,88
 MF 220,236,92
 TR 176,232,28864
 MF 220,232,76
 MF 216,224,76
 TR 178,232,32448
 MF 216,228,92
 WL 231,2048
 MF 212,220,92
 TR 180,232,36032
 MF 212,216,76
 MF 208,208,76
 TR 182,232,39616
 MF 208,212,92
 MF 204,204,92
 MF 204,200,76
 MF 200,192,76
 MF 200,196,92
 buffer_load_dword v239, v238, s[40:43], s11 offen
 s_add_u32 s11, s11, 458752
 MF 196,188,92
 MF 196,184,76
 s_waitcnt vmcnt(43) lgkmcnt(0)
 MF 0,128,96
 TR 184,232,43008
 TR 186,232,46592
 MF 0,132,112
 MF 4,140,112
 TR 188,232,50176
 MF 4,136,96
 XL 64,237,0
 MF 8,144,96
 TR 190,232,53760
 MF 8,148,112
 MF 12,156,112
 TR 192,232,43040
 MF 12,152,96
 MF 16,160,96
 TR 194,232,46624
 MF 16,164,112
 XL 68,237,1024
 MF 20,172,112
 TR 196,232,50208
 MF 20,168,96
 MF 24,176,96
 TR 198,232,53792
 MF 24,180,112
 MF 80,180,116
 TR 200,232,43072
 MF 80,176,100
 XL 72,237,2048
 MF 76,168,100
 TR 202,232,46656
 TR 204,232,50240
 MF 76,172,116
 MF 72,164,116
 TR 206,232,53824
 MF 72,160,100
 MF 68,152,100
 TR 208,232,43104
 MF 68,156,116
 XL 76,237,3072
 s_add_u32 s44, s44, 4096
 MF 64,148,116
 TR 210,232,46688
 MF 64,144,100
 MF 60,136,100
 TR 212,232,50272
 MF 60,140,116
 MF 56,132,116
 TR 214,232,53856
 MF 56,128,100
 MF 112,128,104
 TR 216,232,43136
 MF 112,132,120
 XL 80,237,0
 MF 116,140,120
 TR 218,232,46720
 MF 116,136,104
 MF 120,144,104
 TR 220,232,50304
 TR 222,232,53888
 MF 120,148,120
 MF 124,156,120
 TR 224,232,43168
 MF 124,152,104
 XL 84,237,1024
 MF 128,160,104
 TR 226,232,46752
 MF 128,164,120
 MF 132,172,120
 TR 228,232,50336
 MF 132,168,104
 MF 136,176,104
 TR 230,232,53920
 MF 136,180,120
 XL 88,237,2048
 MF 192,180,124
 TR 232,232,43200
 MF 192,176,108
 MF 188,168,108
 TR 234,232,46784
 MF 188,172,124
 MF 184,164,124
 TR 236,232,50368
 MF 184,160,108
 XL 92,237,3072
 s_add_u32 s44, s44, 4096
 MF 180,152,108
 TR 238,232,53952
 MF 180,156,124
 MF 176,148,124
 MF 176,144,108
 MF 172,136,108
 MF 172,140,124
 buffer_load_dword v239, v238, s[40:43], s11 offen
 s_add_u32 s11, s11, 458752
 MF 168,132,124
 MF 168,128,108
 s_waitcnt vmcnt(44) lgkmcnt(0)
 s_barrier
 MF 28,184,96
 TR 128,233,32768
 TR 130,233,36352
 MF 28,188,112
 MF 32,196,112
 TR 132,233,39936
 MF 32,192,96
 s_add_u32 m0, s46, 28672
 s_add_u32 s45, s45, 0xe0000
 WL 225,0
 MF 36,200,96
 TR 134,233,43520
 MF 36,204,112
 MF 40,212,112
 TR 136,233,32800
 MF 40,208,96
 MF 44,216,96
 TR 138,233,36384
 MF 44,220,112
 MF 48,228,112
 TR 140,233,39968
 MF 48,224,96
 WL 226,1024
 MF 52,232,96
 TR 142,233,43552
 MF 52,236,112
 MF 108,236,116
 TR 144,233,32832
 MF 108,232,100
 MF 104,224,100
 TR 146,233,36416
 TR 148,233,40000
 MF 104,228,116
 WL 227,2048
 MF 100,220,116
 TR 150,233,43584
 MF 100,216,100
 MF 96,208,100
 TR 152,233,32864
 MF 96,212,116
 MF 92,204,116
 TR 154,233,36448
 MF 92,200,100
 MF 88,192,100
 TR 156,233,40032
 MF 88,196,116
 WL 228,3072
 s_add_u32 m0, s46, 32768
 MF 84,188,116
 TR 158,233,43616
 MF 84,184,100
 MF 140,184,104
 TR 160,233,32896
 MF 140,188,120
 MF 144,196,120
 TR 162,233,36480
 MF 144,192,104
 WL 229,0
 MF 148,200,104
 TR 164,233,40064
 TR 166,233,43648
 MF 148,204,120
 MF 152,212,120
 TR 168,233,32928
 MF 152,208,104
 MF 156,216,104
 TR 170,233,36512
 MF 156,220,120
 MF 160,228,120
 TR 172,233,40096
 MF 160,224,104
 WL 230,1024
 MF 164,232,104
 TR 174,233,43680
 MF 164,236,120
 MF 220,236,124
 TR 176,233,32960
 MF 220,232,108
 MF 216,224,108
 TR 178,233,36544
 MF 216,228,124
 WL 231,2048
 MF 212,220,124
 TR 180,233,40128
 MF 212,216,108
 MF 208,208,108
 TR 182,233,43712
 MF 208,212,124
 MF 204,204,124
 MF 204,200,108
 MF 200,192,108
 MF 200,196,124
 buffer_load_dword v239, v238, s[40:43], s11 offen
 s_add_u32 s11, s11, 458752
 MF 196,188,124
 MF 196,184,108
 s_waitcnt vmcnt(43) lgkmcnt(0)
 MF 0,128,0
 TR 184,233,47104
 TR 186,233,50688
 MF 0,132,16
 MF 4,140,16
 TR 188,233,54272
 MF 4,136,0
 XL 96,237,0
 MF 8,144,0
 TR 190,233,57856
 MF 8,148,16
 MF 12,156,16
 TR 192,233,47136
 MF 12,152,0
 MF 16,160,0
 TR 194,233,50720
 MF 16,164,16
 XL 100,237,1024
 MF 20,172,16
 TR 196,233,54304
 MF 20,168,0
 MF 24,176,0
 TR 198,233,57888
 MF 24,180,16
 MF 80,180,20
 TR 200,233,47168
 MF 80,176,4
 XL 104,237,2048
 MF 76,168,4
 TR 202,233,50752
 TR 204,233,54336
 MF 76,172,20
 MF 72,164,20
 TR 206,233,57920
 MF 72,160,4
 MF 68,152,4
 TR 208,233,47200
 MF 68,156,20
 XL 108,237,3072
 s_add_u32 s44, s44, 4096
 MF 64,148,20
 TR 210,233,50784
 MF 64,144,4
 MF 60,136,4
 TR 212,233,54368
 MF 60,140,20
 MF 56,132,20
 TR 214,233,57952
 MF 56,128,4
 MF 112,128,8
 TR 216,233,47232
 MF 112,132,24
 XL 112,237,0
 MF 116,140,24
 TR 218,233,50816
 MF 116,136,8
 MF 120,144,8
 TR 220,233,54400
 TR 222,233,57984
 MF 120,148,24
 MF 124,156,24
 TR 224,233,47264
 MF 124,152,8
 XL 116,237,1024
 MF 128,160,8
 TR 226,233,50848
 MF 128,164,24
 MF 132,172,24
 TR 228,233,54432
 MF 132,168,8
 MF 136,176,8
 TR 230,233,58016
 MF 136,180,24
 XL 120,237,2048
 MF 192,180,28
 TR 232,233,47296
 MF 192,176,12
 MF 188,168,12
 TR 234,233,50880
 MF 188,172,28
 MF 184,164,28
 TR 236,233,54464
 MF 184,160,12
 XL 124,237,3072
 s_add_u32 s44, s44, 4096
 MF 180,152,12
 TR 238,233,58048
 MF 180,156,28
 MF 176,148,28
 MF 176,144,12
 MF 172,136,12
 MF 172,140,28
 buffer_load_dword v239, v238, s[40:43], s11 offen
 s_add_u32 s11, s11, 458752
 MF 168,132,28
 MF 168,128,12
 s_waitcnt vmcnt(44) lgkmcnt(0)
 s_barrier
 MF 28,184,0
 TR 128,233,0
 TR 130,233,3584
 MF 28,188,16
 MF 32,196,16
 TR 132,233,7168
 MF 32,192,0
 s_add_u32 m0, s46, 131072
 s_add_u32 s45, s45, 0xe0000
 WL 225,0
 MF 36,200,0
 TR 134,233,10752
 MF 36,204,16
 MF 40,212,16
 TR 136,233,32
 MF 40,208,0
 MF 44,216,0
 TR 138,233,3616
 MF 44,220,16
 MF 48,228,16
 TR 140,233,7200
 MF 48,224,0
 WL 226,1024
 MF 52,232,0
 TR 142,233,10784
 MF 52,236,16
 MF 108,236,20
 TR 144,233,64
 MF 108,232,4
 MF 104,224,4
 TR 146,233,3648
 TR 148,233,7232
 MF 104,228,20
 WL 227,2048
 MF 100,220,20
 TR 150,233,10816
 MF 100,216,4
 MF 96,208,4
 TR 152,233,96
 MF 96,212,20
 MF 92,204,20
 TR 154,233,3680
 MF 92,200,4
 MF 88,192,4
 TR 156,233,7264
 MF 88,196,20
 WL 228,3072
 s_add_u32 m0, s46, 135168
 MF 84,188,20
 TR 158,233,10848
 MF 84,184,4
 MF 140,184,8
 TR 160,233,128
 MF 140,188,24
 MF 144,196,24
 TR 162,233,3712
 MF 144,192,8
 WL 229,0
 MF 148,200,8
 TR 164,233,7296
 TR 166,233,10880
 MF 148,204,24
 MF 152,212,24
 TR 168,233,160
 MF 152,208,8
 MF 156,216,8
 TR 170,233,3744
 MF 156,220,24
 MF 160,228,24
 TR 172,233,7328
 MF 160,224,8
 WL 230,1024
 MF 164,232,8
 TR 174,233,10912
 MF 164,236,24
 MF 220,236,28
 TR 176,233,192
 MF 220,232,12
 MF 216,224,12
 TR 178,233,3776
 MF 216,228,28
 WL 231,2048
 MF 212,220,28
 TR 180,233,7360
 MF 212,216,12
 MF 208,208,12
 TR 182,233,10944
 MF 208,212,28
 MF 204,204,28
 MF 204,200,12
 MF 200,192,12
 MF 200,196,28
 buffer_load_dword v239, v238, s[40:43], s11 offen
 s_add_u32 s11, s11, 458752
 MF 196,188,28
 MF 196,184,12
 s_waitcnt vmcnt(43) lgkmcnt(0)
 MF 0,128,32
 TR 184,233,14336
 TR 186,233,17920
 MF 0,132,48
 XL 0,237,0
 MF 4,140,48
 TR 188,233,21504
 MF 4,136,32
 XL 4,237,1024
 MF 8,144,32
 TR 190,233,25088
 MF 8,148,48
 XL 8,237,2048
 s_branch L_sequential_preLN__sliding_local_dilated__geglu_ffn__prompt_kernel_pg11_skip
.p2align 12
L_sequential_preLN__sliding_local_dilated__geglu_ffn__prompt_kernel_pg11:
 s_branch L_sequential_preLN__sliding_local_dilated__geglu_ffn__prompt_kernel_hop4_ret
L_sequential_preLN__sliding_local_dilated__geglu_ffn__prompt_kernel_pg11b:
 s_branch L_sequential_preLN__sliding_local_dilated__geglu_ffn__prompt_kernel_sp_ret
L_sequential_preLN__sliding_local_dilated__geglu_ffn__prompt_kernel_pg11_skip:
 MF 12,156,48
 TR 192,233,14368
 MF 12,152,32
 XL 12,237,3072
 s_add_u32 s44, s44, 4096
 MF 16,160,32
 TR 194,233,17952
 MF 16,164,48
 MF 20,172,48
 TR 196,233,21536
 MF 20,168,32
 XL 16,237,0
 MF 24,176,32
 TR 198,233,25120
 MF 24,180,48
 XL 20,237,1024
 MF 80,180,52
 TR 200,233,14400
 MF 80,176,36
 XL 24,237,2048
 MF 76,168,36
 TR 202,233,17984
 TR 204,233,21568
 MF 76,172,52
 XL 28,237,3072
 s_add_u32 s44, s44, 4096
 MF 72,164,52
 TR 206,233,25152
 MF 72,160,36
 buffer_load_dword v239, v238, s[40:43], s11 offen
 s_add_u32 s11, s11, 458752
 MF 68,152,36
 TR 208,233,14432
 MF 68,156,52
 buffer_load_dword v240, v235, s[48:51], s9 offen offset:0
 MF 64,148,52
 TR 210,233,18016
 MF 64,144,36
 buffer_load_dword v241, v235, s[48:51], s9 offen offset:128
 MF 60,136,36
 TR 212,233,21600
 MF 60,140,52
 buffer_load_dword v242, v235, s[48:51], s9 offen offset:256
 MF 56,132,52
 TR 214,233,25184
 MF 56,128,36
 MF 112,128,40
 TR 216,233,14464
 MF 112,132,56
 buffer_load_dword v243, v235, s[48:51], s9 offen offset:384
 MF 116,140,56
 TR 218,233,18048
 MF 116,136,40
 buffer_load_dword v244, v235, s[48:51], s9 offen offset:512
 MF 120,144,40
 TR 220,233,21632
 TR 222,233,25216
 MF 120,148,56
 buffer_load_dword v245, v235, s[48:51], s9 offen offset:640
 MF 124,156,56
 TR 224,233,14496
 MF 124,152,40
 buffer_load_dword v246, v235, s[48:51], s9 offen offset:768
 MF 128,160,40
 TR 226,233,18080
 MF 128,164,56
 buffer_load_dword v247, v235, s[48:51], s9 offen offset:896
 MF 132,172,56
 TR 228,233,21664
 MF 132,168,40
 buffer_load_dword v248, v235, s[48:51], s9 offen offset:1024
 MF 136,176,40
 TR 230,233,25248
 MF 136,180,56
 buffer_load_dword v249, v235, s[48:51], s9 offen offset:1152
 MF 192,180,60
 TR 232,233,14528
 MF 192,176,44
 buffer_load_dword v250, v235, s[48:51], s9 offen offset:1280
 MF 188,168,44
 TR 234,233,18112
 MF 188,172,60
 buffer_load_dword v251, v235, s[48:51], s9 offen offset:1408
 MF 184,164,60
 TR 236,233,21696
 MF 184,160,44
 MF 180,152,44
 TR 238,233,25280
 MF 180,156,60
 buffer_load_dword v252, v235, s[48:51], s9 offen offset:1536
 MF 176,148,60
 MF 176,144,44
 buffer_load_dword v253, v235, s[48:51], s9 offen offset:1664
 MF 172,136,44
 MF 172,140,60
 buffer_load_dword v254, v235, s[48:51], s9 offen offset:1792
 MF 168,132,60
 MF 168,128,44
 buffer_load_dword v255, v235, s[48:51], s9 offen offset:1920
 s_waitcnt vmcnt(60) lgkmcnt(0)
 s_barrier
 MF 28,184,32
 TR 128,232,0
 TR 130,232,3584
 MF 28,188,48
 MF 32,196,48
 TR 132,232,7168
 MF 32,192,32
 s_add_u32 m0, s46, 98304
 s_add_u32 s45, s45, 0xe0000
 WL 225,0
 MF 36,200,32
 TR 134,232,10752
 MF 36,204,48
 MF 40,212,48
 TR 136,232,32
 MF 40,208,32
 MF 44,216,32
 TR 138,232,3616
 MF 44,220,48
 MF 48,228,48
 TR 140,232,7200
 MF 48,224,32
 WL 226,1024
 MF 52,232,32
 TR 142,232,10784
 MF 52,236,48
 MF 108,236,52
 TR 144,232,64
 MF 108,232,36
 MF 104,224,36
 TR 146,232,3648
 TR 148,232,7232
 MF 104,228,52
 WL 227,2048
 MF 100,220,52
 TR 150,232,10816
 MF 100,216,36
 MF 96,208,36
 TR 152,232,96
 MF 96,212,52
 MF 92,204,52
 TR 154,232,3680
 MF 92,200,36
 MF 88,192,36
 TR 156,232,7264
 MF 88,196,52
 WL 228,3072
 s_add_u32 m0, s46, 102400
 MF 84,188,52
 TR 158,232,10848
 MF 84,184,36
 MF 140,184,40
 TR 160,232,128
 MF 140,188,56
 MF 144,196,56
 TR 162,232,3712
 MF 144,192,40
 WL 229,0
 MF 148,200,40
 TR 164,232,7296
 TR 166,232,10880
 MF 148,204,56
 MF 152,212,56
 TR 168,232,160
 MF 152,208,40
 MF 156,216,40
 TR 170,232,3744
 MF 156,220,56
 MF 160,228,56
 TR 172,232,7328
 MF 160,224,40
 WL 230,1024
 MF 164,232,40
 TR 174,232,10912
 MF 164,236,56
 MF 220,236,60
 TR 176,232,192
 MF 220,232,44
 MF 216,224,44
 TR 178,232,3776
 MF 216,228,60
 WL 231,2048
 MF 212,220,60
 TR 180,232,7360
 MF 212,216,44
 MF 208,208,44
 TR 182,232,10944
 MF 208,212,60
 MF 204,204,60
 MF 204,200,44
 MF 200,192,44
 MF 200,196,60
 buffer_load_dword v239, v238, s[40:43], s11 offen
 s_add_u32 s11, s11, 458752
 MF 196,188,60
 MF 196,184,44
 s_waitcnt vmcnt(59) lgkmcnt(0)
 MF 0,128,64
 TR 184,232,14336
 TR 186,232,17920
 MF 0,132,80
 MF 4,140,80
 TR 188,232,21504
 MF 4,136,64
 XL 32,237,0
 MF 8,144,64
 TR 190,232,25088
 MF 8,148,80
 MF 12,156,80
 TR 192,232,14368
 MF 12,152,64
 MF 16,160,64
 TR 194,232,17952
 MF 16,164,80
 MF 20,172,80
 TR 196,232,21536
 MF 20,168,64
 XL 36,237,1024
 MF 24,176,64
 TR 198,232,25120
 MF 24,180,80
 MF 80,180,84
 TR 200,232,14400
 MF 80,176,68
 MF 76,168,68
 TR 202,232,17984
 TR 204,232,21568
 MF 76,172,84
 XL 40,237,2048
 MF 72,164,84
 TR 206,232,25152
 MF 72,160,68
 MF 68,152,68
 TR 208,232,14432
 MF 68,156,84
 MF 64,148,84
 TR 210,232,18016
 MF 64,144,68
 MF 60,136,68
 TR 212,232,21600
 MF 60,140,84
 XL 44,237,3072
 s_add_u32 s44, s44, 4096
 MF 56,132,84
 TR 214,232,25184
 MF 56,128,68
 MF 112,128,72
 TR 216,232,14464
 MF 112,132,88
 MF 116,140,88
 TR 218,232,18048
 MF 116,136,72
 XL 48,237,0
 MF 120,144,72
 TR 220,232,21632
 TR 222,232,25216
 MF 120,148,88
 MF 124,156,88
 TR 224,232,14496
 MF 124,152,72
 MF 128,160,72
 TR 226,232,18080
 MF 128,164,88
 MF 132,172,88
 TR 228,232,21664
 MF 132,168,72
 XL 52,237,1024
 MF 136,176,72
 TR 230,232,25248
 MF 136,180,88
 MF 192,180,92
 TR 232,232,14528
 MF 192,176,76
 MF 188,168,76
 TR 234,232,18112
 MF 188,172,92
 XL 56,237,2048
 MF 184,164,92
 TR 236,232,21696
 MF 184,160,76
 MF 180,152,76
 TR 238,232,25280
 MF 180,156,92
 MF 176,148,92
 MF 176,144,76
 MF 172,136,76
 MF 172,140,92
 XL 60,237,3072
 s_add_u32 s44, s44, 4096
 MF 168,132,92
 MF 168,128,76
 s_waitcnt vmcnt(59) lgkmcnt(0)
 s_barrier
 MF 28,184,64
 TR 128,232,28672
 TR 130,232,32256
 MF 28,188,80
 MF 32,196,80
 TR 132,232,35840
 MF 32,192,64
 MF 36,200,64
 TR 134,232,39424
 MF 36,204,80
 s_add_u32 m0, s46, 0
 s_add_u32 s45, s45, 0xe0000
 WL 225,0
 MF 40,212,80
 TR 136,232,28704
 MF 40,208,64
 MF 44,216,64
 TR 138,232,32288
 MF 44,220,80
 MF 48,228,80
 TR 140,232,35872
 MF 48,224,64
 MF 52,232,64
 TR 142,232,39456
 MF 52,236,80
 WL 226,1024
 MF 108,236,84
 TR 144,232,28736
 MF 108,232,68
 MF 104,224,68
 TR 146,232,32320
 TR 148,232,35904
 MF 104,228,84
 MF 100,220,84
 TR 150,232,39488
 MF 100,216,68
 MF 96,208,68
 TR 152,232,28768
 MF 96,212,84
 WL 227,2048
 MF 92,204,84
 TR 154,232,32352
 MF 92,200,68
 MF 88,192,68
 TR 156,232,35936
 MF 88,196,84
 MF 84,188,84
 TR 158,232,39520
 MF 84,184,68
 MF 140,184,72
 TR 160,232,28800
 MF 140,188,88
 WL 228,3072
 s_add_u32 m0, s46, 4096
 MF 144,196,88
 TR 162,232,32384
 MF 144,192,72
 MF 148,200,72
 TR 164,232,35968
 TR 166,232,39552
 MF 148,204,88
 MF 152,212,88
 TR 168,232,28832
 MF 152,208,72
 MF 156,216,72
 TR 170,232,32416
 MF 156,220,88
 WL 229,0
 MF 160,228,88
 TR 172,232,36000
 MF 160,224,72
 MF 164,232,72
 TR 174,232,39584
 MF 164,236,88
 MF 220,236,92
 TR 176,232,28864
 MF 220,232,76
 MF 216,224,76
 TR 178,232,32448
 MF 216,228,92
 WL 230,1024
 MF 212,220,92
 TR 180,232,36032
 MF 212,216,76
 MF 208,208,76
 TR 182,232,39616
 MF 208,212,92
 MF 204,204,92
 MF 204,200,76
 MF 200,192,76
 MF 200,196,92
 WL 231,2048
 MF 196,188,92
 MF 196,184,76
 s_waitcnt vmcnt(23) lgkmcnt(0)
 MF 0,128,96
 TR 184,232,43008
 TR 186,232,46592
 MF 0,132,112
 v_add_f32 v240, v240, v248
 v_add_f32 v241, v241, v249
 MF 4,140,112
 TR 188,232,50176
 v_add_f32 v242, v242, v250
 MF 4,136,96
 XL 64,237,0
 MF 8,144,96
 TR 190,232,53760
 v_add_f32 v243, v243, v251
 MF 8,148,112
 v_add_f32 v244, v244, v252
 v_add_f32 v245, v245, v253
 MF 12,156,112
 TR 192,232,43040
 v_add_f32 v246, v246, v254
 MF 12,152,96
 v_add_f32 v247, v247, v255
 v_add_f32 v240, v240, v244
 MF 16,160,96
 TR 194,232,46624
 v_add_f32 v241, v241, v245
 MF 16,164,112
 XL 68,237,1024
 MF 20,172,112
 TR 196,232,50208
 v_add_f32 v242, v242, v246
 MF 20,168,96
 v_add_f32 v243, v243, v247
 v_add_f32 v240, v240, v242
 MF 24,176,96
 TR 198,232,53792
 v_add_f32 v241, v241, v243
 MF 24,180,112
 v_add_f32 v240, v240, v241
 v_mov_b32 v248, 0x3727c5ac
 MF 80,180,116
 TR 200,232,43072
 v_fmac_f32 v248, 0x3a800000, v240
 MF 80,176,100
 XL 72,237,2048
 MF 76,168,100
 TR 202,232,46656
 TR 204,232,50240
 MF 76,172,116
 ds_bpermute_b32 v240, v236, v248 offset:0
 ds_bpermute_b32 v241, v236, v248 offset:64
 MF 72,164,116
 TR 206,232,53824
 ds_bpermute_b32 v242, v236, v248 offset:128
 MF 72,160,100
 ds_bpermute_b32 v243, v236, v248 offset:192
 MF 68,152,100
 TR 208,232,43104
 MF 68,156,116
 XL 76,237,3072
 s_add_u32 s44, s44, 4096
 MF 64,148,116
 TR 210,232,46688
 MF 64,144,100
 MF 60,136,100
 TR 212,232,50272
 MF 60,140,116
 MF 56,132,116
 TR 214,232,53856
 MF 56,128,100
 MF 112,128,104
 TR 216,232,43136
 MF 112,132,120
 XL 80,237,0
 MF 116,140,120
 TR 218,232,46720
 MF 116,136,104
 MF 120,144,104
 TR 220,232,50304
 TR 222,232,53888
 MF 120,148,120
 MF 124,156,120
 TR 224,232,43168
 MF 124,152,104
 XL 84,237,1024
 MF 128,160,104
 TR 226,232,46752
 MF 128,164,120
 MF 132,172,120
 TR 228,232,50336
 MF 132,168,104
 MF 136,176,104
 TR 230,232,53920
 MF 136,180,120
 XL 88,237,2048
 MF 192,180,124
 TR 232,232,43200
 MF 192,176,108
 MF 188,168,108
 TR 234,232,46784
 MF 188,172,124
 MF 184,164,124
 TR 236,232,50368
 MF 184,160,108
 XL 92,237,3072
 s_add_u32 s44, s44, 4096
 MF 180,152,108
 TR 238,232,53952
 MF 180,156,124
 MF 176,148,124
 MF 176,144,108
 MF 172,136,108
 MF 172,140,124
 buffer_load_dword v239, v234, s[52:55], s12 offen
 s_add_u32 s12, s12, 65536
 MF 168,132,124
 MF 168,128,108
 s_waitcnt vmcnt(58) lgkmcnt(0)
 s_barrier
 MF 28,184,96
 TR 128,233,32768
 TR 130,233,36352
 MF 28,188,112
 v_rsq_f32 v244, v240
 MF 32,196,112
 TR 132,233,39936
 MF 32,192,96
 s_add_u32 m0, s46, 28672
 s_add_u32 s45, s45, 0xe0000
 WL 225,0
 MF 36,200,96
 TR 134,233,43520
 MF 36,204,112
 v_rcp_f32 v245, v240
 s_branch L_sequential_preLN__sliding_local_dilated__geglu_ffn__prompt_kernel_pg12_skip
.p2align 12
L_sequential_preLN__sliding_local_dilated__geglu_ffn__prompt_kernel_pg12:
 s_branch L_sequential_preLN__sliding_local_dilated__geglu_ffn__prompt_kernel_pg16
L_sequential_preLN__sliding_local_dilated__geglu_ffn__prompt_kernel_pg12b:
 s_branch L_sequential_preLN__sliding_local_dilated__geglu_ffn__prompt_kernel_sp_ret
L_sequential_preLN__sliding_local_dilated__geglu_ffn__prompt_kernel_pg12_skip:
 MF 40,212,112
 TR 136,233,32800
 MF 40,208,96
 v_rsq_f32 v246, v241
 MF 44,216,96
 TR 138,233,36384
 MF 44,220,112
 v_rcp_f32 v247, v241
 MF 48,228,112
 TR 140,233,39968
 MF 48,224,96
 WL 226,1024
 MF 52,232,96
 TR 142,233,43552
 MF 52,236,112
 v_rsq_f32 v248, v242
 MF 108,236,116
 TR 144,233,32832
 MF 108,232,100
 v_rcp_f32 v249, v242
 MF 104,224,100
 TR 146,233,36416
 TR 148,233,40000
 MF 104,228,116
 WL 227,2048
 MF 100,220,116
 TR 150,233,43584
 MF 100,216,100
 v_rsq_f32 v250, v243
 MF 96,208,100
 TR 152,233,32864
 MF 96,212,116
 v_rcp_f32 v251, v243
 MF 92,204,116
 TR 154,233,36448
 v_mul_f32 v245, v245, v244
 MF 92,200,100
 v_mul_f32 v244, 0xc0135761, v244
 v_mul_f32 v245, 0xbdd2d3e8, v245
 MF 88,192,100
 TR 156,233,40032
 v_mul_f32 v247, v247, v246
 MF 88,196,116
 WL 228,3072
 s_add_u32 m0, s46, 32768
 MF 84,188,116
 TR 158,233,43616
 v_mul_f32 v246, 0xc0135761, v246
 MF 84,184,100
 v_mul_f32 v247, 0xbdd2d3e8, v247
 v_mul_f32 v249, v249, v248
 MF 140,184,104
 TR 160,233,32896
 v_mul_f32 v248, 0xc0135761, v248
 MF 140,188,120
 v_mul_f32 v249, 0xbdd2d3e8, v249
 v_mul_f32 v251, v251, v250
 MF 144,196,120
 TR 162,233,36480
 v_mul_f32 v250, 0xc0135761, v250
 MF 144,192,104
 WL 229,0
 MF 148,200,104
 TR 164,233,40064
 TR 166,233,43648
 MF 148,204,120
 v_mul_f32 v251, 0xbdd2d3e8, v251
 MF 152,212,120
 TR 168,233,32928
 MF 152,208,104
 MF 156,216,104
 TR 170,233,36512
 MF 156,220,120
 MF 160,228,120
 TR 172,233,40096
 MF 160,224,104
 WL 230,1024
 MF 164,232,104
 TR 174,233,43680
 MF 164,236,120
 MF 220,236,124
 TR 176,233,32960
 MF 220,232,108
 MF 216,224,108
 TR 178,233,36544
 MF 216,228,124
 WL 231,2048
 MF 212,220,124
 TR 180,233,40128
 MF 212,216,108
 MF 208,208,108
 TR 182,233,43712
 MF 208,212,124
 MF 204,204,124
 MF 204,200,108
 MF 200,192,108
 MF 200,196,124
 buffer_load_dword v239, v234, s[52:55], s12 offen
 s_add_u32 s12, s12, 65536
 MF 196,188,124
 MF 196,184,108
 s_waitcnt vmcnt(57) lgkmcnt(0)
 MF 0,128,0
 TR 184,233,47104
 TR 186,233,50688
 MF 0,132,16
 MF 4,140,16
 TR 188,233,54272
 MF 4,136,0
 XL 96,237,0
 MF 8,144,0
 TR 190,233,57856
 MF 8,148,16
 MF 12,156,16
 TR 192,233,47136
 MF 12,152,0
 MF 16,160,0
 TR 194,233,50720
 MF 16,164,16
 XL 100,237,1024
 MF 20,172,16
 TR 196,233,54304
 MF 20,168,0
 MF 24,176,0
 TR 198,233,57888
 MF 24,180,16
 MF 80,180,20
 TR 200,233,47168
 MF 80,176,4
 XL 104,237,2048
 MF 76,168,4
 TR 202,233,50752
 TR 204,233,54336
 MF 76,172,20
 MF 72,164,20
 TR 206,233,57920
 MF 72,160,4
 MF 68,152,4
 TR 208,233,47200
 MF 68,156,20
 XL 108,237,3072
 s_add_u32 s44, s44, 4096
 MF 64,148,20
 TR 210,233,50784
 MF 64,144,4
 MF 60,136,4
 TR 212,233,54368
 MF 60,140,20
 MF 56,132,20
 TR 214,233,57952
 MF 56,128,4
 MF 112,128,8
 TR 216,233,47232
 MF 112,132,24
 XL 112,237,0
 MF 116,140,24
 TR 218,233,50816
 MF 116,136,8
 MF 120,144,8
 TR 220,233,54400
 TR 222,233,57984
 MF 120,148,24
 MF 124,156,24
 TR 224,233,47264
 MF 124,152,8
 XL 116,237,1024
 MF 128,160,8
 TR 226,233,50848
 MF 128,164,24
 MF 132,172,24
 TR 228,233,54432
 MF 132,168,8
 MF 136,176,8
 TR 230,233,58016
 MF 136,180,24
 XL 120,237,2048
 MF 192,180,28
 TR 232,233,47296
 MF 192,176,12
 MF 188,168,12
 TR 234,233,50880
 MF 188,172,28
 MF 184,164,28
 TR 236,233,54464
 MF 184,160,12
 XL 124,237,3072
 s_add_u32 s44, s44, 4096
 MF 180,152,12
 TR 238,233,58048
 MF 180,156,28
 MF 176,148,28
 MF 176,144,12
 MF 172,136,12
 MF 172,140,28
 buffer_load_dword v239, v234, s[52:55], s12 offen
 s_mov_b32 s12, s76
 MF 168,132,28
 MF 168,128,12
 s_waitcnt vmcnt(26) lgkmcnt(0)
 s_barrier
 MF 28,184,0
 TR 128,233,0
 MF 28,188,16
 MF 32,196,16
 MF 32,192,0
 MF 36,200,0
 TR 130,233,3584
 MF 36,204,16
 MF 40,212,16
 MF 40,208,0
 MF 44,216,0
 TR 132,233,14336
 MF 44,220,16
 MF 48,228,16
 MF 48,224,0
 MF 52,232,0
 TR 134,233,17920
 MF 52,236,16
 MF 108,236,20
 MF 108,232,4
 MF 104,224,4
 TR 136,233,7168
 MF 104,228,20
 MF 100,220,20
 MF 100,216,4
 MF 96,208,4
 TR 138,233,10752
 MF 96,212,20
 MF 92,204,20
 MF 92,200,4
 MF 88,192,4
 TR 140,233,21504
 MF 88,196,20
 MF 84,188,20
 MF 84,184,4
 MF 140,184,8
 TR 142,233,25088
 MF 140,188,24
 buffer_load_dword v239, v234, s[52:55], s12 offen
 s_mov_b32 s12, s76
 MF 144,196,24
 MF 144,192,8
 MF 148,200,8
 TR 144,232,0
 MF 148,204,24
 MF 152,212,24
 MF 152,208,8
 MF 156,216,8
 TR 146,232,3584
 MF 156,220,24
 MF 160,228,24
 MF 160,224,8
 MF 164,232,8
 TR 148,232,14336
 MF 164,236,24
 MF 220,236,28
 MF 220,232,12
 MF 216,224,12
 TR 150,232,17920
 MF 216,228,28
 MF 212,220,28
 MF 212,216,12
 MF 208,208,12
 MF 208,212,28
 MF 204,204,28
 MF 204,200,12
 MF 200,192,12
 MF 200,196,28
 MF 196,188,28
 MF 196,184,12
 s_waitcnt vmcnt(11) lgkmcnt(0)
 s_barrier
 MF 0,128,32
 TR 184,232,7168
 MF 0,136,48
 TR 186,232,10752
 MF 0,144,64
 v_lshrrev_b32 v226, 8, v224
 v_bfe_u32 v228, v224, 5, 3
 v_xor_b32 v228, v228, v226
 MF 56,144,68
 TR 188,232,21504
 MF 56,136,52
 TR 190,232,25088
 MF 56,128,36
 v_xor_b32 v230, 4, v228
 v_and_b32 v238, 16, v224
 v_lshl_add_u32 v226, s7, 4, v226
 v_lshl_add_u32 v238, v226, 11, v238
 s_lshl_b32 s45, s73, 8
 s_mul_i32 s46, s74, 3670016
 MF 112,128,40
 TR 192,232,28672
 MF 112,136,56
 TR 194,232,32256
 MF 112,144,72
 s_add_u32 s45, s45, s46
 s_add_u32 s45, s45, s69
 v_add_u32 v238, s45, v238
 MF 168,144,76
 TR 196,232,43008
 MF 168,136,60
 TR 198,232,46592
 MF 168,128,44
 v_lshl_add_u32 v225, v228, 5, v238
 v_lshl_add_u32 v227, v230, 5, v238
 v_add_u32 v229, 14336, v225
 v_add_u32 v231, 21504, v227
 v_add_u32 v227, 7168, v227
 s_mov_b32 s45, 0
 MF 196,132,44
 TR 200,232,35840
 MF 196,140,60
 TR 202,232,39424
 MF 196,148,76
 s_lshl_b32 s46, s7, 12
 s_mov_b32 s40, s28
 s_mov_b32 s41, s29
 MF 140,148,72
 TR 204,232,50176
 MF 140,140,56
 TR 206,232,53760
 MF 140,132,40
 s_mov_b32 s42, 7340032
 v_lshrrev_b32 v226, 1, v224
 v_mov_b32 v228, 0
 v_mov_b32 v230, s96
 s_mov_b32 s36, s56
 s_mov_b32 s37, s57
 MF 84,132,36
 MF 84,140,52
 MF 84,148,68
 s_mov_b32 s38, 14680064
 s_mov_b32 s44, 0
 MF 28,148,64
 MF 28,140,48
 MF 28,132,32
 s_add_u32 m0, s46, 65536
 s_add_u32 s45, s45, 0x0
 WL 225,0
 WL 227,1024
 s_waitcnt vmcnt(4) lgkmcnt(0)
 MF 0,184,80
 TR 128,233,32
 MF 0,192,96
 TR 130,233,3616
 MF 0,200,112
 MF 56,200,116
 TR 132,233,14368
 MF 56,192,100
 TR 134,233,17952
 MF 56,184,84
 MF 112,184,88
 TR 136,233,7200
 MF 112,192,104
 TR 138,233,10784
 MF 112,200,120
 WL 229,2048
 MF 168,200,124
 TR 140,233,21536
 MF 168,192,108
 TR 142,233,25120
 MF 168,184,92
 MF 196,188,92
 TR 144,232,32
 MF 196,196,108
 TR 146,232,3616
 MF 196,204,124
 MF 140,204,120
 TR 148,232,14368
 MF 140,196,104
 TR 150,232,17952
 MF 140,188,88
 MF 84,188,84
 MF 84,196,100
 MF 84,204,116
 WL 231,3072
 MF 28,204,112
 MF 28,196,96
 MF 28,188,80
 s_waitcnt lgkmcnt(0)
 MF 4,128,32
 TR 184,232,7200
 MF 4,136,48
 TR 186,232,10784
 MF 4,144,64
 v_pk_mul_f32 v[252:253], v[0:1], v[0:1]
 v_pk_mul_f32 v[254:255], v[2:3], v[2:3]
 v_pk_mul_f32 v[234:235], v[56:57], v[56:57]
 v_pk_mul_f32 v[236:237], v[58:59], v[58:59]
 v_pk_fma_f32 v[252:253], v[252:253], v[244:245], v[244:245] op_sel:[0,1,0] op_sel_hi:[1,1,0]
 v_pk_fma_f32 v[254:255], v[254:255], v[244:245], v[244:245] op_sel:[0,1,0] op_sel_hi:[1,1,0]
 v_pk_fma_f32 v[234:235], v[234:235], v[246:247], v[246:247] op_sel:[0,1,0] op_sel_hi:[1,1,0]
 v_pk_fma_f32 v[236:237], v[236:237], v[246:247], v[246:247] op_sel:[0,1,0] op_sel_hi:[1,1,0]
 v_pk_mul_f32 v[28:29], v[28:29], v[0:1]
 v_pk_mul_f32 v[30:31], v[30:31], v[2:3]
 v_pk_mul_f32 v[84:85], v[84:85], v[56:57]
 v_pk_mul_f32 v[86:87], v[86:87], v[58:59]
 v_pk_mul_f32 v[0:1], v[252:253], v[0:1]
 v_pk_mul_f32 v[2:3], v[254:255], v[2:3]
 v_pk_mul_f32 v[56:57], v[234:235], v[56:57]
 v_pk_mul_f32 v[58:59], v[236:237], v[58:59]
 v_pk_mul_f32 v[252:253], v[112:113], v[112:113]
 v_pk_mul_f32 v[254:255], v[114:115], v[114:115]
 v_pk_mul_f32 v[234:235], v[168:169], v[168:169]
 v_pk_mul_f32 v[236:237], v[170:171], v[170:171]
 v_pk_fma_f32 v[252:253], v[252:253], v[248:249], v[248:249] op_sel:[0,1,0] op_sel_hi:[1,1,0]
 v_pk_fma_f32 v[254:255], v[254:255], v[248:249], v[248:249] op_sel:[0,1,0] op_sel_hi:[1,1,0]
 v_pk_fma_f32 v[234:235], v[234:235], v[250:251], v[250:251] op_sel:[0,1,0] op_sel_hi:[1,1,0]
 v_pk_fma_f32 v[236:237], v[236:237], v[250:251], v[250:251] op_sel:[0,1,0] op_sel_hi:[1,1,0]
 v_pk_mul_f32 v[140:141], v[140:141], v[112:113]
 v_pk_mul_f32 v[142:143], v[142:143], v[114:115]
 v_pk_mul_f32 v[196:197], v[196:197], v[168:169]
 v_pk_mul_f32 v[198:199], v[198:199], v[170:171]
 v_pk_mul_f32 v[112:113], v[252:253], v[112:113]
 v_pk_mul_f32 v[114:115], v[254:255], v[114:115]
 v_pk_mul_f32 v[168:169], v[234:235], v[168:169]
 v_pk_mul_f32 v[170:171], v[236:237], v[170:171]
 v_exp_f32 v0, v0
 s_nop 0
 MF 60,144,68
 TR 188,232,21536
 v_exp_f32 v1, v1
 MF 60,136,52
 TR 190,232,25120
 v_exp_f32 v2, v2
 MF 60,128,36
 v_exp_f32 v3, v3
 MF 116,128,40
 TR 192,232,28704
 v_exp_f32 v56, v56
 MF 116,136,56
 TR 194,232,32288
 v_exp_f32 v57, v57
 MF 116,144,72
 s_add_u32 m0, s46, 81920
 s_add_u32 s45, s45, 0x70000
 WL 225,0
 MF 172,144,76
 TR 196,232,43040
 v_exp_f32 v58, v58
 MF 172,136,60
 TR 198,232,46624
 v_exp_f32 v59, v59
 MF 172,128,44
 v_exp_f32 v112, v112
 MF 200,132,44
 TR 200,232,35872
 v_exp_f32 v113, v113
 MF 200,140,60
 TR 202,232,39456
 v_exp_f32 v114, v114
 MF 200,148,76
 v_exp_f32 v115, v115
 MF 144,148,72
 TR 204,232,50208
 v_exp_f32 v168, v168
 MF 144,140,56
 TR 206,232,53792
 v_exp_f32 v169, v169
 MF 144,132,40
 v_exp_f32 v170, v170
 MF 88,132,36
 v_exp_f32 v171, v171
 MF 88,140,52
 MF 88,148,68
 WL 227,1024
 MF 32,148,64
 MF 32,140,48
 MF 32,132,32
 s_waitcnt lgkmcnt(0)
 MF 4,184,80
 TR 128,233,64
 MF 4,192,96
 TR 130,233,3648
 v_pk_fma_f32 v[0:1], v[0:1], v[240:241], v[240:241] op_sel:[0,0,0] op_sel_hi:[1,0,0]
 v_pk_fma_f32 v[2:3], v[2:3], v[240:241], v[240:241] op_sel:[0,0,0] op_sel_hi:[1,0,0]
 v_pk_fma_f32 v[56:57], v[56:57], v[240:241], v[240:241] op_sel:[0,1,1] op_sel_hi:[1,1,1]
 v_pk_fma_f32 v[58:59], v[58:59], v[240:241], v[240:241] op_sel:[0,1,1] op_sel_hi:[1,1,1]
 v_pk_fma_f32 v[112:113], v[112:113], v[242:243], v[242:243] op_sel:[0,0,0] op_sel_hi:[1,0,0]
 v_pk_fma_f32 v[114:115], v[114:115], v[242:243], v[242:243] op_sel:[0,0,0] op_sel_hi:[1,0,0]
 v_pk_fma_f32 v[168:169], v[168:169], v[242:243], v[242:243] op_sel:[0,1,1] op_sel_hi:[1,1,1]
 v_pk_fma_f32 v[170:171], v[170:171], v[242:243], v[242:243] op_sel:[0,1,1] op_sel_hi:[1,1,1]
 v_rcp_f32 v0, v0
 s_nop 0
 MF 4,200,112
 v_rcp_f32 v1, v1
 MF 60,200,116
 TR 132,233,14400
 v_rcp_f32 v2, v2
 MF 60,192,100
 TR 134,233,17984
 v_rcp_f32 v3, v3
 MF 60,184,84
 v_rcp_f32 v56, v56
 MF 116,184,88
 TR 136,233,7232
 v_rcp_f32 v57, v57
 MF 116,192,104
 TR 138,233,10816
 v_rcp_f32 v58, v58
 MF 116,200,120
 WL 229,2048
 MF 172,200,124
 TR 140,233,21568
 v_rcp_f32 v59, v59
 MF 172,192,108
 TR 142,233,25152
 v_rcp_f32 v112, v112
 MF 172,184,92
 v_rcp_f32 v113, v113
 MF 200,188,92
 TR 144,232,64
 v_rcp_f32 v114, v114
 MF 200,196,108
 TR 146,232,3648
 v_rcp_f32 v115, v115
 MF 200,204,124
 v_rcp_f32 v168, v168
 MF 144,204,120
 TR 148,232,14400
 v_rcp_f32 v169, v169
 MF 144,196,104
 TR 150,232,17984
 v_rcp_f32 v170, v170
 MF 144,188,88
 v_rcp_f32 v171, v171
 v_pk_mul_f32 v[28:29], v[28:29], v[0:1]
 v_pk_mul_f32 v[30:31], v[30:31], v[2:3]
 v_pk_mul_f32 v[84:85], v[84:85], v[56:57]
 v_pk_mul_f32 v[86:87], v[86:87], v[58:59]
 v_pk_mul_f32 v[140:141], v[140:141], v[112:113]
 v_pk_mul_f32 v[142:143], v[142:143], v[114:115]
 v_pk_mul_f32 v[196:197], v[196:197], v[168:169]
 v_pk_mul_f32 v[198:199], v[198:199], v[170:171]
 v_cvt_pk_bf16_f32 v0, v28, v29
 s_nop 0
 MF 88,188,84
 v_cvt_pk_bf16_f32 v1, v30, v31
 v_cvt_pk_bf16_f32 v56, v84, v85
 v_cvt_pk_bf16_f32 v57, v86, v87
 MF 88,196,100
 v_cvt_pk_bf16_f32 v112, v140, v141
 v_cvt_pk_bf16_f32 v113, v142, v143
 v_cvt_pk_bf16_f32 v168, v196, v197
 MF 88,204,116
 WL 231,3072
 s_branch L_sequential_preLN__sliding_local_dilated__geglu_ffn__prompt_kernel_pg13_skip
.p2align 12
L_sequential_preLN__sliding_local_dilated__geglu_ffn__prompt_kernel_pg13:
 s_branch L_sequential_preLN__sliding_local_dilated__geglu_ffn__prompt_kernel_pg17
L_sequential_preLN__sliding_local_dilated__geglu_ffn__prompt_kernel_pg13b:
 s_branch L_sequential_preLN__sliding_local_dilated__geglu_ffn__prompt_kernel_sp_ret
L_sequential_preLN__sliding_local_dilated__geglu_ffn__prompt_kernel_pg13_skip:
 v_cvt_pk_bf16_f32 v169, v198, v199
 MF 32,204,112
 MF 32,196,96
 MF 32,188,80
 s_waitcnt lgkmcnt(0)
 MF 8,128,32
 TR 184,232,7232
 MF 8,136,48
 TR 186,232,10816
 MF 8,144,64
 v_pk_mul_f32 v[252:253], v[4:5], v[4:5]
 v_pk_mul_f32 v[254:255], v[6:7], v[6:7]
 v_pk_mul_f32 v[234:235], v[60:61], v[60:61]
 v_pk_mul_f32 v[236:237], v[62:63], v[62:63]
 v_pk_fma_f32 v[252:253], v[252:253], v[244:245], v[244:245] op_sel:[0,1,0] op_sel_hi:[1,1,0]
 v_pk_fma_f32 v[254:255], v[254:255], v[244:245], v[244:245] op_sel:[0,1,0] op_sel_hi:[1,1,0]
 v_pk_fma_f32 v[234:235], v[234:235], v[246:247], v[246:247] op_sel:[0,1,0] op_sel_hi:[1,1,0]
 v_pk_fma_f32 v[236:237], v[236:237], v[246:247], v[246:247] op_sel:[0,1,0] op_sel_hi:[1,1,0]
 v_pk_mul_f32 v[32:33], v[32:33], v[4:5]
 v_pk_mul_f32 v[34:35], v[34:35], v[6:7]
 v_pk_mul_f32 v[88:89], v[88:89], v[60:61]
 v_pk_mul_f32 v[90:91], v[90:91], v[62:63]
 v_pk_mul_f32 v[4:5], v[252:253], v[4:5]
 v_pk_mul_f32 v[6:7], v[254:255], v[6:7]
 v_pk_mul_f32 v[60:61], v[234:235], v[60:61]
 v_pk_mul_f32 v[62:63], v[236:237], v[62:63]
 v_pk_mul_f32 v[252:253], v[116:117], v[116:117]
 v_pk_mul_f32 v[254:255], v[118:119], v[118:119]
 v_pk_mul_f32 v[234:235], v[172:173], v[172:173]
 v_pk_mul_f32 v[236:237], v[174:175], v[174:175]
 v_pk_fma_f32 v[252:253], v[252:253], v[248:249], v[248:249] op_sel:[0,1,0] op_sel_hi:[1,1,0]
 v_pk_fma_f32 v[254:255], v[254:255], v[248:249], v[248:249] op_sel:[0,1,0] op_sel_hi:[1,1,0]
 v_pk_fma_f32 v[234:235], v[234:235], v[250:251], v[250:251] op_sel:[0,1,0] op_sel_hi:[1,1,0]
 v_pk_fma_f32 v[236:237], v[236:237], v[250:251], v[250:251] op_sel:[0,1,0] op_sel_hi:[1,1,0]
 v_pk_mul_f32 v[144:145], v[144:145], v[116:117]
 v_pk_mul_f32 v[146:147], v[146:147], v[118:119]
 v_pk_mul_f32 v[200:201], v[200:201], v[172:173]
 v_pk_mul_f32 v[202:203], v[202:203], v[174:175]
 v_pk_mul_f32 v[116:117], v[252:253], v[116:117]
 v_pk_mul_f32 v[118:119], v[254:255], v[118:119]
 v_pk_mul_f32 v[172:173], v[234:235], v[172:173]
 v_pk_mul_f32 v[174:175], v[236:237], v[174:175]
 v_exp_f32 v4, v4
 s_nop 0
 MF 64,144,68
 TR 188,232,21568
 v_exp_f32 v5, v5
 MF 64,136,52
 TR 190,232,25152
 v_exp_f32 v6, v6
 MF 64,128,36
 v_exp_f32 v7, v7
 MF 120,128,40
 TR 192,232,28736
 v_exp_f32 v60, v60
 MF 120,136,56
 TR 194,232,32320
 v_exp_f32 v61, v61
 MF 120,144,72
 s_add_u32 m0, s46, 131072
 s_add_u32 s45, s45, 0x70000
 WL 225,0
 MF 176,144,76
 TR 196,232,43072
 v_exp_f32 v62, v62
 MF 176,136,60
 TR 198,232,46656
 v_exp_f32 v63, v63
 MF 176,128,44
 v_exp_f32 v116, v116
 MF 204,132,44
 TR 200,232,35904
 v_exp_f32 v117, v117
 MF 204,140,60
 TR 202,232,39488
 v_exp_f32 v118, v118
 MF 204,148,76
 v_exp_f32 v119, v119
 MF 148,148,72
 TR 204,232,50240
 v_exp_f32 v172, v172
 MF 148,140,56
 TR 206,232,53824
 v_exp_f32 v173, v173
 MF 148,132,40
 v_exp_f32 v174, v174
 MF 92,132,36
 v_exp_f32 v175, v175
 MF 92,140,52
 MF 92,148,68
 WL 227,1024
 MF 36,148,64
 MF 36,140,48
 MF 36,132,32
 s_waitcnt lgkmcnt(0)
 MF 8,184,80
 TR 128,233,96
 MF 8,192,96
 TR 130,233,3680
 v_pk_fma_f32 v[4:5], v[4:5], v[240:241], v[240:241] op_sel:[0,0,0] op_sel_hi:[1,0,0]
 v_pk_fma_f32 v[6:7], v[6:7], v[240:241], v[240:241] op_sel:[0,0,0] op_sel_hi:[1,0,0]
 v_pk_fma_f32 v[60:61], v[60:61], v[240:241], v[240:241] op_sel:[0,1,1] op_sel_hi:[1,1,1]
 v_pk_fma_f32 v[62:63], v[62:63], v[240:241], v[240:241] op_sel:[0,1,1] op_sel_hi:[1,1,1]
 v_pk_fma_f32 v[116:117], v[116:117], v[242:243], v[242:243] op_sel:[0,0,0] op_sel_hi:[1,0,0]
 v_pk_fma_f32 v[118:119], v[118:119], v[242:243], v[242:243] op_sel:[0,0,0] op_sel_hi:[1,0,0]
 v_pk_fma_f32 v[172:173], v[172:173], v[242:243], v[242:243] op_sel:[0,1,1] op_sel_hi:[1,1,1]
 v_pk_fma_f32 v[174:175], v[174:175], v[242:243], v[242:243] op_sel:[0,1,1] op_sel_hi:[1,1,1]
 v_rcp_f32 v4, v4
 s_nop 0
 MF 8,200,112
 v_rcp_f32 v5, v5
 MF 64,200,116
 TR 132,233,14432
 v_rcp_f32 v6, v6
 MF 64,192,100
 TR 134,233,18016
 v_rcp_f32 v7, v7
 MF 64,184,84
 v_rcp_f32 v60, v60
 MF 120,184,88
 TR 136,233,7264
 v_rcp_f32 v61, v61
 MF 120,192,104
 TR 138,233,10848
 v_rcp_f32 v62, v62
 MF 120,200,120
 WL 229,2048
 MF 176,200,124
 TR 140,233,21600
 v_rcp_f32 v63, v63
 MF 176,192,108
 TR 142,233,25184
 v_rcp_f32 v116, v116
 MF 176,184,92
 v_rcp_f32 v117, v117
 MF 204,188,92
 TR 144,232,96
 v_rcp_f32 v118, v118
 MF 204,196,108
 TR 146,232,3680
 v_rcp_f32 v119, v119
 MF 204,204,124
 v_rcp_f32 v172, v172
 MF 148,204,120
 TR 148,232,14432
 v_rcp_f32 v173, v173
 MF 148,196,104
 TR 150,232,18016
 v_rcp_f32 v174, v174
 MF 148,188,88
 v_rcp_f32 v175, v175
 v_pk_mul_f32 v[32:33], v[32:33], v[4:5]
 v_pk_mul_f32 v[34:35], v[34:35], v[6:7]
 v_pk_mul_f32 v[88:89], v[88:89], v[60:61]
 v_pk_mul_f32 v[90:91], v[90:91], v[62:63]
 v_pk_mul_f32 v[144:145], v[144:145], v[116:117]
 v_pk_mul_f32 v[146:147], v[146:147], v[118:119]
 v_pk_mul_f32 v[200:201], v[200:201], v[172:173]
 v_pk_mul_f32 v[202:203], v[202:203], v[174:175]
 v_cvt_pk_bf16_f32 v2, v32, v33
 s_nop 0
 MF 92,188,84
 v_cvt_pk_bf16_f32 v3, v34, v35
 buffer_store_dwordx4 v[0:3], v224, s[56:59], s64 offen offset:0 sc0 sc1
 MF 92,196,100
 v_cvt_pk_bf16_f32 v58, v88, v89
 v_cvt_pk_bf16_f32 v59, v90, v91
 MF 92,204,116
 WL 231,3072
 MF 36,204,112
 buffer_store_dwordx4 v[56:59], v224, s[56:59], s64 offen offset:1024 sc0 sc1
 s_add_u32 s64, s64, 32768
 v_cvt_pk_bf16_f32 v114, v144, v145
 MF 36,196,96
 v_cvt_pk_bf16_f32 v115, v146, v147
 buffer_store_dwordx4 v[112:115], v224, s[56:59], s65 offen offset:0 sc0 sc1
 MF 36,188,80
 v_cvt_pk_bf16_f32 v170, v200, v201
 v_cvt_pk_bf16_f32 v171, v202, v203
 buffer_store_dwordx4 v[168:171], v224, s[56:59], s65 offen offset:1024 sc0 sc1
 s_add_u32 s65, s65, 32768
 s_waitcnt lgkmcnt(0)
 MF 12,128,32
 TR 184,232,7264
 MF 12,136,48
 TR 186,232,10848
 MF 12,144,64
 v_pk_mul_f32 v[252:253], v[8:9], v[8:9]
 v_pk_mul_f32 v[254:255], v[10:11], v[10:11]
 v_pk_mul_f32 v[234:235], v[64:65], v[64:65]
 v_pk_mul_f32 v[236:237], v[66:67], v[66:67]
 v_pk_fma_f32 v[252:253], v[252:253], v[244:245], v[244:245] op_sel:[0,1,0] op_sel_hi:[1,1,0]
 v_pk_fma_f32 v[254:255], v[254:255], v[244:245], v[244:245] op_sel:[0,1,0] op_sel_hi:[1,1,0]
 v_pk_fma_f32 v[234:235], v[234:235], v[246:247], v[246:247] op_sel:[0,1,0] op_sel_hi:[1,1,0]
 v_pk_fma_f32 v[236:237], v[236:237], v[246:247], v[246:247] op_sel:[0,1,0] op_sel_hi:[1,1,0]
 v_pk_mul_f32 v[36:37], v[36:37], v[8:9]
 v_pk_mul_f32 v[38:39], v[38:39], v[10:11]
 v_pk_mul_f32 v[92:93], v[92:93], v[64:65]
 v_pk_mul_f32 v[94:95], v[94:95], v[66:67]
 v_pk_mul_f32 v[8:9], v[252:253], v[8:9]
 v_pk_mul_f32 v[10:11], v[254:255], v[10:11]
 v_pk_mul_f32 v[64:65], v[234:235], v[64:65]
 v_pk_mul_f32 v[66:67], v[236:237], v[66:67]
 v_pk_mul_f32 v[252:253], v[120:121], v[120:121]
 v_pk_mul_f32 v[254:255], v[122:123], v[122:123]
 v_pk_mul_f32 v[234:235], v[176:177], v[176:177]
 v_pk_mul_f32 v[236:237], v[178:179], v[178:179]
 v_pk_fma_f32 v[252:253], v[252:253], v[248:249], v[248:249] op_sel:[0,1,0] op_sel_hi:[1,1,0]
 v_pk_fma_f32 v[254:255], v[254:255], v[248:249], v[248:249] op_sel:[0,1,0] op_sel_hi:[1,1,0]
 v_pk_fma_f32 v[234:235], v[234:235], v[250:251], v[250:251] op_sel:[0,1,0] op_sel_hi:[1,1,0]
 v_pk_fma_f32 v[236:237], v[236:237], v[250:251], v[250:251] op_sel:[0,1,0] op_sel_hi:[1,1,0]
 v_pk_mul_f32 v[148:149], v[148:149], v[120:121]
 v_pk_mul_f32 v[150:151], v[150:151], v[122:123]
 v_pk_mul_f32 v[204:205], v[204:205], v[176:177]
 v_pk_mul_f32 v[206:207], v[206:207], v[178:179]
 v_pk_mul_f32 v[120:121], v[252:253], v[120:121]
 v_pk_mul_f32 v[122:123], v[254:255], v[122:123]
 v_pk_mul_f32 v[176:177], v[234:235], v[176:177]
 v_pk_mul_f32 v[178:179], v[236:237], v[178:179]
 v_exp_f32 v8, v8
 s_nop 0
 MF 68,144,68
 TR 188,232,21600
 v_exp_f32 v9, v9
 MF 68,136,52
 TR 190,232,25184
 v_exp_f32 v10, v10
 MF 68,128,36
 v_exp_f32 v11, v11
 MF 124,128,40
 TR 192,232,28768
 v_exp_f32 v64, v64
 MF 124,136,56
 TR 194,232,32352
 v_exp_f32 v65, v65
 MF 124,144,72
 s_add_u32 m0, s46, 147456
 s_add_u32 s45, s45, 0x70000
 WL 225,0
 MF 180,144,76
 TR 196,232,43104
 v_exp_f32 v66, v66
 MF 180,136,60
 TR 198,232,46688
 v_exp_f32 v67, v67
 MF 180,128,44
 v_exp_f32 v120, v120
 MF 208,132,44
 TR 200,232,35936
 v_exp_f32 v121, v121
 MF 208,140,60
 TR 202,232,39520
 v_exp_f32 v122, v122
 MF 208,148,76
 v_exp_f32 v123, v123
 MF 152,148,72
 TR 204,232,50272
 v_exp_f32 v176, v176
 MF 152,140,56
 TR 206,232,53856
 v_exp_f32 v177, v177
 MF 152,132,40
 v_exp_f32 v178, v178
 MF 96,132,36
 v_exp_f32 v179, v179
 s_mul_i32 s71, s75, 114688
 s_mul_i32 s13, s74, 114688
 s_add_u32 s71, s71, s13
 MF 96,140,52
 v_add_u32 v28, s71, v224
 v_add_u32 v29, s71, v226
 v_bfe_u32 v30, v224, 4, 4
 MF 96,148,68
 WL 227,1024
 v_lshlrev_b32 v30, 2, v30
 MF 40,148,64
 MF 40,140,48
 MF 40,132,32
 s_waitcnt vmcnt(2)
 v_add_u32 v230, 1, v230
 buffer_store_dword v230, v228, s[60:63], s68 offen sc0 sc1
 s_waitcnt lgkmcnt(0)
 MF 12,184,80
 TR 128,233,128
 MF 12,192,96
 TR 130,233,3712
 v_pk_fma_f32 v[8:9], v[8:9], v[240:241], v[240:241] op_sel:[0,0,0] op_sel_hi:[1,0,0]
 v_pk_fma_f32 v[10:11], v[10:11], v[240:241], v[240:241] op_sel:[0,0,0] op_sel_hi:[1,0,0]
 v_pk_fma_f32 v[64:65], v[64:65], v[240:241], v[240:241] op_sel:[0,1,1] op_sel_hi:[1,1,1]
 v_pk_fma_f32 v[66:67], v[66:67], v[240:241], v[240:241] op_sel:[0,1,1] op_sel_hi:[1,1,1]
 v_pk_fma_f32 v[120:121], v[120:121], v[242:243], v[242:243] op_sel:[0,0,0] op_sel_hi:[1,0,0]
 v_pk_fma_f32 v[122:123], v[122:123], v[242:243], v[242:243] op_sel:[0,0,0] op_sel_hi:[1,0,0]
 v_pk_fma_f32 v[176:177], v[176:177], v[242:243], v[242:243] op_sel:[0,1,1] op_sel_hi:[1,1,1]
 v_pk_fma_f32 v[178:179], v[178:179], v[242:243], v[242:243] op_sel:[0,1,1] op_sel_hi:[1,1,1]
 v_rcp_f32 v8, v8
 s_nop 0
 MF 12,200,112
 v_rcp_f32 v9, v9
 MF 68,200,116
 TR 132,233,14464
 v_rcp_f32 v10, v10
 MF 68,192,100
 TR 134,233,18048
 v_rcp_f32 v11, v11
 MF 68,184,84
 v_rcp_f32 v64, v64
 MF 124,184,88
 TR 136,233,7296
 v_rcp_f32 v65, v65
 MF 124,192,104
 TR 138,233,10880
 v_rcp_f32 v66, v66
 MF 124,200,120
 WL 229,2048
 MF 180,200,124
 TR 140,233,21632
 v_rcp_f32 v67, v67
 MF 180,192,108
 TR 142,233,25216
 v_rcp_f32 v120, v120
 MF 180,184,92
 v_rcp_f32 v121, v121
 MF 208,188,92
 TR 144,232,128
 v_rcp_f32 v122, v122
 MF 208,196,108
 TR 146,232,3712
 v_rcp_f32 v123, v123
 MF 208,204,124
 v_rcp_f32 v176, v176
 MF 152,204,120
 TR 148,232,14464
 v_rcp_f32 v177, v177
 MF 152,196,104
 TR 150,232,18048
 v_rcp_f32 v178, v178
 MF 152,188,88
 v_rcp_f32 v179, v179
 v_pk_mul_f32 v[36:37], v[36:37], v[8:9]
 v_pk_mul_f32 v[38:39], v[38:39], v[10:11]
 v_pk_mul_f32 v[92:93], v[92:93], v[64:65]
 v_pk_mul_f32 v[94:95], v[94:95], v[66:67]
 v_pk_mul_f32 v[148:149], v[148:149], v[120:121]
 v_pk_mul_f32 v[150:151], v[150:151], v[122:123]
 v_pk_mul_f32 v[204:205], v[204:205], v[176:177]
 v_pk_mul_f32 v[206:207], v[206:207], v[178:179]
 v_cvt_pk_bf16_f32 v4, v36, v37
 s_nop 0
 MF 96,188,84
 v_cvt_pk_bf16_f32 v5, v38, v39
 v_cvt_pk_bf16_f32 v60, v92, v93
 v_cvt_pk_bf16_f32 v61, v94, v95
 MF 96,196,100
 v_cvt_pk_bf16_f32 v116, v148, v149
 v_cvt_pk_bf16_f32 v117, v150, v151
 v_cvt_pk_bf16_f32 v172, v204, v205
 MF 96,204,116
 WL 231,3072
 v_cvt_pk_bf16_f32 v173, v206, v207
 MF 40,204,112
 MF 40,196,96
 MF 40,188,80
 s_waitcnt lgkmcnt(0)
 MF 16,128,32
 TR 184,232,7296
 MF 16,136,48
 TR 186,232,10880
 MF 16,144,64
 v_pk_mul_f32 v[252:253], v[12:13], v[12:13]
 v_pk_mul_f32 v[254:255], v[14:15], v[14:15]
 v_pk_mul_f32 v[234:235], v[68:69], v[68:69]
 v_pk_mul_f32 v[236:237], v[70:71], v[70:71]
 v_pk_fma_f32 v[252:253], v[252:253], v[244:245], v[244:245] op_sel:[0,1,0] op_sel_hi:[1,1,0]
 v_pk_fma_f32 v[254:255], v[254:255], v[244:245], v[244:245] op_sel:[0,1,0] op_sel_hi:[1,1,0]
 v_pk_fma_f32 v[234:235], v[234:235], v[246:247], v[246:247] op_sel:[0,1,0] op_sel_hi:[1,1,0]
 v_pk_fma_f32 v[236:237], v[236:237], v[246:247], v[246:247] op_sel:[0,1,0] op_sel_hi:[1,1,0]
 v_pk_mul_f32 v[40:41], v[40:41], v[12:13]
 v_pk_mul_f32 v[42:43], v[42:43], v[14:15]
 v_pk_mul_f32 v[96:97], v[96:97], v[68:69]
 v_pk_mul_f32 v[98:99], v[98:99], v[70:71]
 v_pk_mul_f32 v[12:13], v[252:253], v[12:13]
 v_pk_mul_f32 v[14:15], v[254:255], v[14:15]
 v_pk_mul_f32 v[68:69], v[234:235], v[68:69]
 v_pk_mul_f32 v[70:71], v[236:237], v[70:71]
 v_pk_mul_f32 v[252:253], v[124:125], v[124:125]
 v_pk_mul_f32 v[254:255], v[126:127], v[126:127]
 v_pk_mul_f32 v[234:235], v[180:181], v[180:181]
 v_pk_mul_f32 v[236:237], v[182:183], v[182:183]
 v_pk_fma_f32 v[252:253], v[252:253], v[248:249], v[248:249] op_sel:[0,1,0] op_sel_hi:[1,1,0]
 v_pk_fma_f32 v[254:255], v[254:255], v[248:249], v[248:249] op_sel:[0,1,0] op_sel_hi:[1,1,0]
 v_pk_fma_f32 v[234:235], v[234:235], v[250:251], v[250:251] op_sel:[0,1,0] op_sel_hi:[1,1,0]
 v_pk_fma_f32 v[236:237], v[236:237], v[250:251], v[250:251] op_sel:[0,1,0] op_sel_hi:[1,1,0]
 v_pk_mul_f32 v[152:153], v[152:153], v[124:125]
 v_pk_mul_f32 v[154:155], v[154:155], v[126:127]
 v_pk_mul_f32 v[208:209], v[208:209], v[180:181]
 v_pk_mul_f32 v[210:211], v[210:211], v[182:183]
 v_pk_mul_f32 v[124:125], v[252:253], v[124:125]
 v_pk_mul_f32 v[126:127], v[254:255], v[126:127]
 v_pk_mul_f32 v[180:181], v[234:235], v[180:181]
 v_pk_mul_f32 v[182:183], v[236:237], v[182:183]
 v_exp_f32 v12, v12
 s_nop 0
 MF 72,144,68
 TR 188,232,21632
 MF 72,136,52
 TR 190,232,25216
 MF 72,128,36
 v_exp_f32 v13, v13
 MF 128,128,40
 TR 192,232,28800
 MF 128,136,56
 TR 194,232,32384
 MF 128,144,72
 v_exp_f32 v14, v14
 MF 184,144,76
 TR 196,232,43136
 MF 184,136,60
 TR 198,232,46720
 MF 184,128,44
 v_exp_f32 v15, v15
 MF 212,132,44
 TR 200,232,35968
 MF 212,140,60
 TR 202,232,39552
 MF 212,148,76
 v_exp_f32 v68, v68
 MF 156,148,72
 TR 204,232,50304
 MF 156,140,56
 TR 206,232,53888
 MF 156,132,40
 v_exp_f32 v69, v69
 MF 100,132,36
 v_exp_f32 v70, v70
 MF 100,140,52
 v_exp_f32 v71, v71
 MF 100,148,68
 v_exp_f32 v124, v124
 MF 44,148,64
 v_exp_f32 v125, v125
 MF 44,140,48
 v_exp_f32 v126, v126
 MF 44,132,32
 v_exp_f32 v127, v127
 v_exp_f32 v180, v180
 v_exp_f32 v181, v181
 v_exp_f32 v182, v182
 v_exp_f32 v183, v183
 s_waitcnt lgkmcnt(0)
 MF 16,184,80
 TR 128,233,160
 MF 16,192,96
 TR 130,233,3744
 v_pk_fma_f32 v[12:13], v[12:13], v[240:241], v[240:241] op_sel:[0,0,0] op_sel_hi:[1,0,0]
 v_pk_fma_f32 v[14:15], v[14:15], v[240:241], v[240:241] op_sel:[0,0,0] op_sel_hi:[1,0,0]
 v_pk_fma_f32 v[68:69], v[68:69], v[240:241], v[240:241] op_sel:[0,1,1] op_sel_hi:[1,1,1]
 v_pk_fma_f32 v[70:71], v[70:71], v[240:241], v[240:241] op_sel:[0,1,1] op_sel_hi:[1,1,1]
 v_pk_fma_f32 v[124:125], v[124:125], v[242:243], v[242:243] op_sel:[0,0,0] op_sel_hi:[1,0,0]
 v_pk_fma_f32 v[126:127], v[126:127], v[242:243], v[242:243] op_sel:[0,0,0] op_sel_hi:[1,0,0]
 v_pk_fma_f32 v[180:181], v[180:181], v[242:243], v[242:243] op_sel:[0,1,1] op_sel_hi:[1,1,1]
 v_pk_fma_f32 v[182:183], v[182:183], v[242:243], v[242:243] op_sel:[0,1,1] op_sel_hi:[1,1,1]
 v_rcp_f32 v12, v12
 s_nop 0
 MF 16,200,112
 v_rcp_f32 v13, v13
 MF 72,200,116
 TR 132,233,14496
 v_rcp_f32 v14, v14
 MF 72,192,100
 TR 134,233,18080
 v_rcp_f32 v15, v15
 MF 72,184,84
 v_rcp_f32 v68, v68
 MF 128,184,88
 TR 136,233,7328
 v_rcp_f32 v69, v69
 MF 128,192,104
 TR 138,233,10912
 v_rcp_f32 v70, v70
 MF 128,200,120
 v_rcp_f32 v71, v71
 MF 184,200,124
 TR 140,233,21664
 v_rcp_f32 v124, v124
 MF 184,192,108
 TR 142,233,25248
 v_rcp_f32 v125, v125
 MF 184,184,92
 v_rcp_f32 v126, v126
 MF 212,188,92
 TR 144,232,160
 v_rcp_f32 v127, v127
 MF 212,196,108
 TR 146,232,3744
 v_rcp_f32 v180, v180
 MF 212,204,124
 v_rcp_f32 v181, v181
 MF 156,204,120
 TR 148,232,14496
 v_rcp_f32 v182, v182
 MF 156,196,104
 TR 150,232,18080
 v_rcp_f32 v183, v183
 v_pk_mul_f32 v[40:41], v[40:41], v[12:13]
 v_pk_mul_f32 v[42:43], v[42:43], v[14:15]
 v_pk_mul_f32 v[96:97], v[96:97], v[68:69]
 v_pk_mul_f32 v[98:99], v[98:99], v[70:71]
 v_pk_mul_f32 v[152:153], v[152:153], v[124:125]
 v_pk_mul_f32 v[154:155], v[154:155], v[126:127]
 v_pk_mul_f32 v[208:209], v[208:209], v[180:181]
 v_pk_mul_f32 v[210:211], v[210:211], v[182:183]
 s_nop 1
 MF 156,188,88
 v_cvt_pk_bf16_f32 v6, v40, v41
 v_cvt_pk_bf16_f32 v7, v42, v43
 MF 100,188,84
 buffer_store_dwordx4 v[4:7], v224, s[56:59], s64 offen offset:0 sc0 sc1
 v_cvt_pk_bf16_f32 v62, v96, v97
 MF 100,196,100
 v_cvt_pk_bf16_f32 v63, v98, v99
 buffer_store_dwordx4 v[60:63], v224, s[56:59], s64 offen offset:1024 sc0 sc1
 s_add_u32 s64, s64, 32768
 MF 100,204,116
 v_cvt_pk_bf16_f32 v118, v152, v153
 v_cvt_pk_bf16_f32 v119, v154, v155
 MF 44,204,112
 buffer_store_dwordx4 v[116:119], v224, s[56:59], s65 offen offset:0 sc0 sc1
 v_cvt_pk_bf16_f32 v174, v208, v209
 MF 44,196,96
 v_cvt_pk_bf16_f32 v175, v210, v211
 buffer_store_dwordx4 v[172:175], v224, s[56:59], s65 offen offset:1024 sc0 sc1
 s_add_u32 s65, s65, 32768
 MF 44,188,80
 s_waitcnt lgkmcnt(0)
 MF 20,128,32
 TR 184,232,7328
 MF 20,136,48
 TR 186,232,10912
 MF 20,144,64
 v_pk_mul_f32 v[252:253], v[16:17], v[16:17]
 v_pk_mul_f32 v[254:255], v[18:19], v[18:19]
 v_pk_mul_f32 v[234:235], v[72:73], v[72:73]
 v_pk_mul_f32 v[236:237], v[74:75], v[74:75]
 v_pk_fma_f32 v[252:253], v[252:253], v[244:245], v[244:245] op_sel:[0,1,0] op_sel_hi:[1,1,0]
 v_pk_fma_f32 v[254:255], v[254:255], v[244:245], v[244:245] op_sel:[0,1,0] op_sel_hi:[1,1,0]
 v_pk_fma_f32 v[234:235], v[234:235], v[246:247], v[246:247] op_sel:[0,1,0] op_sel_hi:[1,1,0]
 v_pk_fma_f32 v[236:237], v[236:237], v[246:247], v[246:247] op_sel:[0,1,0] op_sel_hi:[1,1,0]
 v_pk_mul_f32 v[44:45], v[44:45], v[16:17]
 v_pk_mul_f32 v[46:47], v[46:47], v[18:19]
 v_pk_mul_f32 v[100:101], v[100:101], v[72:73]
 v_pk_mul_f32 v[102:103], v[102:103], v[74:75]
 v_pk_mul_f32 v[16:17], v[252:253], v[16:17]
 v_pk_mul_f32 v[18:19], v[254:255], v[18:19]
 v_pk_mul_f32 v[72:73], v[234:235], v[72:73]
 v_pk_mul_f32 v[74:75], v[236:237], v[74:75]
 v_pk_mul_f32 v[252:253], v[128:129], v[128:129]
 v_pk_mul_f32 v[254:255], v[130:131], v[130:131]
 v_pk_mul_f32 v[234:235], v[184:185], v[184:185]
 v_pk_mul_f32 v[236:237], v[186:187], v[186:187]
 v_pk_fma_f32 v[252:253], v[252:253], v[248:249], v[248:249] op_sel:[0,1,0] op_sel_hi:[1,1,0]
 v_pk_fma_f32 v[254:255], v[254:255], v[248:249], v[248:249] op_sel:[0,1,0] op_sel_hi:[1,1,0]
 v_pk_fma_f32 v[234:235], v[234:235], v[250:251], v[250:251] op_sel:[0,1,0] op_sel_hi:[1,1,0]
 v_pk_fma_f32 v[236:237], v[236:237], v[250:251], v[250:251] op_sel:[0,1,0] op_sel_hi:[1,1,0]
 v_pk_mul_f32 v[156:157], v[156:157], v[128:129]
 v_pk_mul_f32 v[158:159], v[158:159], v[130:131]
 v_pk_mul_f32 v[212:213], v[212:213], v[184:185]
 v_pk_mul_f32 v[214:215], v[214:215], v[186:187]
 v_pk_mul_f32 v[128:129], v[252:253], v[128:129]
 v_pk_mul_f32 v[130:131], v[254:255], v[130:131]
 s_branch L_sequential_preLN__sliding_local_dilated__geglu_ffn__prompt_kernel_pg14_skip
.p2align 12
L_sequential_preLN__sliding_local_dilated__geglu_ffn__prompt_kernel_pg14:
 s_branch L_sequential_preLN__sliding_local_dilated__geglu_ffn__prompt_kernel_pg18
L_sequential_preLN__sliding_local_dilated__geglu_ffn__prompt_kernel_pg14b:
 s_branch L_sequential_preLN__sliding_local_dilated__geglu_ffn__prompt_kernel_sp_ret
L_sequential_preLN__sliding_local_dilated__geglu_ffn__prompt_kernel_pg14_skip:
 v_pk_mul_f32 v[184:185], v[234:235], v[184:185]
 v_pk_mul_f32 v[186:187], v[236:237], v[186:187]
 v_exp_f32 v16, v16
 v_exp_f32 v17, v17
 MF 76,144,68
 TR 188,232,21664
 v_exp_f32 v18, v18
 MF 76,136,52
 TR 190,232,25248
 v_exp_f32 v19, v19
 MF 76,128,36
 v_exp_f32 v72, v72
 v_exp_f32 v73, v73
 MF 132,128,40
 TR 192,232,28832
 v_exp_f32 v74, v74
 MF 132,136,56
 TR 194,232,32416
 v_exp_f32 v75, v75
 MF 132,144,72
 v_exp_f32 v128, v128
 v_exp_f32 v129, v129
 MF 188,144,76
 TR 196,232,43168
 v_exp_f32 v130, v130
 MF 188,136,60
 TR 198,232,46752
 v_exp_f32 v131, v131
 MF 188,128,44
 v_exp_f32 v184, v184
 v_exp_f32 v185, v185
 MF 216,132,44
 TR 200,232,36000
 v_exp_f32 v186, v186
 MF 216,140,60
 TR 202,232,39584
 v_exp_f32 v187, v187
 MF 216,148,76
 buffer_load_dword v31, v30, s[60:63], s70 offen sc0 sc1
 v_bfe_u32 v33, v224, 6, 2
 v_bfe_u32 v34, v224, 4, 2
 MF 160,148,72
 TR 204,232,50336
 v_lshrrev_b32 v35, 8, v224
 v_lshl_add_u32 v33, v35, 2, v33
 MF 160,140,56
 TR 206,232,53920
 v_and_b32 v35, 7, v33
 s_lshl_b32 s13, s74, 2
 v_xor_b32 v35, s13, v35
 MF 160,132,40
 v_lshlrev_b32 v33, 8, v33
 v_lshl_add_u32 v33, v34, 3, v33
 v_lshl_add_u32 v33, v35, 5, v33
 v_add_u32 v34, 32768, v33
 MF 104,132,36
 v_add_u32 v33, 98304, v33
 v_xor_b32 v36, 0, v34
 v_xor_b32 v37, 32, v34
 v_xor_b32 v38, 64, v34
 MF 104,140,52
 v_xor_b32 v39, 96, v34
 v_xor_b32 v40, 128, v34
 v_xor_b32 v41, 160, v34
 v_xor_b32 v42, 192, v34
 MF 104,148,68
 v_xor_b32 v43, 224, v34
 MF 48,148,64
 MF 48,140,48
 MF 48,132,32
 s_waitcnt lgkmcnt(0)
 MF 20,184,80
 TR 128,233,192
 MF 20,192,96
 TR 130,233,3776
 v_pk_fma_f32 v[16:17], v[16:17], v[240:241], v[240:241] op_sel:[0,0,0] op_sel_hi:[1,0,0]
 v_pk_fma_f32 v[18:19], v[18:19], v[240:241], v[240:241] op_sel:[0,0,0] op_sel_hi:[1,0,0]
 v_pk_fma_f32 v[72:73], v[72:73], v[240:241], v[240:241] op_sel:[0,1,1] op_sel_hi:[1,1,1]
 v_pk_fma_f32 v[74:75], v[74:75], v[240:241], v[240:241] op_sel:[0,1,1] op_sel_hi:[1,1,1]
 v_pk_fma_f32 v[128:129], v[128:129], v[242:243], v[242:243] op_sel:[0,0,0] op_sel_hi:[1,0,0]
 v_pk_fma_f32 v[130:131], v[130:131], v[242:243], v[242:243] op_sel:[0,0,0] op_sel_hi:[1,0,0]
 v_pk_fma_f32 v[184:185], v[184:185], v[242:243], v[242:243] op_sel:[0,1,1] op_sel_hi:[1,1,1]
 v_pk_fma_f32 v[186:187], v[186:187], v[242:243], v[242:243] op_sel:[0,1,1] op_sel_hi:[1,1,1]
 v_rcp_f32 v16, v16
 s_nop 0
 MF 20,200,112
 v_rcp_f32 v17, v17
 MF 76,200,116
 TR 132,233,14528
 v_rcp_f32 v18, v18
 MF 76,192,100
 TR 134,233,18112
 v_rcp_f32 v19, v19
 MF 76,184,84
 v_rcp_f32 v72, v72
 MF 132,184,88
 TR 136,233,7360
 v_rcp_f32 v73, v73
 MF 132,192,104
 TR 138,233,10944
 v_rcp_f32 v74, v74
 MF 132,200,120
 v_rcp_f32 v75, v75
 MF 188,200,124
 TR 140,233,21696
 v_rcp_f32 v128, v128
 MF 188,192,108
 TR 142,233,25280
 v_rcp_f32 v129, v129
 MF 188,184,92
 v_rcp_f32 v130, v130
 MF 216,188,92
 TR 144,232,192
 v_rcp_f32 v131, v131
 MF 216,196,108
 TR 146,232,3776
 v_rcp_f32 v184, v184
 MF 216,204,124
 v_rcp_f32 v185, v185
 MF 160,204,120
 TR 148,232,14528
 v_rcp_f32 v186, v186
 MF 160,196,104
 TR 150,232,18112
 v_rcp_f32 v187, v187
 v_pk_mul_f32 v[44:45], v[44:45], v[16:17]
 v_pk_mul_f32 v[46:47], v[46:47], v[18:19]
 v_pk_mul_f32 v[100:101], v[100:101], v[72:73]
 v_pk_mul_f32 v[102:103], v[102:103], v[74:75]
 v_pk_mul_f32 v[156:157], v[156:157], v[128:129]
 v_pk_mul_f32 v[158:159], v[158:159], v[130:131]
 v_pk_mul_f32 v[212:213], v[212:213], v[184:185]
 v_pk_mul_f32 v[214:215], v[214:215], v[186:187]
 s_nop 1
 MF 160,188,88
 v_cvt_pk_bf16_f32 v8, v44, v45
 v_cvt_pk_bf16_f32 v9, v46, v47
 v_cvt_pk_bf16_f32 v64, v100, v101
 MF 104,188,84
 v_cvt_pk_bf16_f32 v65, v102, v103
 v_cvt_pk_bf16_f32 v120, v156, v157
 v_cvt_pk_bf16_f32 v121, v158, v159
 MF 104,196,100
 v_cvt_pk_bf16_f32 v176, v212, v213
 v_cvt_pk_bf16_f32 v177, v214, v215
 MF 104,204,116
 MF 48,204,112
 MF 48,196,96
 MF 48,188,80
 s_waitcnt vmcnt(0)
 s_cmp_eq_u32 s70, 262144
 s_cbranch_scc1 L_chk4_1_ok
 s_add_u32 s71, s96, 1
 s_mov_b32 s47, 0x100000
L_chk4_1:
 v_subrev_u32 v32, s71, v31
 v_cmp_lt_u32 vcc, 3, v32
 s_nop 1
 s_cmp_eq_u64 vcc, 0
 s_cbranch_scc1 L_chk4_1_go
 s_sub_u32 s47, s47, 1
 s_cbranch_scc1 L_chk4_1_go
 buffer_load_dword v31, v30, s[60:63], s70 offen sc0 sc1
 s_waitcnt vmcnt(0)
 s_branch L_chk4_1
L_chk4_1_go:
 v_cmp_ne_u32 vcc, 3, v32
 s_nop 1
 s_cmp_eq_u64 vcc, 0
 s_cselect_b32 s70, 262144, s70
L_chk4_1_ok:
 s_waitcnt lgkmcnt(0)
 s_barrier
 MF 24,128,32
 TR 184,232,7360
 MF 24,136,48
 TR 186,232,10944
 MF 24,144,64
 XL 0,28,0
 v_pk_mul_f32 v[252:253], v[20:21], v[20:21]
 v_pk_mul_f32 v[254:255], v[22:23], v[22:23]
 v_pk_mul_f32 v[234:235], v[76:77], v[76:77]
 v_pk_mul_f32 v[236:237], v[78:79], v[78:79]
 v_pk_fma_f32 v[252:253], v[252:253], v[244:245], v[244:245] op_sel:[0,1,0] op_sel_hi:[1,1,0]
 v_pk_fma_f32 v[254:255], v[254:255], v[244:245], v[244:245] op_sel:[0,1,0] op_sel_hi:[1,1,0]
 v_pk_fma_f32 v[234:235], v[234:235], v[246:247], v[246:247] op_sel:[0,1,0] op_sel_hi:[1,1,0]
 v_pk_fma_f32 v[236:237], v[236:237], v[246:247], v[246:247] op_sel:[0,1,0] op_sel_hi:[1,1,0]
 v_pk_mul_f32 v[48:49], v[48:49], v[20:21]
 v_pk_mul_f32 v[50:51], v[50:51], v[22:23]
 v_pk_mul_f32 v[104:105], v[104:105], v[76:77]
 v_pk_mul_f32 v[106:107], v[106:107], v[78:79]
 v_pk_mul_f32 v[20:21], v[252:253], v[20:21]
 v_pk_mul_f32 v[22:23], v[254:255], v[22:23]
 v_pk_mul_f32 v[76:77], v[234:235], v[76:77]
 v_pk_mul_f32 v[78:79], v[236:237], v[78:79]
 v_pk_mul_f32 v[252:253], v[132:133], v[132:133]
 v_pk_mul_f32 v[254:255], v[134:135], v[134:135]
 v_pk_mul_f32 v[234:235], v[188:189], v[188:189]
 v_pk_mul_f32 v[236:237], v[190:191], v[190:191]
 v_pk_fma_f32 v[252:253], v[252:253], v[248:249], v[248:249] op_sel:[0,1,0] op_sel_hi:[1,1,0]
 v_pk_fma_f32 v[254:255], v[254:255], v[248:249], v[248:249] op_sel:[0,1,0] op_sel_hi:[1,1,0]
 v_pk_fma_f32 v[234:235], v[234:235], v[250:251], v[250:251] op_sel:[0,1,0] op_sel_hi:[1,1,0]
 v_pk_fma_f32 v[236:237], v[236:237], v[250:251], v[250:251] op_sel:[0,1,0] op_sel_hi:[1,1,0]
 v_pk_mul_f32 v[160:161], v[160:161], v[132:133]
 v_pk_mul_f32 v[162:163], v[162:163], v[134:135]
 v_pk_mul_f32 v[216:217], v[216:217], v[188:189]
 v_pk_mul_f32 v[218:219], v[218:219], v[190:191]
 v_pk_mul_f32 v[132:133], v[252:253], v[132:133]
 v_pk_mul_f32 v[134:135], v[254:255], v[134:135]
 v_pk_mul_f32 v[188:189], v[234:235], v[188:189]
 v_pk_mul_f32 v[190:191], v[236:237], v[190:191]
 s_nop 1
 MF 80,144,68
 TR 188,232,21696
 v_exp_f32 v20, v20
 MF 80,136,52
 TR 190,232,25280
 v_exp_f32 v21, v21
 MF 80,128,36
 XL 4,28,1024
 MF 136,128,40
 TR 192,232,28864
 v_exp_f32 v22, v22
 MF 136,136,56
 TR 194,232,32448
 v_exp_f32 v23, v23
 MF 136,144,72
 XL 8,28,2048
 MF 192,144,76
 TR 196,232,43200
 v_exp_f32 v76, v76
 MF 192,136,60
 TR 198,232,46784
 v_exp_f32 v77, v77
 MF 192,128,44
 v_exp_f32 v78, v78
 MF 220,132,44
 TR 200,232,36032
 v_exp_f32 v79, v79
 MF 220,140,60
 TR 202,232,39616
 v_exp_f32 v132, v132
 MF 220,148,76
 XL 12,28,3072
 s_add_u32 s44, s44, 4096
 MF 164,148,72
 TR 204,232,50368
 v_exp_f32 v133, v133
 MF 164,140,56
 TR 206,232,53952
 v_exp_f32 v134, v134
 MF 164,132,40
 XL 16,28,0
 MF 108,132,36
 v_exp_f32 v135, v135
 MF 108,140,52
 v_exp_f32 v188, v188
 MF 108,148,68
 XL 20,28,1024
 MF 52,148,64
 v_exp_f32 v189, v189
 MF 52,140,48
 v_exp_f32 v190, v190
 MF 52,132,32
 XL 24,28,2048
 v_exp_f32 v191, v191
 s_waitcnt vmcnt(29) lgkmcnt(0)
 s_barrier
 MF 24,184,80
 TR 128,40,32768
 TR 130,40,36864
 MF 24,192,96
 TR 132,41,32768
 v_pk_fma_f32 v[20:21], v[20:21], v[240:241], v[240:241] op_sel:[0,0,0] op_sel_hi:[1,0,0]
 v_pk_fma_f32 v[22:23], v[22:23], v[240:241], v[240:241] op_sel:[0,0,0] op_sel_hi:[1,0,0]
 v_pk_fma_f32 v[76:77], v[76:77], v[240:241], v[240:241] op_sel:[0,1,1] op_sel_hi:[1,1,1]
 v_pk_fma_f32 v[78:79], v[78:79], v[240:241], v[240:241] op_sel:[0,1,1] op_sel_hi:[1,1,1]
 v_pk_fma_f32 v[132:133], v[132:133], v[242:243], v[242:243] op_sel:[0,0,0] op_sel_hi:[1,0,0]
 v_pk_fma_f32 v[134:135], v[134:135], v[242:243], v[242:243] op_sel:[0,0,0] op_sel_hi:[1,0,0]
 v_pk_fma_f32 v[188:189], v[188:189], v[242:243], v[242:243] op_sel:[0,1,1] op_sel_hi:[1,1,1]
 v_pk_fma_f32 v[190:191], v[190:191], v[242:243], v[242:243] op_sel:[0,1,1] op_sel_hi:[1,1,1]
 v_rcp_f32 v20, v20
 s_nop 0
 MF 24,200,112
 XL 28,28,3072
 s_add_u32 s44, s44, 4096
 v_rcp_f32 v21, v21
 MF 80,200,116
 TR 134,41,36864
 v_rcp_f32 v22, v22
 MF 80,192,100
 TR 136,42,32768
 v_rcp_f32 v23, v23
 MF 80,184,84
 XL 160,28,0
 v_rcp_f32 v76, v76
 MF 136,184,88
 TR 138,42,36864
 TR 140,43,32768
 v_rcp_f32 v77, v77
 MF 136,192,104
 TR 142,43,36864
 v_rcp_f32 v78, v78
 MF 136,200,120
 XL 164,28,1024
 v_rcp_f32 v79, v79
 MF 192,200,124
 TR 144,40,40960
 v_rcp_f32 v132, v132
 MF 192,192,108
 TR 146,40,45056
 v_rcp_f32 v133, v133
 MF 192,184,92
 v_rcp_f32 v134, v134
 v_rcp_f32 v135, v135
 MF 220,188,92
 TR 148,41,40960
 TR 150,41,45056
 v_rcp_f32 v188, v188
 MF 220,196,108
 TR 152,42,40960
 v_rcp_f32 v189, v189
 MF 220,204,124
 XL 168,28,2048
 v_rcp_f32 v190, v190
 MF 164,204,120
 TR 154,42,45056
 v_rcp_f32 v191, v191
 v_pk_mul_f32 v[48:49], v[48:49], v[20:21]
 v_pk_mul_f32 v[50:51], v[50:51], v[22:23]
 v_pk_mul_f32 v[104:105], v[104:105], v[76:77]
 v_pk_mul_f32 v[106:107], v[106:107], v[78:79]
 v_pk_mul_f32 v[160:161], v[160:161], v[132:133]
 v_pk_mul_f32 v[162:163], v[162:163], v[134:135]
 v_pk_mul_f32 v[216:217], v[216:217], v[188:189]
 v_pk_mul_f32 v[218:219], v[218:219], v[190:191]
 v_cvt_pk_bf16_f32 v10, v48, v49
 s_nop 0
 MF 164,196,104
 TR 156,43,40960
 v_cvt_pk_bf16_f32 v11, v50, v51
 buffer_store_dwordx4 v[8:11], v224, s[56:59], s64 offen offset:0 sc0 sc1
 MF 164,188,88
 XL 172,28,3072
 s_add_u32 s44, s44, 4096
 v_cvt_pk_bf16_f32 v66, v104, v105
 v_cvt_pk_bf16_f32 v67, v106, v107
 MF 108,188,84
 TR 158,43,45056
 buffer_store_dwordx4 v[64:67], v224, s[56:59], s64 offen offset:1024 sc0 sc1
 s_add_u32 s64, s64, 32768
 MF 108,196,100
 v_cvt_pk_bf16_f32 v122, v160, v161
 v_cvt_pk_bf16_f32 v123, v162, v163
 buffer_store_dwordx4 v[120:123], v224, s[56:59], s65 offen offset:0 sc0 sc1
 MF 108,204,116
 XL 176,28,0
 v_cvt_pk_bf16_f32 v178, v216, v217
 v_cvt_pk_bf16_f32 v179, v218, v219
 MF 52,204,112
 buffer_store_dwordx4 v[176:179], v224, s[56:59], s65 offen offset:1024 sc0 sc1
 s_add_u32 s65, s65, 32768
 MF 52,196,96
 MF 52,188,80
 XL 180,28,1024
 s_waitcnt vmcnt(19)
 v_add_u32 v230, 1, v230
 buffer_store_dword v230, v228, s[60:63], s68 offen sc0 sc1
 s_waitcnt vmcnt(15) lgkmcnt(0)
 v_mfma_f32_16x16x32_bf16 v[100:103], a[128:131], a[0:3], 0
 TR 184,36,32768
 TR 186,36,36864
 TR 188,37,32768
 MF 100,144,8
 XL 216,28,2048
 v_mfma_f32_16x16x32_bf16 v[196:199], a[144:147], a[12:15], 0
 TR 190,37,36864
 TR 192,38,32768
 TR 194,38,36864
 MF 196,128,4
 XL 220,28,3072
 s_add_u32 s44, s44, 4096
 v_pk_mul_f32 v[252:253], v[24:25], v[24:25]
 v_pk_mul_f32 v[254:255], v[26:27], v[26:27]
 v_pk_mul_f32 v[234:235], v[80:81], v[80:81]
 v_pk_mul_f32 v[236:237], v[82:83], v[82:83]
 v_pk_fma_f32 v[252:253], v[252:253], v[244:245], v[244:245] op_sel:[0,1,0] op_sel_hi:[1,1,0]
 v_pk_fma_f32 v[254:255], v[254:255], v[244:245], v[244:245] op_sel:[0,1,0] op_sel_hi:[1,1,0]
 v_pk_fma_f32 v[234:235], v[234:235], v[246:247], v[246:247] op_sel:[0,1,0] op_sel_hi:[1,1,0]
 v_pk_fma_f32 v[236:237], v[236:237], v[246:247], v[246:247] op_sel:[0,1,0] op_sel_hi:[1,1,0]
 v_pk_mul_f32 v[52:53], v[52:53], v[24:25]
 v_pk_mul_f32 v[54:55], v[54:55], v[26:27]
 v_pk_mul_f32 v[108:109], v[108:109], v[80:81]
 v_pk_mul_f32 v[110:111], v[110:111], v[82:83]
 v_pk_mul_f32 v[24:25], v[252:253], v[24:25]
 v_pk_mul_f32 v[26:27], v[254:255], v[26:27]
 v_pk_mul_f32 v[80:81], v[234:235], v[80:81]
 v_pk_mul_f32 v[82:83], v[236:237], v[82:83]
 v_pk_mul_f32 v[252:253], v[136:137], v[136:137]
 v_pk_mul_f32 v[254:255], v[138:139], v[138:139]
 v_pk_mul_f32 v[234:235], v[192:193], v[192:193]
 v_pk_mul_f32 v[236:237], v[194:195], v[194:195]
 v_pk_fma_f32 v[252:253], v[252:253], v[248:249], v[248:249] op_sel:[0,1,0] op_sel_hi:[1,1,0]
 v_pk_fma_f32 v[254:255], v[254:255], v[248:249], v[248:249] op_sel:[0,1,0] op_sel_hi:[1,1,0]
 v_pk_fma_f32 v[234:235], v[234:235], v[250:251], v[250:251] op_sel:[0,1,0] op_sel_hi:[1,1,0]
 v_pk_fma_f32 v[236:237], v[236:237], v[250:251], v[250:251] op_sel:[0,1,0] op_sel_hi:[1,1,0]
 v_pk_mul_f32 v[164:165], v[164:165], v[136:137]
 v_pk_mul_f32 v[166:167], v[166:167], v[138:139]
 v_pk_mul_f32 v[220:221], v[220:221], v[192:193]
 v_pk_mul_f32 v[222:223], v[222:223], v[194:195]
 v_pk_mul_f32 v[136:137], v[252:253], v[136:137]
 v_pk_mul_f32 v[138:139], v[254:255], v[138:139]
 v_pk_mul_f32 v[192:193], v[234:235], v[192:193]
 v_pk_mul_f32 v[194:195], v[236:237], v[194:195]
 s_nop 1
 v_mfma_f32_16x16x32_bf16 v[200:203], a[132:135], a[4:7], 0
 TR 196,39,32768
 TR 198,39,36864
 MF 200,148,12
 XL 224,28,0
 v_mfma_f32_16x16x32_bf16 v[104:107], a[148:151], a[8:11], 0
 TR 200,36,40960
 TR 202,36,45056
 TR 204,37,40960
 MF 104,132,0
 v_exp_f32 v24, v24
 v_mfma_f32_16x16x32_bf16 v[140:143], a[136:139], a[0:3], 0
 TR 206,37,45056
 TR 208,38,40960
 TR 210,38,45056
 MF 140,152,8
 XL 228,28,1024
 v_mfma_f32_16x16x32_bf16 v[204:207], a[152:155], a[12:15], 0
 TR 212,39,40960
 TR 214,39,45056
 MF 204,136,4
 XL 232,28,2048
 v_mfma_f32_16x16x32_bf16 v[208:211], a[140:143], a[4:7], 0
 v_exp_f32 v25, v25
 MF 208,156,12
 XL 236,28,3072
 s_add_u32 s44, s44, 4096
 v_mfma_f32_16x16x32_bf16 v[144:147], a[156:159], a[8:11], 0
 v_exp_f32 v26, v26
 MF 144,140,0
 s_add_u32 m0, s46, 98304
 s_add_u32 s45, s45, 0x70000
 WL 225,0
 v_exp_f32 v27, v27
 v_exp_f32 v80, v80
 v_exp_f32 v81, v81
 s_waitcnt vmcnt(44) lgkmcnt(0)
 s_barrier
 v_mfma_f32_16x16x32_bf16 v[84:87], a[184:187], a[0:3], 0
 TR 128,40,49152
 TR 130,40,53248
 TR 132,41,49152
 MF 84,200,8
 WL 227,1024
 v_exp_f32 v82, v82
 v_mfma_f32_16x16x32_bf16 v[148:151], a[200:203], a[12:15], 0
 TR 134,41,53248
 TR 136,42,49152
 TR 138,42,53248
 MF 148,184,4
 WL 229,2048
 v_exp_f32 v83, v83
 v_mfma_f32_16x16x32_bf16 v[152:155], a[188:191], a[4:7], 0
 TR 140,43,49152
 TR 142,43,53248
 v_exp_f32 v136, v136
 MF 152,204,12
 WL 231,3072
 v_exp_f32 v137, v137
 v_mfma_f32_16x16x32_bf16 v[88:91], a[204:207], a[8:11], 0
 TR 144,40,57344
 TR 146,40,61440
 TR 148,41,57344
 MF 88,188,0
 v_exp_f32 v138, v138
 v_exp_f32 v139, v139
 v_mfma_f32_16x16x32_bf16 v[92:95], a[192:195], a[0:3], 0
 TR 150,41,61440
 TR 152,42,57344
 TR 154,42,61440
 MF 92,208,8
 s_add_u32 m0, s46, 114688
 s_add_u32 s45, s45, 0x70000
 WL 225,0
 v_mfma_f32_16x16x32_bf16 v[156:159], a[208:211], a[12:15], 0
 TR 156,43,57344
 TR 158,43,61440
 v_exp_f32 v192, v192
 MF 156,192,4
 WL 227,1024
 v_exp_f32 v193, v193
 v_mfma_f32_16x16x32_bf16 v[160:163], a[196:199], a[4:7], 0
 v_xor_b32 v44, 0, v33
 v_xor_b32 v45, 32, v33
 v_xor_b32 v46, 64, v33
 v_xor_b32 v47, 96, v33
 MF 160,212,12
 WL 229,2048
 v_xor_b32 v48, 128, v33
 v_xor_b32 v49, 160, v33
 v_mfma_f32_16x16x32_bf16 v[96:99], a[212:215], a[8:11], 0
 v_xor_b32 v50, 192, v33
 v_xor_b32 v51, 224, v33
 MF 96,196,0
 WL 231,3072
 s_waitcnt vmcnt(25) lgkmcnt(0)
 MF 100,128,16
 TR 184,36,49152
 TR 186,36,53248
 TR 188,37,49152
 MF 100,144,24
 s_add_u32 m0, s46, 32768
 s_add_u32 s45, s45, 0x70000
 WL 225,0
 MF 196,144,28
 TR 190,37,53248
 TR 192,38,49152
 TR 194,38,53248
 MF 196,128,20
 v_exp_f32 v194, v194
 MF 200,132,20
 TR 196,39,49152
 TR 198,39,53248
 MF 200,148,28
 WL 227,1024
 MF 104,148,24
 TR 200,36,57344
 TR 202,36,61440
 TR 204,37,57344
 MF 104,132,16
 v_exp_f32 v195, v195
 v_pk_fma_f32 v[24:25], v[24:25], v[240:241], v[240:241] op_sel:[0,0,0] op_sel_hi:[1,0,0]
 v_pk_fma_f32 v[26:27], v[26:27], v[240:241], v[240:241] op_sel:[0,0,0] op_sel_hi:[1,0,0]
 v_pk_fma_f32 v[80:81], v[80:81], v[240:241], v[240:241] op_sel:[0,1,1] op_sel_hi:[1,1,1]
 v_pk_fma_f32 v[82:83], v[82:83], v[240:241], v[240:241] op_sel:[0,1,1] op_sel_hi:[1,1,1]
 v_pk_fma_f32 v[136:137], v[136:137], v[242:243], v[242:243] op_sel:[0,0,0] op_sel_hi:[1,0,0]
 v_pk_fma_f32 v[138:139], v[138:139], v[242:243], v[242:243] op_sel:[0,0,0] op_sel_hi:[1,0,0]
 v_pk_fma_f32 v[192:193], v[192:193], v[242:243], v[242:243] op_sel:[0,1,1] op_sel_hi:[1,1,1]
 v_pk_fma_f32 v[194:195], v[194:195], v[242:243], v[242:243] op_sel:[0,1,1] op_sel_hi:[1,1,1]
 s_nop 1
 MF 140,136,16
 TR 206,37,61440
 TR 208,38,57344
 TR 210,38,61440
 MF 140,152,24
 WL 229,2048
 MF 204,152,28
 TR 212,39,57344
 TR 214,39,61440
 MF 204,136,20
 WL 231,3072
 MF 208,140,20
 v_rcp_f32 v24, v24
 MF 208,156,28
 v_rcp_f32 v25, v25
 MF 144,156,24
 v_rcp_f32 v26, v26
 MF 144,140,16
 s_add_u32 m0, s46, 49152
 s_add_u32 s45, s45, 0x70000
 WL 225,0
 v_rcp_f32 v27, v27
 v_rcp_f32 v80, v80
 s_waitcnt vmcnt(51) lgkmcnt(0)
 s_barrier
 MF 84,184,16
 TR 128,48,32768
 TR 130,48,36864
 TR 132,49,32768
 MF 84,200,24
 WL 227,1024
 MF 148,200,28
 TR 134,49,36864
 TR 136,50,32768
 s_branch L_sequential_preLN__sliding_local_dilated__geglu_ffn__prompt_kernel_pg15_skip
.p2align 12
L_sequential_preLN__sliding_local_dilated__geglu_ffn__prompt_kernel_pg15:
 s_branch L_sequential_preLN__sliding_local_dilated__geglu_ffn__prompt_kernel_pg19
L_sequential_preLN__sliding_local_dilated__geglu_ffn__prompt_kernel_pg15b:
 s_branch L_sequential_preLN__sliding_local_dilated__geglu_ffn__prompt_kernel_sp_ret
L_sequential_preLN__sliding_local_dilated__geglu_ffn__prompt_kernel_pg15_skip:
 TR 138,50,36864
 MF 148,184,20
 v_rcp_f32 v81, v81
 MF 152,188,20
 TR 140,51,32768
 TR 142,51,36864
 MF 152,204,28
 WL 229,2048
 MF 88,204,24
 TR 144,48,40960
 TR 146,48,45056
 TR 148,49,40960
 MF 88,188,16
 v_rcp_f32 v82, v82
 MF 92,192,16
 TR 150,49,45056
 TR 152,50,40960
 TR 154,50,45056
 MF 92,208,24
 WL 231,3072
 MF 156,208,28
 TR 156,51,40960
 TR 158,51,45056
 MF 156,192,20
 XL 240,28,0
 MF 160,196,20
 v_rcp_f32 v83, v83
 MF 160,212,28
 v_rcp_f32 v136, v136
 MF 96,212,24
 v_rcp_f32 v137, v137
 MF 96,196,16
 XL 244,28,1024
 v_rcp_f32 v138, v138
 v_rcp_f32 v139, v139
 v_rcp_f32 v192, v192
 s_waitcnt vmcnt(26)
 v_add_u32 v230, 1, v230
 buffer_store_dword v230, v228, s[60:63], s68 offen sc0 sc1
 s_waitcnt vmcnt(31) lgkmcnt(0)
 MF 100,128,160
 TR 184,44,32768
 TR 186,44,36864
 TR 188,45,32768
 MF 100,144,168
 XL 248,28,2048
 MF 196,144,172
 TR 190,45,36864
 TR 192,46,32768
 TR 194,46,36864
 MF 196,128,164
 v_rcp_f32 v193, v193
 MF 200,132,164
 TR 196,47,32768
 TR 198,47,36864
 MF 200,148,172
 XL 252,28,3072
 s_add_u32 s44, s44, 4096
 MF 104,148,168
 TR 200,44,40960
 TR 202,44,45056
 TR 204,45,40960
 MF 104,132,160
 v_rcp_f32 v194, v194
 MF 140,136,160
 TR 206,45,45056
 TR 208,46,40960
 TR 210,46,45056
 MF 140,152,168
 XL 32,28,0
 MF 204,152,172
 TR 212,47,40960
 TR 214,47,45056
 MF 204,136,164
 XL 36,28,1024
 MF 208,140,164
 v_rcp_f32 v195, v195
 v_pk_mul_f32 v[52:53], v[52:53], v[24:25]
 v_pk_mul_f32 v[54:55], v[54:55], v[26:27]
 v_pk_mul_f32 v[108:109], v[108:109], v[80:81]
 v_pk_mul_f32 v[110:111], v[110:111], v[82:83]
 v_pk_mul_f32 v[164:165], v[164:165], v[136:137]
 v_pk_mul_f32 v[166:167], v[166:167], v[138:139]
 v_pk_mul_f32 v[220:221], v[220:221], v[192:193]
 v_pk_mul_f32 v[222:223], v[222:223], v[194:195]
 v_cvt_pk_bf16_f32 v12, v52, v53
 s_nop 0
 MF 208,156,172
 v_cvt_pk_bf16_f32 v13, v54, v55
 buffer_store_dwordx2 v[12:13], v226, s[56:59], s66 offen offset:0 sc0 sc1
 MF 144,156,168
 v_cvt_pk_bf16_f32 v68, v108, v109
 MF 144,140,160
 XL 40,28,2048
 s_waitcnt vmcnt(55) lgkmcnt(0)
 s_barrier
 MF 84,184,160
 TR 128,48,49152
 TR 130,48,53248
 TR 132,49,49152
 MF 84,200,168
 XL 44,28,3072
 s_add_u32 s44, s44, 4096
 v_cvt_pk_bf16_f32 v69, v110, v111
 MF 148,200,172
 TR 134,49,53248
 TR 136,50,49152
 TR 138,50,53248
 MF 148,184,164
 buffer_store_dwordx2 v[68:69], v226, s[56:59], s66 offen offset:1024 sc0 sc1
 v_cvt_pk_bf16_f32 v124, v164, v165
 MF 152,188,164
 TR 140,51,49152
 TR 142,51,53248
 v_cvt_pk_bf16_f32 v125, v166, v167
 MF 152,204,172
 XL 48,28,0
 MF 88,204,168
 TR 144,48,57344
 TR 146,48,61440
 TR 148,49,57344
 MF 88,188,160
 XL 52,28,1024
 MF 92,192,160
 TR 150,49,61440
 TR 152,50,57344
 TR 154,50,61440
 MF 92,208,168
 XL 56,28,2048
 MF 156,208,172
 TR 156,51,57344
 TR 158,51,61440
 MF 156,192,164
 buffer_store_dwordx2 v[124:125], v226, s[56:59], s67 offen offset:0 sc0 sc1
 v_cvt_pk_bf16_f32 v180, v220, v221
 MF 160,196,164
 v_cvt_pk_bf16_f32 v181, v222, v223
 buffer_store_dwordx2 v[180:181], v226, s[56:59], s67 offen offset:1024 sc0 sc1
 MF 160,212,172
 XL 60,28,3072
 s_add_u32 s44, s44, 4096
 MF 96,212,168
 MF 96,196,160
 buffer_load_dword v31, v30, s[60:63], s70 offen sc0 sc1
 s_waitcnt vmcnt(38) lgkmcnt(0)
 MF 100,128,176
 TR 184,44,49152
 TR 186,44,53248
 TR 188,45,49152
 MF 100,144,216
 MF 196,144,220
 TR 190,45,53248
 TR 192,46,49152
 TR 194,46,53248
 MF 196,128,180
 s_add_u32 m0, s46, 65536
 s_add_u32 s45, s45, 0xffd00000
 WL 225,0
 MF 200,132,180
 TR 196,47,49152
 TR 198,47,53248
 MF 200,148,220
 MF 104,148,216
 TR 200,44,57344
 TR 202,44,61440
 TR 204,45,57344
 MF 104,132,176
 WL 227,1024
 MF 140,136,176
 TR 206,45,61440
 TR 208,46,57344
 TR 210,46,61440
 MF 140,152,216
 MF 204,152,220
 TR 212,47,57344
 TR 214,47,61440
 MF 204,136,180
 WL 229,2048
 MF 208,140,180
 MF 208,156,220
 MF 144,156,216
 MF 144,140,176
 WL 231,3072
 s_waitcnt vmcnt(34) lgkmcnt(0)
 s_barrier
 MF 84,184,176
 TR 128,48,0
 TR 130,48,4096
 TR 132,49,0
 MF 84,200,216
 MF 148,200,220
 TR 134,49,4096
 TR 136,50,0
 TR 138,50,4096
 MF 148,184,180
 MF 152,188,180
 TR 140,51,0
 TR 142,51,4096
 MF 152,204,220
 MF 88,204,216
 TR 144,48,8192
 TR 146,48,12288
 TR 148,49,8192
 MF 88,188,176
 MF 92,192,176
 TR 150,49,12288
 TR 152,50,8192
 TR 154,50,12288
 MF 92,208,216
 MF 156,208,220
 TR 156,51,8192
 TR 158,51,12288
 MF 156,192,180
 MF 160,196,180
 MF 160,212,220
 MF 96,212,216
 MF 96,196,176
 s_waitcnt vmcnt(38) lgkmcnt(0)
 MF 100,128,224
 TR 184,44,0
 TR 186,44,4096
 TR 188,45,0
 MF 100,144,232
 MF 196,144,236
 TR 190,45,4096
 TR 192,46,0
 TR 194,46,4096
 MF 196,128,228
 MF 200,132,228
 TR 196,47,0
 TR 198,47,4096
 MF 200,148,236
 MF 104,148,232
 TR 200,44,8192
 TR 202,44,12288
 TR 204,45,8192
 MF 104,132,224
 MF 140,136,224
 TR 206,45,12288
 TR 208,46,8192
 TR 210,46,12288
 MF 140,152,232
 MF 204,152,236
 TR 212,47,8192
 TR 214,47,12288
 MF 204,136,228
 MF 208,140,228
 MF 208,156,236
 MF 144,156,232
 MF 144,140,224
 s_waitcnt vmcnt(4)
 s_cmp_eq_u32 s70, 262144
 s_cbranch_scc1 L_chk4_2_ok
 s_add_u32 s71, s96, 2
 s_mov_b32 s47, 0x100000
L_chk4_2:
 v_subrev_u32 v32, s71, v31
 v_cmp_lt_u32 vcc, 2, v32
 s_nop 1
 s_cmp_eq_u64 vcc, 0
 s_cbranch_scc1 L_chk4_2_go
 s_sub_u32 s47, s47, 1
 s_cbranch_scc1 L_chk4_2_go
 buffer_load_dword v31, v30, s[60:63], s70 offen sc0 sc1
 s_waitcnt vmcnt(0)
 s_branch L_chk4_2
L_chk4_2_go:
 v_cmp_ne_u32 vcc, 2, v32
 s_nop 1
 s_cmp_eq_u64 vcc, 0
 s_cselect_b32 s70, 262144, s70
L_chk4_2_ok:
 s_waitcnt vmcnt(30) lgkmcnt(0)
 s_barrier
 MF 84,184,224
 TR 128,48,16384
 TR 130,48,20480
 TR 132,49,16384
 MF 84,200,232
 XL 0,28,0
 MF 148,200,236
 TR 134,49,20480
 TR 136,50,16384
 TR 138,50,20480
 MF 148,184,228
 MF 152,188,228
 TR 140,51,16384
 TR 142,51,20480
 MF 152,204,236
 XL 4,28,1024
 MF 88,204,232
 TR 144,48,24576
 TR 146,48,28672
 TR 148,49,24576
 MF 88,188,224
 MF 92,192,224
 TR 150,49,28672
 TR 152,50,24576
 TR 154,50,28672
 MF 92,208,232
 XL 8,28,2048
 MF 156,208,236
 TR 156,51,24576
 TR 158,51,28672
 MF 156,192,228
 XL 12,28,3072
 s_add_u32 s44, s44, 4096
 MF 160,196,228
 MF 160,212,236
 MF 96,212,232
 MF 96,196,224
 s_add_u32 m0, s46, 81920
 s_add_u32 s45, s45, 0x70000
 WL 225,0
 s_waitcnt vmcnt(22) lgkmcnt(0)
 MF 100,128,240
 TR 184,44,16384
 TR 186,44,20480
 TR 188,45,16384
 MF 100,144,248
 WL 227,1024
 MF 196,144,252
 TR 190,45,20480
 TR 192,46,16384
 TR 194,46,20480
 MF 196,128,244
 MF 200,132,244
 TR 196,47,16384
 TR 198,47,20480
 MF 200,148,252
 WL 229,2048
 MF 104,148,248
 TR 200,44,24576
 TR 202,44,28672
 TR 204,45,24576
 MF 104,132,240
 MF 140,136,240
 TR 206,45,28672
 TR 208,46,24576
 TR 210,46,28672
 MF 140,152,248
 WL 231,3072
 MF 204,152,252
 TR 212,47,24576
 TR 214,47,28672
 MF 204,136,244
 XL 16,28,0
 MF 208,140,244
 MF 208,156,252
 MF 144,156,248
 MF 144,140,240
 XL 20,28,1024
 s_waitcnt vmcnt(16)
 v_add_u32 v230, 1, v230
 buffer_store_dword v230, v228, s[60:63], s68 offen sc0 sc1
 s_waitcnt vmcnt(37) lgkmcnt(0)
 s_barrier
 MF 84,184,240
 TR 128,40,0
 TR 130,40,4096
 TR 132,41,0
 MF 84,200,248
 XL 24,28,2048
 MF 148,200,252
 TR 134,41,4096
 TR 136,42,0
 TR 138,42,4096
 MF 148,184,244
 MF 152,188,244
 TR 140,43,0
 TR 142,43,4096
 MF 152,204,252
 XL 28,28,3072
 s_add_u32 s44, s44, 4096
 MF 88,204,248
 TR 144,40,8192
 TR 146,40,12288
 TR 148,41,8192
 MF 88,188,240
 MF 92,192,240
 TR 150,41,12288
 TR 152,42,8192
 TR 154,42,12288
 MF 92,208,248
 s_add_u32 m0, s46, 131072
 s_add_u32 s45, s45, 0x70000
 WL 225,0
 MF 156,208,252
 TR 156,43,8192
 TR 158,43,12288
 MF 156,192,244
 WL 227,1024
 MF 160,196,244
 MF 160,212,252
 MF 96,212,248
 MF 96,196,240
 WL 229,2048
 s_waitcnt vmcnt(28) lgkmcnt(0)
 MF 100,128,32
 TR 184,36,0
 TR 186,36,4096
 TR 188,37,0
 MF 100,144,40
 WL 231,3072
 MF 196,144,44
 TR 190,37,4096
 TR 192,38,0
 TR 194,38,4096
 MF 196,128,36
 MF 200,132,36
 TR 196,39,0
 TR 198,39,4096
 MF 200,148,44
 XL 160,28,0
 MF 104,148,40
 TR 200,36,8192
 TR 202,36,12288
 TR 204,37,8192
 MF 104,132,32
 MF 140,136,32
 TR 206,37,12288
 TR 208,38,8192
 TR 210,38,12288
 MF 140,152,40
 XL 164,28,1024
 MF 204,152,44
 TR 212,39,8192
 TR 214,39,12288
 MF 204,136,36
 XL 168,28,2048
 MF 208,140,36
 MF 208,156,44
 MF 144,156,40
 MF 144,140,32
 XL 172,28,3072
 s_add_u32 s44, s44, 4096
 s_waitcnt vmcnt(43) lgkmcnt(0)
 s_barrier
 MF 84,184,32
 TR 128,40,16384
 TR 130,40,20480
 TR 132,41,16384
 MF 84,200,40
 s_add_u32 m0, s46, 147456
 s_add_u32 s45, s45, 0x70000
 WL 225,0
 MF 148,200,44
 TR 134,41,20480
 TR 136,42,16384
 TR 138,42,20480
 MF 148,184,36
 MF 152,188,36
 TR 140,43,16384
 TR 142,43,20480
 MF 152,204,44
 WL 227,1024
 MF 88,204,40
 TR 144,40,24576
 TR 146,40,28672
 TR 148,41,24576
 MF 88,188,32
 MF 92,192,32
 TR 150,41,28672
 TR 152,42,24576
 TR 154,42,28672
 MF 92,208,40
 WL 229,2048
 MF 156,208,44
 TR 156,43,24576
 TR 158,43,28672
 MF 156,192,36
 WL 231,3072
 MF 160,196,36
 MF 160,212,44
 MF 96,212,40
 MF 96,196,32
 XL 176,28,0
 s_waitcnt vmcnt(31) lgkmcnt(0)
 MF 100,128,48
 TR 184,36,16384
 TR 186,36,20480
 TR 188,37,16384
 MF 100,144,56
 XL 180,28,1024
 s_add_u32 s48, s34, 8388608
 s_addc_u32 s49, s35, 0
 s_mov_b32 s50, 5316608
 MF 196,144,60
 TR 190,37,20480
 TR 192,38,16384
 TR 194,38,20480
 MF 196,128,52
 s_lshr_b32 s52, s75, 2
 s_lshl_b32 s52, s52, 17
 s_lshl_b32 s10, s73, 13
 s_add_u32 s52, s52, s10
 s_lshl_b32 s10, s74, 12
 s_add_u32 s52, s52, s10
 s_and_b32 s10, s75, 3
 MF 200,132,52
 TR 196,39,16384
 TR 198,39,20480
 s_lshl_b32 s10, s10, 10
 s_add_u32 s52, s52, s10
 MF 200,148,60
 XL 216,28,2048
 s_add_u32 s53, s52, 65536
 s_lshl_b32 s54, s75, 6
 s_add_u32 s54, s54, 5308416
 MF 104,148,56
 TR 200,36,24576
 TR 202,36,28672
 TR 204,37,24576
 MF 104,132,48
 s_lshl_b32 s9, s2, 15
 s_lshl_b32 s10, s7, 13
 s_add_u32 s9, s9, s10
 s_xor_b32 s13, s9, 131072
 s_add_u32 s9, s9, 16777216
 s_add_u32 s10, s9, 4096
 s_add_u32 s13, s13, 16777216
 MF 140,136,48
 TR 206,37,28672
 TR 208,38,24576
 TR 210,38,28672
 MF 140,152,56
 XL 220,28,3072
 s_add_u32 s44, s44, 4096
 s_add_u32 s14, s13, 4096
 MF 204,152,60
 TR 212,39,24576
 TR 214,39,28672
 v_mov_b32 v230, s96
 MF 204,136,52
 s_add_u32 m0, s46, 98304
 s_add_u32 s45, s45, 0x70000
 WL 225,0
 MF 208,140,52
 v_lshlrev_b32 v20, 9, v30
 v_bfe_u32 v21, v224, 8, 1
 v_lshl_add_u32 v20, v21, 5, v20
 MF 208,156,60
 v_lshrrev_b32 v21, 9, v224
 v_lshl_add_u32 v20, v21, 4, v20
 MF 144,156,56
 s_branch L_sequential_preLN__sliding_local_dilated__geglu_ffn__prompt_kernel_pg16_skip
.p2align 12
L_sequential_preLN__sliding_local_dilated__geglu_ffn__prompt_kernel_pg16:
 s_branch L_sequential_preLN__sliding_local_dilated__geglu_ffn__prompt_kernel_hop5_ret
L_sequential_preLN__sliding_local_dilated__geglu_ffn__prompt_kernel_pg16b:
 s_branch L_sequential_preLN__sliding_local_dilated__geglu_ffn__prompt_kernel_sp_ret
L_sequential_preLN__sliding_local_dilated__geglu_ffn__prompt_kernel_pg16_skip:
 MF 144,140,48
 WL 227,1024
 s_waitcnt vmcnt(31) lgkmcnt(0)
 s_barrier
 MF 84,184,48
 TR 128,40,32768
 TR 130,40,36864
 TR 132,41,32768
 MF 84,200,56
 WL 229,2048
 MF 148,200,60
 TR 134,41,36864
 TR 136,42,32768
 TR 138,42,36864
 MF 148,184,52
 MF 152,188,52
 TR 140,43,32768
 TR 142,43,36864
 MF 152,204,60
 WL 231,3072
 MF 88,204,56
 TR 144,40,40960
 TR 146,40,45056
 TR 148,41,40960
 MF 88,188,48
 MF 92,192,48
 TR 150,41,45056
 TR 152,42,40960
 TR 154,42,45056
 MF 92,208,56
 XL 224,28,0
 MF 156,208,60
 TR 156,43,40960
 TR 158,43,45056
 MF 156,192,52
 XL 228,28,1024
 MF 160,196,52
 MF 160,212,60
 MF 96,212,56
 MF 96,196,48
 XL 232,28,2048
 s_waitcnt vmcnt(32) lgkmcnt(0)
 MF 100,128,0
 TR 184,36,32768
 TR 186,36,36864
 TR 188,37,32768
 MF 100,144,8
 XL 236,28,3072
 s_add_u32 s44, s44, 4096
 MF 196,144,12
 TR 190,37,36864
 TR 192,38,32768
 TR 194,38,36864
 MF 196,128,4
 MF 200,132,4
 TR 196,39,32768
 TR 198,39,36864
 MF 200,148,12
 s_add_u32 m0, s46, 114688
 s_add_u32 s45, s45, 0x70000
 WL 225,0
 MF 104,148,8
 TR 200,36,40960
 TR 202,36,45056
 TR 204,37,40960
 MF 104,132,0
 MF 140,136,0
 TR 206,37,45056
 TR 208,38,40960
 TR 210,38,45056
 MF 140,152,8
 WL 227,1024
 MF 204,152,12
 TR 212,39,40960
 TR 214,39,45056
 MF 204,136,4
 WL 229,2048
 MF 208,140,4
 MF 208,156,12
 MF 144,156,8
 MF 144,140,0
 WL 231,3072
 s_waitcnt vmcnt(33) lgkmcnt(0)
 s_barrier
 MF 84,184,0
 TR 128,40,49152
 TR 130,40,53248
 TR 132,41,49152
 MF 84,200,8
 XL 240,28,0
 MF 148,200,12
 TR 134,41,53248
 TR 136,42,49152
 TR 138,42,53248
 MF 148,184,4
 MF 152,188,4
 TR 140,43,49152
 TR 142,43,53248
 MF 152,204,12
 XL 244,28,1024
 MF 88,204,8
 TR 144,40,57344
 TR 146,40,61440
 TR 148,41,57344
 MF 88,188,0
 MF 92,192,0
 TR 150,41,61440
 TR 152,42,57344
 TR 154,42,61440
 MF 92,208,8
 XL 248,28,2048
 MF 156,208,12
 TR 156,43,57344
 TR 158,43,61440
 MF 156,192,4
 XL 252,28,3072
 s_add_u32 s44, s44, 4096
 MF 160,196,4
 MF 160,212,12
 MF 96,212,8
 MF 96,196,0
 s_add_u32 m0, s46, 32768
 s_add_u32 s45, s45, 0x70000
 WL 225,0
 s_waitcnt vmcnt(33) lgkmcnt(0)
 MF 100,128,16
 TR 184,36,49152
 TR 186,36,53248
 TR 188,37,49152
 MF 100,144,24
 WL 227,1024
 MF 196,144,28
 TR 190,37,53248
 TR 192,38,49152
 TR 194,38,53248
 MF 196,128,20
 MF 200,132,20
 TR 196,39,49152
 TR 198,39,53248
 MF 200,148,28
 WL 229,2048
 MF 104,148,24
 TR 200,36,57344
 TR 202,36,61440
 TR 204,37,57344
 MF 104,132,16
 MF 140,136,16
 TR 206,37,61440
 TR 208,38,57344
 TR 210,38,61440
 MF 140,152,24
 WL 231,3072
 MF 204,152,28
 TR 212,39,57344
 TR 214,39,61440
 MF 204,136,20
 XL 32,28,0
 MF 208,140,20
 MF 208,156,28
 MF 144,156,24
 MF 144,140,16
 XL 36,28,1024
 s_waitcnt vmcnt(34) lgkmcnt(0)
 s_barrier
 MF 84,184,16
 TR 128,48,32768
 TR 130,48,36864
 TR 132,49,32768
 MF 84,200,24
 XL 40,28,2048
 MF 148,200,28
 TR 134,49,36864
 TR 136,50,32768
 TR 138,50,36864
 MF 148,184,20
 MF 152,188,20
 TR 140,51,32768
 TR 142,51,36864
 MF 152,204,28
 XL 44,28,3072
 s_add_u32 s44, s44, 4096
 MF 88,204,24
 TR 144,48,40960
 TR 146,48,45056
 TR 148,49,40960
 MF 88,188,16
 s_add_u32 m0, s46, 49152
 s_add_u32 s45, s45, 0x70000
 WL 225,0
 MF 92,192,16
 TR 150,49,45056
 TR 152,50,40960
 TR 154,50,45056
 MF 92,208,24
 WL 227,1024
 MF 156,208,28
 TR 156,51,40960
 TR 158,51,45056
 MF 156,192,20
 MF 160,196,20
 MF 160,212,28
 WL 229,2048
 MF 96,212,24
 MF 96,196,16
 buffer_load_dword v31, v30, s[60:63], s70 offen sc0 sc1
 s_waitcnt vmcnt(36) lgkmcnt(0)
 MF 100,128,160
 TR 184,44,32768
 TR 186,44,36864
 TR 188,45,32768
 MF 100,144,168
 WL 231,3072
 MF 196,144,172
 TR 190,45,36864
 TR 192,46,32768
 TR 194,46,36864
 MF 196,128,164
 MF 200,132,164
 TR 196,47,32768
 TR 198,47,36864
 MF 200,148,172
 XL 48,28,0
 MF 104,148,168
 TR 200,44,40960
 TR 202,44,45056
 TR 204,45,40960
 MF 104,132,160
 MF 140,136,160
 TR 206,45,45056
 TR 208,46,40960
 TR 210,46,45056
 MF 140,152,168
 XL 52,28,1024
 MF 204,152,172
 TR 212,47,40960
 TR 214,47,45056
 MF 204,136,164
 XL 56,28,2048
 MF 208,140,164
 MF 208,156,172
 MF 144,156,168
 MF 144,140,160
 XL 60,28,3072
 s_add_u32 s44, s44, 4096
 s_waitcnt vmcnt(37) lgkmcnt(0)
 s_barrier
 MF 84,184,160
 TR 128,48,49152
 TR 130,48,53248
 TR 132,49,49152
 MF 84,200,168
 MF 148,200,172
 TR 134,49,53248
 TR 136,50,49152
 TR 138,50,53248
 MF 148,184,164
 s_add_u32 m0, s46, 65536
 s_add_u32 s45, s45, 0xffd00000
 WL 225,0
 MF 152,188,164
 TR 140,51,49152
 TR 142,51,53248
 MF 152,204,172
 MF 88,204,168
 TR 144,48,57344
 TR 146,48,61440
 TR 148,49,57344
 MF 88,188,160
 WL 227,1024
 MF 92,192,160
 TR 150,49,61440
 TR 152,50,57344
 TR 154,50,61440
 MF 92,208,168
 MF 156,208,172
 TR 156,51,57344
 TR 158,51,61440
 MF 156,192,164
 WL 229,2048
 MF 160,196,164
 MF 160,212,172
 MF 96,212,168
 MF 96,196,160
 WL 231,3072
 s_waitcnt vmcnt(37) lgkmcnt(0)
 MF 100,128,176
 TR 184,44,49152
 TR 186,44,53248
 TR 188,45,49152
 MF 100,144,216
 MF 196,144,220
 TR 190,45,53248
 TR 192,46,49152
 TR 194,46,53248
 MF 196,128,180
 MF 200,132,180
 TR 196,47,49152
 TR 198,47,53248
 MF 200,148,220
 MF 104,148,216
 TR 200,44,57344
 TR 202,44,61440
 TR 204,45,57344
 MF 104,132,176
 MF 140,136,176
 TR 206,45,61440
 TR 208,46,57344
 TR 210,46,61440
 MF 140,152,216
 MF 204,152,220
 TR 212,47,57344
 TR 214,47,61440
 MF 204,136,180
 MF 208,140,180
 MF 208,156,220
 MF 144,156,216
 MF 144,140,176
 s_waitcnt vmcnt(9)
 s_cmp_eq_u32 s70, 262144
 s_cbranch_scc1 L_chk4_3_ok
 s_add_u32 s71, s96, 3
 s_mov_b32 s47, 0x100000
L_chk4_3:
 v_subrev_u32 v32, s71, v31
 v_cmp_lt_u32 vcc, 1, v32
 s_nop 1
 s_cmp_eq_u64 vcc, 0
 s_cbranch_scc1 L_chk4_3_go
 s_sub_u32 s47, s47, 1
 s_cbranch_scc1 L_chk4_3_go
 buffer_load_dword v31, v30, s[60:63], s70 offen sc0 sc1
 s_waitcnt vmcnt(0)
 s_branch L_chk4_3
L_chk4_3_go:
 v_cmp_ne_u32 vcc, 1, v32
 s_nop 1
 s_cmp_eq_u64 vcc, 0
 s_cselect_b32 s70, 262144, s70
L_chk4_3_ok:
 s_waitcnt vmcnt(33) lgkmcnt(0)
 s_barrier
 MF 84,184,176
 TR 128,48,0
 TR 130,48,4096
 TR 132,49,0
 MF 84,200,216
 XL 0,28,0
 MF 148,200,220
 TR 134,49,4096
 TR 136,50,0
 TR 138,50,4096
 MF 148,184,180
 MF 152,188,180
 TR 140,51,0
 TR 142,51,4096
 MF 152,204,220
 XL 4,28,1024
 MF 88,204,216
 TR 144,48,8192
 TR 146,48,12288
 TR 148,49,8192
 MF 88,188,176
 MF 92,192,176
 TR 150,49,12288
 TR 152,50,8192
 TR 154,50,12288
 MF 92,208,216
 XL 8,28,2048
 MF 156,208,220
 TR 156,51,8192
 TR 158,51,12288
 MF 156,192,180
 XL 12,28,3072
 s_add_u32 s44, s44, 4096
 MF 160,196,180
 MF 160,212,220
 MF 96,212,216
 MF 96,196,176
 s_add_u32 m0, s46, 81920
 s_add_u32 s45, s45, 0x70000
 WL 225,0
 s_waitcnt vmcnt(34) lgkmcnt(0)
 MF 100,128,224
 TR 184,44,0
 TR 186,44,4096
 TR 188,45,0
 MF 100,144,232
 WL 227,1024
 MF 196,144,236
 TR 190,45,4096
 TR 192,46,0
 TR 194,46,4096
 MF 196,128,228
 MF 200,132,228
 TR 196,47,0
 TR 198,47,4096
 MF 200,148,236
 WL 229,2048
 MF 104,148,232
 TR 200,44,8192
 TR 202,44,12288
 TR 204,45,8192
 MF 104,132,224
 MF 140,136,224
 TR 206,45,12288
 TR 208,46,8192
 TR 210,46,12288
 MF 140,152,232
 WL 231,3072
 MF 204,152,236
 TR 212,47,8192
 TR 214,47,12288
 MF 204,136,228
 XL 16,28,0
 MF 208,140,228
 MF 208,156,236
 MF 144,156,232
 MF 144,140,224
 XL 20,28,1024
 s_waitcnt vmcnt(35) lgkmcnt(0)
 s_barrier
 MF 84,184,224
 TR 128,48,16384
 TR 130,48,20480
 TR 132,49,16384
 MF 84,200,232
 XL 24,28,2048
 MF 148,200,236
 TR 134,49,20480
 TR 136,50,16384
 TR 138,50,20480
 MF 148,184,228
 MF 152,188,228
 TR 140,51,16384
 TR 142,51,20480
 MF 152,204,236
 XL 28,28,3072
 s_add_u32 s44, s44, 4096
 MF 88,204,232
 TR 144,48,24576
 TR 146,48,28672
 TR 148,49,24576
 MF 88,188,224
 MF 92,192,224
 TR 150,49,28672
 TR 152,50,24576
 TR 154,50,28672
 MF 92,208,232
 s_add_u32 m0, s46, 131072
 s_add_u32 s45, s45, 0x70000
 WL 225,0
 MF 156,208,236
 TR 156,51,24576
 TR 158,51,28672
 MF 156,192,228
 WL 227,1024
 MF 160,196,228
 MF 160,212,236
 MF 96,212,232
 MF 96,196,224
 WL 229,2048
 s_waitcnt vmcnt(36) lgkmcnt(0)
 MF 100,128,240
 TR 184,44,16384
 TR 186,44,20480
 TR 188,45,16384
 MF 100,144,248
 WL 231,3072
 MF 196,144,252
 TR 190,45,20480
 TR 192,46,16384
 TR 194,46,20480
 MF 196,128,244
 MF 200,132,244
 TR 196,47,16384
 TR 198,47,20480
 MF 200,148,252
 XL 160,28,0
 MF 104,148,248
 TR 200,44,24576
 TR 202,44,28672
 TR 204,45,24576
 MF 104,132,240
 MF 140,136,240
 TR 206,45,28672
 TR 208,46,24576
 TR 210,46,28672
 MF 140,152,248
 XL 164,28,1024
 MF 204,152,252
 TR 212,47,24576
 TR 214,47,28672
 MF 204,136,244
 XL 168,28,2048
 MF 208,140,244
 MF 208,156,252
 MF 144,156,248
 MF 144,140,240
 XL 172,28,3072
 s_add_u32 s44, s44, 4096
 s_waitcnt vmcnt(37) lgkmcnt(0)
 s_barrier
 MF 84,184,240
 TR 128,40,0
 TR 130,40,4096
 TR 132,41,0
 MF 84,200,248
 s_add_u32 m0, s46, 147456
 s_add_u32 s45, s45, 0x70000
 WL 225,0
 MF 148,200,252
 TR 134,41,4096
 TR 136,42,0
 TR 138,42,4096
 MF 148,184,244
 MF 152,188,244
 TR 140,43,0
 TR 142,43,4096
 MF 152,204,252
 WL 227,1024
 MF 88,204,248
 TR 144,40,8192
 TR 146,40,12288
 TR 148,41,8192
 MF 88,188,240
 MF 92,192,240
 TR 150,41,12288
 TR 152,42,8192
 TR 154,42,12288
 MF 92,208,248
 WL 229,2048
 s_branch L_sequential_preLN__sliding_local_dilated__geglu_ffn__prompt_kernel_pg17_skip
.p2align 12
L_sequential_preLN__sliding_local_dilated__geglu_ffn__prompt_kernel_pg17:
 s_branch L_sequential_preLN__sliding_local_dilated__geglu_ffn__prompt_kernel_hop5_ret
L_sequential_preLN__sliding_local_dilated__geglu_ffn__prompt_kernel_pg17b:
 s_branch L_sequential_preLN__sliding_local_dilated__geglu_ffn__prompt_kernel_sp_ret
L_sequential_preLN__sliding_local_dilated__geglu_ffn__prompt_kernel_pg17_skip:
 MF 156,208,252
 TR 156,43,8192
 TR 158,43,12288
 MF 156,192,244
 WL 231,3072
 MF 160,196,244
 MF 160,212,252
 MF 96,212,248
 MF 96,196,240
 XL 176,28,0
 s_waitcnt vmcnt(38) lgkmcnt(0)
 MF 100,128,32
 TR 184,36,0
 TR 186,36,4096
 TR 188,37,0
 MF 100,144,40
 XL 180,28,1024
 MF 196,144,44
 TR 190,37,4096
 TR 192,38,0
 TR 194,38,4096
 MF 196,128,36
 MF 200,132,36
 TR 196,39,0
 TR 198,39,4096
 MF 200,148,44
 XL 216,28,2048
 MF 104,148,40
 TR 200,36,8192
 TR 202,36,12288
 TR 204,37,8192
 MF 104,132,32
 MF 140,136,32
 TR 206,37,12288
 TR 208,38,8192
 TR 210,38,12288
 MF 140,152,40
 XL 220,28,3072
 s_add_u32 s44, s44, 4096
 MF 204,152,44
 TR 212,39,8192
 TR 214,39,12288
 MF 204,136,36
 s_add_u32 m0, s46, 98304
 s_add_u32 s45, s45, 0x70000
 WL 225,0
 MF 208,140,36
 MF 208,156,44
 MF 144,156,40
 MF 144,140,32
 WL 227,1024
 s_waitcnt vmcnt(38) lgkmcnt(0)
 s_barrier
 MF 84,184,32
 TR 128,40,16384
 TR 130,40,20480
 TR 132,41,16384
 MF 84,200,40
 WL 229,2048
 MF 148,200,44
 TR 134,41,20480
 TR 136,42,16384
 TR 138,42,20480
 MF 148,184,36
 MF 152,188,36
 TR 140,43,16384
 TR 142,43,20480
 MF 152,204,44
 WL 231,3072
 MF 88,204,40
 TR 144,40,24576
 TR 146,40,28672
 TR 148,41,24576
 MF 88,188,32
 MF 92,192,32
 TR 150,41,28672
 TR 152,42,24576
 TR 154,42,28672
 MF 92,208,40
 XL 224,28,0
 MF 156,208,44
 TR 156,43,24576
 TR 158,43,28672
 MF 156,192,36
 XL 228,28,1024
 MF 160,196,36
 MF 160,212,44
 MF 96,212,40
 MF 96,196,32
 XL 232,28,2048
 s_waitcnt vmcnt(39) lgkmcnt(0)
 MF 100,128,48
 TR 184,36,16384
 TR 186,36,20480
 TR 188,37,16384
 MF 100,144,56
 XL 236,28,3072
 s_add_u32 s44, s44, 4096
 MF 196,144,60
 TR 190,37,20480
 TR 192,38,16384
 TR 194,38,20480
 MF 196,128,52
 MF 200,132,52
 TR 196,39,16384
 TR 198,39,20480
 MF 200,148,60
 s_add_u32 m0, s46, 114688
 s_add_u32 s45, s45, 0x70000
 WL 225,0
 MF 104,148,56
 TR 200,36,24576
 TR 202,36,28672
 TR 204,37,24576
 MF 104,132,48
 MF 140,136,48
 TR 206,37,28672
 TR 208,38,24576
 TR 210,38,28672
 MF 140,152,56
 WL 227,1024
 MF 204,152,60
 TR 212,39,24576
 TR 214,39,28672
 MF 204,136,52
 WL 229,2048
 MF 208,140,52
 MF 208,156,60
 MF 144,156,56
 MF 144,140,48
 WL 231,3072
 s_waitcnt vmcnt(40) lgkmcnt(0)
 s_barrier
 MF 84,184,48
 TR 128,40,32768
 TR 130,40,36864
 TR 132,41,32768
 MF 84,200,56
 XL 240,28,0
 MF 148,200,60
 TR 134,41,36864
 TR 136,42,32768
 TR 138,42,36864
 MF 148,184,52
 MF 152,188,52
 TR 140,43,32768
 TR 142,43,36864
 MF 152,204,60
 XL 244,28,1024
 MF 88,204,56
 TR 144,40,40960
 TR 146,40,45056
 TR 148,41,40960
 MF 88,188,48
 MF 92,192,48
 TR 150,41,45056
 TR 152,42,40960
 TR 154,42,45056
 MF 92,208,56
 XL 248,28,2048
 MF 156,208,60
 TR 156,43,40960
 TR 158,43,45056
 MF 156,192,52
 XL 252,28,3072
 s_add_u32 s44, s44, 4096
 MF 160,196,52
 MF 160,212,60
 MF 96,212,56
 MF 96,196,48
 s_add_u32 m0, s46, 32768
 s_add_u32 s45, s45, 0x70000
 WL 225,0
 s_waitcnt vmcnt(41) lgkmcnt(0)
 MF 100,128,0
 TR 184,36,32768
 TR 186,36,36864
 TR 188,37,32768
 MF 100,144,8
 WL 227,1024
 MF 196,144,12
 TR 190,37,36864
 TR 192,38,32768
 TR 194,38,36864
 MF 196,128,4
 MF 200,132,4
 TR 196,39,32768
 TR 198,39,36864
 MF 200,148,12
 WL 229,2048
 MF 104,148,8
 TR 200,36,40960
 TR 202,36,45056
 TR 204,37,40960
 MF 104,132,0
 MF 140,136,0
 TR 206,37,45056
 TR 208,38,40960
 TR 210,38,45056
 MF 140,152,8
 WL 231,3072
 MF 204,152,12
 TR 212,39,40960
 TR 214,39,45056
 MF 204,136,4
 XL 32,28,0
 MF 208,140,4
 MF 208,156,12
 MF 144,156,8
 MF 144,140,0
 XL 36,28,1024
 s_waitcnt vmcnt(42) lgkmcnt(0)
 s_barrier
 MF 84,184,0
 TR 128,40,49152
 TR 130,40,53248
 TR 132,41,49152
 MF 84,200,8
 XL 40,28,2048
 MF 148,200,12
 TR 134,41,53248
 TR 136,42,49152
 TR 138,42,53248
 MF 148,184,4
 MF 152,188,4
 TR 140,43,49152
 TR 142,43,53248
 MF 152,204,12
 XL 44,28,3072
 s_add_u32 s44, s44, 4096
 MF 88,204,8
 TR 144,40,57344
 TR 146,40,61440
 TR 148,41,57344
 MF 88,188,0
 s_add_u32 m0, s46, 49152
 s_add_u32 s45, s45, 0x70000
 WL 225,0
 MF 92,192,0
 TR 150,41,61440
 TR 152,42,57344
 TR 154,42,61440
 MF 92,208,8
 WL 227,1024
 MF 156,208,12
 TR 156,43,57344
 TR 158,43,61440
 MF 156,192,4
 MF 160,196,4
 MF 160,212,12
 WL 229,2048
 MF 96,212,8
 MF 96,196,0
 buffer_load_dword v31, v30, s[60:63], s70 offen sc0 sc1
 s_waitcnt vmcnt(44) lgkmcnt(0)
 MF 100,128,16
 TR 184,36,49152
 TR 186,36,53248
 TR 188,37,49152
 MF 100,144,24
 WL 231,3072
 MF 196,144,28
 TR 190,37,53248
 TR 192,38,49152
 TR 194,38,53248
 MF 196,128,20
 MF 200,132,20
 TR 196,39,49152
 TR 198,39,53248
 MF 200,148,28
 XL 48,28,0
 MF 104,148,24
 TR 200,36,57344
 TR 202,36,61440
 TR 204,37,57344
 MF 104,132,16
 MF 140,136,16
 TR 206,37,61440
 TR 208,38,57344
 TR 210,38,61440
 MF 140,152,24
 XL 52,28,1024
 MF 204,152,28
 TR 212,39,57344
 TR 214,39,61440
 MF 204,136,20
 XL 56,28,2048
 MF 208,140,20
 MF 208,156,28
 MF 144,156,24
 MF 144,140,16
 XL 60,28,3072
 s_add_u32 s44, s44, 4096
 s_waitcnt vmcnt(45) lgkmcnt(0)
 s_barrier
 MF 84,184,16
 TR 128,48,32768
 TR 130,48,36864
 TR 132,49,32768
 MF 84,200,24
 MF 148,200,28
 TR 134,49,36864
 TR 136,50,32768
 TR 138,50,36864
 MF 148,184,20
 s_add_u32 m0, s46, 65536
 s_add_u32 s45, s45, 0xffd00000
 s_add_u32 s45, s45, s69
 WL 225,0
 MF 152,188,20
 TR 140,51,32768
 TR 142,51,36864
 MF 152,204,28
 MF 88,204,24
 TR 144,48,40960
 TR 146,48,45056
 TR 148,49,40960
 MF 88,188,16
 WL 227,1024
 MF 92,192,16
 TR 150,49,45056
 TR 152,50,40960
 TR 154,50,45056
 MF 92,208,24
 MF 156,208,28
 TR 156,51,40960
 TR 158,51,45056
 MF 156,192,20
 WL 229,2048
 MF 160,196,20
 MF 160,212,28
 MF 96,212,24
 MF 96,196,16
 WL 231,3072
 s_waitcnt vmcnt(45) lgkmcnt(0)
 MF 100,128,160
 TR 184,44,32768
 TR 186,44,36864
 TR 188,45,32768
 MF 100,144,168
 buffer_load_dwordx4 v[0:3], v224, s[48:51], s52 offen offset:0
 MF 196,144,172
 TR 190,45,36864
 TR 192,46,32768
 TR 194,46,36864
 MF 196,128,164
 MF 200,132,164
 TR 196,47,32768
 TR 198,47,36864
 MF 200,148,172
 buffer_load_dwordx4 v[4:7], v224, s[48:51], s53 offen offset:0
 MF 104,148,168
 TR 200,44,40960
 TR 202,44,45056
 TR 204,45,40960
 MF 104,132,160
 buffer_load_dwordx4 v[8:11], v224, s[48:51], s52 offen offset:1024
 MF 140,136,160
 TR 206,45,45056
 TR 208,46,40960
 TR 210,46,45056
 MF 140,152,168
 buffer_load_dwordx4 v[12:15], v224, s[48:51], s53 offen offset:1024
 MF 204,152,172
 TR 212,47,40960
 TR 214,47,45056
 MF 204,136,164
 MF 208,140,164
 MF 208,156,172
 buffer_load_dword v16, v30, s[48:51], s54 offen
 MF 144,156,168
 MF 144,140,160
 buffer_load_dword v18, v30, s[48:51], s54 offen offset:64
 s_waitcnt vmcnt(15)
 s_cmp_eq_u32 s70, 262144
 s_cbranch_scc1 L_chk4_4_ok
 s_add_u32 s71, s96, 4
 s_mov_b32 s47, 0x100000
L_chk4_4:
 v_subrev_u32 v32, s71, v31
 v_cmp_lt_u32 vcc, 0, v32
 s_nop 1
 s_cmp_eq_u64 vcc, 0
 s_cbranch_scc1 L_chk4_4_go
 s_sub_u32 s47, s47, 1
 s_cbranch_scc1 L_chk4_4_go
 buffer_load_dword v31, v30, s[60:63], s70 offen sc0 sc1
 s_waitcnt vmcnt(0)
 s_branch L_chk4_4
L_chk4_4_go:
 v_cmp_ne_u32 vcc, 0, v32
 s_nop 1
 s_cmp_eq_u64 vcc, 0
 s_cselect_b32 s70, 262144, s70
L_chk4_4_ok:
 s_waitcnt vmcnt(47) lgkmcnt(0)
 s_barrier
 MF 84,184,160
 TR 128,48,49152
 TR 130,48,53248
 TR 132,49,49152
 MF 84,200,168
 buffer_load_dwordx2 a[0:1], v29, s[36:39], s44 offen offset:0
 MF 148,200,172
 TR 134,49,53248
 TR 136,50,49152
 TR 138,50,53248
 MF 148,184,164
 MF 152,188,164
 TR 140,51,49152
 TR 142,51,53248
 MF 152,204,172
 buffer_load_dwordx2 a[2:3], v29, s[36:39], s44 offen offset:512
 MF 88,204,168
 TR 144,48,57344
 TR 146,48,61440
 TR 148,49,57344
 MF 88,188,160
 MF 92,192,160
 TR 150,49,61440
 TR 152,50,57344
 TR 154,50,61440
 MF 92,208,168
 buffer_load_dwordx2 a[4:5], v29, s[36:39], s44 offen offset:1024
 MF 156,208,172
 TR 156,51,57344
 TR 158,51,61440
 MF 156,192,164
 buffer_load_dwordx2 a[6:7], v29, s[36:39], s44 offen offset:1536
 MF 160,196,164
 MF 160,212,172
 MF 96,212,168
 MF 96,196,160
 buffer_load_dwordx2 a[8:9], v29, s[36:39], s44 offen offset:2048
 s_waitcnt vmcnt(48) lgkmcnt(0)
 MF 100,128,176
 TR 184,44,49152
 TR 186,44,53248
 TR 188,45,49152
 MF 100,144,216
 buffer_load_dwordx2 a[10:11], v29, s[36:39], s44 offen offset:2560
 MF 196,144,220
 TR 190,45,53248
 TR 192,46,49152
 TR 194,46,53248
 MF 196,128,180
 MF 200,132,180
 TR 196,47,49152
 TR 198,47,53248
 MF 200,148,220
 buffer_load_dwordx2 a[12:13], v29, s[36:39], s44 offen offset:3072
 MF 104,148,216
 TR 200,44,57344
 TR 202,44,61440
 TR 204,45,57344
 MF 104,132,176
 MF 140,136,176
 TR 206,45,61440
 TR 208,46,57344
 TR 210,46,61440
 MF 140,152,216
 buffer_load_dwordx2 a[14:15], v29, s[36:39], s44 offen offset:3584
 s_add_u32 s44, s44, 4096
 MF 204,152,220
 TR 212,47,57344
 TR 214,47,61440
 MF 204,136,180
 s_add_u32 m0, s46, 81920
 s_add_u32 s45, s45, 0xe0000
 WL 225,0
 MF 208,140,180
 MF 208,156,220
 MF 144,156,216
 MF 144,140,176
 WL 227,1024
 s_waitcnt vmcnt(49) lgkmcnt(0)
 s_barrier
 MF 84,184,176
 TR 128,48,0
 TR 130,48,4096
 TR 132,49,0
 MF 84,200,216
 WL 229,2048
 MF 148,200,220
 TR 134,49,4096
 TR 136,50,0
 TR 138,50,4096
 MF 148,184,180
 MF 152,188,180
 TR 140,51,0
 TR 142,51,4096
 MF 152,204,220
 WL 231,3072
 MF 88,204,216
 TR 144,48,8192
 TR 146,48,12288
 TR 148,49,8192
 MF 88,188,176
 MF 92,192,176
 TR 150,49,12288
 TR 152,50,8192
 TR 154,50,12288
 MF 92,208,216
 buffer_load_dwordx2 a[16:17], v29, s[36:39], s44 offen offset:0
 MF 156,208,220
 TR 156,51,8192
 TR 158,51,12288
 MF 156,192,180
 buffer_load_dwordx2 a[18:19], v29, s[36:39], s44 offen offset:512
 MF 160,196,180
 MF 160,212,220
 MF 96,212,216
 MF 96,196,176
 buffer_load_dwordx2 a[20:21], v29, s[36:39], s44 offen offset:1024
 s_waitcnt vmcnt(46) lgkmcnt(0)
 s_barrier
 MF 100,128,224
 TR 184,48,16384
 TR 186,48,20480
 TR 188,49,16384
 MF 100,144,232
 buffer_load_dwordx2 a[22:23], v29, s[36:39], s44 offen offset:1536
 MF 196,144,236
 TR 190,49,20480
 TR 192,50,16384
 TR 194,50,20480
 MF 196,128,228
 v_lshrrev_b32 v58, 8, v224
 v_lshlrev_b32 v58, 4, v58
 MF 200,132,228
 TR 196,51,16384
 TR 198,51,20480
 s_branch L_sequential_preLN__sliding_local_dilated__geglu_ffn__prompt_kernel_pg18_skip
.p2align 12
L_sequential_preLN__sliding_local_dilated__geglu_ffn__prompt_kernel_pg18:
 s_branch L_sequential_preLN__sliding_local_dilated__geglu_ffn__prompt_kernel_hop5_ret
L_sequential_preLN__sliding_local_dilated__geglu_ffn__prompt_kernel_pg18b:
 s_branch L_sequential_preLN__sliding_local_dilated__geglu_ffn__prompt_kernel_sp_ret
L_sequential_preLN__sliding_local_dilated__geglu_ffn__prompt_kernel_pg18_skip:
 MF 200,148,236
 buffer_load_dwordx2 a[24:25], v29, s[36:39], s44 offen offset:2048
 MF 104,148,232
 TR 200,48,24576
 TR 202,48,28672
 TR 204,49,24576
 MF 104,132,224
 v_sub_u32 v58, v30, v58
 v_lshrrev_b32 v58, 3, v58
 MF 140,136,224
 TR 206,49,28672
 TR 208,50,24576
 TR 210,50,28672
 MF 140,152,232
 buffer_load_dwordx2 a[26:27], v29, s[36:39], s44 offen offset:2560
 MF 204,152,236
 TR 212,51,24576
 TR 214,51,28672
 MF 204,136,228
 buffer_load_dwordx2 a[28:29], v29, s[36:39], s44 offen offset:3072
 MF 208,140,228
 v_and_b32 v59, 16, v224
 v_mov_b32 v52, 0x3f80
 MF 208,156,236
 v_lshlrev_b32 v59, v59, v52
 MF 144,156,232
 MF 144,140,224
 buffer_load_dwordx2 a[30:31], v29, s[36:39], s44 offen offset:3584
 s_add_u32 s44, s44, 4096
 s_waitcnt vmcnt(43) lgkmcnt(0)
 s_barrier
 MF 100,184,240
 TR 128,40,0
 TR 130,40,4096
 TR 132,41,0
 MF 100,200,248
 s_add_u32 m0, s46, 131072
 s_add_u32 s45, s45, 0xe0000
 WL 225,0
 MF 196,200,252
 TR 134,41,4096
 TR 136,42,0
 TR 138,42,4096
 MF 196,184,244
 v_cmp_eq_u32 vcc, 0, v58
 s_nop 1
 v_cndmask_b32 v54, 0, v59, vcc
 MF 200,188,244
 TR 140,43,0
 TR 142,43,4096
 MF 200,204,252
 WL 227,1024
 MF 104,204,248
 TR 144,40,8192
 TR 146,40,12288
 TR 148,41,8192
 MF 104,188,240
 v_cmp_eq_u32 vcc, 1, v58
 s_nop 1
 v_cndmask_b32 v55, 0, v59, vcc
 MF 140,192,240
 TR 150,41,12288
 TR 152,42,8192
 TR 154,42,12288
 MF 140,208,248
 WL 229,2048
 MF 204,208,252
 TR 156,43,8192
 TR 158,43,12288
 MF 204,192,244
 WL 231,3072
 MF 208,196,244
 v_mov_b32 v52, 0
 v_mov_b32 v53, 0
 MF 208,212,252
 v_mov_b32 v56, 0
 v_mov_b32 v57, 0
 MF 144,212,248
 MF 144,196,240
 buffer_load_dwordx2 a[160:161], v29, s[36:39], s44 offen offset:0
 s_waitcnt vmcnt(25) lgkmcnt(0)
 s_barrier
 MF 100,128,32
 TR 184,40,16384
 TR 186,40,20480
 TR 188,41,16384
 MF 100,144,40
 buffer_load_dwordx2 a[162:163], v29, s[36:39], s44 offen offset:512
 MF 196,144,44
 TR 190,41,20480
 TR 192,42,16384
 TR 194,42,20480
 MF 196,128,36
 v_mfma_f32_16x16x32_bf16 v[84:87], v[54:57], v[0:3], v[84:87]
 MF 200,132,36
 TR 196,43,16384
 TR 198,43,20480
 MF 200,148,44
 buffer_load_dwordx2 a[164:165], v29, s[36:39], s44 offen offset:1024
 MF 104,148,40
 TR 200,40,24576
 TR 202,40,28672
 TR 204,41,24576
 MF 104,132,32
 v_mfma_f32_16x16x32_bf16 v[88:91], v[52:55], v[0:3], v[88:91]
 MF 140,136,32
 TR 206,41,28672
 TR 208,42,24576
 TR 210,42,28672
 MF 140,152,40
 buffer_load_dwordx2 a[166:167], v29, s[36:39], s44 offen offset:1536
 MF 204,152,44
 TR 212,43,24576
 TR 214,43,28672
 MF 204,136,36
 buffer_load_dwordx2 a[168:169], v29, s[36:39], s44 offen offset:2048
 MF 208,140,36
 v_mfma_f32_16x16x32_bf16 v[92:95], v[54:57], v[4:7], v[92:95]
 MF 208,156,44
 v_mfma_f32_16x16x32_bf16 v[96:99], v[52:55], v[4:7], v[96:99]
 MF 144,156,40
 MF 144,140,32
 buffer_load_dwordx2 a[170:171], v29, s[36:39], s44 offen offset:2560
 s_waitcnt vmcnt(36) lgkmcnt(0)
 s_barrier
 MF 100,184,48
 TR 128,40,32768
 TR 130,40,36864
 TR 132,41,32768
 MF 100,200,56
 buffer_load_dwordx2 a[172:173], v29, s[36:39], s44 offen offset:3072
 MF 196,200,60
 TR 134,41,36864
 TR 136,42,32768
 TR 138,42,36864
 MF 196,184,52
 v_mfma_f32_16x16x32_bf16 v[148:151], v[54:57], v[8:11], v[148:151]
 MF 200,188,52
 TR 140,43,32768
 TR 142,43,36864
 MF 200,204,60
 buffer_load_dwordx2 a[174:175], v29, s[36:39], s44 offen offset:3584
 s_add_u32 s44, s44, 4096
 MF 104,204,56
 TR 144,40,40960
 TR 146,40,45056
 TR 148,41,40960
 MF 104,188,48
 v_mfma_f32_16x16x32_bf16 v[152:155], v[52:55], v[8:11], v[152:155]
 MF 140,192,48
 TR 150,41,45056
 TR 152,42,40960
 TR 154,42,45056
 MF 140,208,56
 s_add_u32 m0, s46, 147456
 s_add_u32 s45, s45, 0xe0000
 WL 225,0
 MF 204,208,60
 TR 156,43,40960
 TR 158,43,45056
 MF 204,192,52
 WL 227,1024
 MF 208,196,52
 v_mfma_f32_16x16x32_bf16 v[156:159], v[54:57], v[12:15], v[156:159]
 MF 208,212,60
 v_mfma_f32_16x16x32_bf16 v[160:163], v[52:55], v[12:15], v[160:163]
 MF 144,212,56
 MF 144,196,48
 WL 229,2048
 s_waitcnt vmcnt(23) lgkmcnt(0)
 s_barrier
 MF 100,128,0
 TR 184,40,49152
 TR 186,40,53248
 TR 188,41,49152
 MF 100,144,8
 WL 231,3072
 MF 196,144,12
 TR 190,41,53248
 TR 192,42,49152
 TR 194,42,53248
 MF 196,128,4
 MF 200,132,4
 TR 196,43,49152
 TR 198,43,53248
 MF 200,148,12
 buffer_load_dwordx2 a[176:177], v29, s[36:39], s44 offen offset:0
 MF 104,148,8
 TR 200,40,57344
 TR 202,40,61440
 TR 204,41,57344
 MF 104,132,0
 MF 140,136,0
 TR 206,41,61440
 TR 208,42,57344
 TR 210,42,61440
 MF 140,152,8
 buffer_load_dwordx2 a[178:179], v29, s[36:39], s44 offen offset:512
 MF 204,152,12
 TR 212,43,57344
 TR 214,43,61440
 MF 204,136,4
 buffer_load_dwordx2 a[180:181], v29, s[36:39], s44 offen offset:1024
 MF 208,140,4
 MF 208,156,12
 MF 144,156,8
 MF 144,140,0
 buffer_load_dwordx2 a[182:183], v29, s[36:39], s44 offen offset:1536
 s_waitcnt vmcnt(16) lgkmcnt(0)
 s_barrier
 MF 100,184,16
 TR 128,48,32768
 TR 130,48,36864
 TR 132,49,32768
 MF 100,200,24
 v_pk_add_f32 v[84:85], v[84:85], v[16:17] op_sel_hi:[1,0]
 v_pk_add_f32 v[86:87], v[86:87], v[16:17] op_sel_hi:[1,0]
 v_pk_add_f32 v[88:89], v[88:89], v[16:17] op_sel_hi:[1,0]
 v_pk_add_f32 v[90:91], v[90:91], v[16:17] op_sel_hi:[1,0]
 v_pk_add_f32 v[92:93], v[92:93], v[16:17] op_sel_hi:[1,0]
 v_pk_add_f32 v[94:95], v[94:95], v[16:17] op_sel_hi:[1,0]
 v_pk_add_f32 v[96:97], v[96:97], v[16:17] op_sel_hi:[1,0]
 v_pk_add_f32 v[98:99], v[98:99], v[16:17] op_sel_hi:[1,0]
 v_pk_add_f32 v[148:149], v[148:149], v[18:19] op_sel_hi:[1,0]
 v_pk_add_f32 v[150:151], v[150:151], v[18:19] op_sel_hi:[1,0]
 v_pk_add_f32 v[152:153], v[152:153], v[18:19] op_sel_hi:[1,0]
 v_pk_add_f32 v[154:155], v[154:155], v[18:19] op_sel_hi:[1,0]
 v_pk_add_f32 v[156:157], v[156:157], v[18:19] op_sel_hi:[1,0]
 v_pk_add_f32 v[158:159], v[158:159], v[18:19] op_sel_hi:[1,0]
 v_pk_add_f32 v[160:161], v[160:161], v[18:19] op_sel_hi:[1,0]
 v_pk_add_f32 v[162:163], v[162:163], v[18:19] op_sel_hi:[1,0]
 s_nop 1
 MF 196,200,28
 TR 134,49,36864
 TR 136,50,32768
 TR 138,50,36864
 MF 196,184,20
 buffer_load_dwordx2 a[216:217], v29, s[36:39], s44 offen offset:2048
 MF 200,188,20
 TR 140,51,32768
 TR 142,51,36864
 MF 200,204,28
 MF 104,204,24
 TR 144,48,40960
 TR 146,48,45056
 TR 148,49,40960
 MF 104,188,16
 buffer_load_dwordx2 a[218:219], v29, s[36:39], s44 offen offset:2560
 MF 140,192,16
 TR 150,49,45056
 TR 152,50,40960
 TR 154,50,45056
 MF 140,208,24
 MF 204,208,28
 TR 156,51,40960
 TR 158,51,45056
 MF 204,192,20
 buffer_load_dwordx2 a[220:221], v29, s[36:39], s44 offen offset:3072
 MF 208,196,20
 MF 208,212,28
 MF 144,212,24
 MF 144,196,16
 buffer_load_dwordx2 a[222:223], v29, s[36:39], s44 offen offset:3584
 s_add_u32 s44, s44, 4096
 s_waitcnt vmcnt(8) lgkmcnt(0)
 s_barrier
 MF 100,128,160
 TR 184,48,49152
 TR 186,48,53248
 TR 188,49,49152
 MF 100,144,168
 v_mov_b32 v111, s96
 v_mov_b32 v115, s96
 MF 196,144,172
 TR 190,49,53248
 TR 192,50,49152
 TR 194,50,53248
 MF 196,128,164
 v_mov_b32 v119, s96
 v_mov_b32 v123, s96
 MF 200,132,164
 TR 196,51,49152
 TR 198,51,53248
 MF 200,148,172
 v_mov_b32 v127, s96
 v_mov_b32 v131, s96
 MF 104,148,168
 TR 200,48,57344
 TR 202,48,61440
 TR 204,49,57344
 MF 104,132,160
 v_mov_b32 v129, 0
 v_mov_b32 v130, 0
 MF 140,136,160
 TR 206,49,61440
 TR 208,50,57344
 TR 210,50,61440
 MF 140,152,168
 MF 204,152,172
 TR 212,51,57344
 TR 214,51,61440
 MF 204,136,164
 MF 208,140,164
 MF 208,156,172
 MF 144,156,168
 MF 144,140,160
 s_waitcnt vmcnt(0) lgkmcnt(0)
 MF 100,184,176
 TR 128,44,0
 TR 130,44,4096
 TR 132,45,0
 MF 100,200,216
 MF 196,200,220
 TR 134,45,4096
 TR 136,46,0
 TR 138,46,4096
 MF 196,184,180
 MF 200,188,180
 TR 140,47,0
 TR 142,47,4096
 MF 200,204,220
 MF 104,204,216
 TR 144,44,8192
 TR 146,44,12288
 TR 148,45,8192
 MF 104,188,176
 MF 140,192,176
 TR 150,45,12288
 TR 152,46,8192
 TR 154,46,12288
 MF 140,208,216
 MF 204,208,220
 TR 156,47,8192
 TR 158,47,12288
 MF 204,192,180
 MF 208,196,180
 MF 208,212,220
 MF 144,212,216
 MF 144,196,176
 s_waitcnt lgkmcnt(0)
 MF 84,128,224
 TR 184,44,16384
 TR 186,44,20480
 TR 188,45,16384
 MF 84,144,232
 MF 148,144,236
 TR 190,45,20480
 TR 192,46,16384
 TR 194,46,20480
 MF 148,128,228
 v_cvt_pk_bf16_f32 v108, v100, v101
 v_cvt_pk_bf16_f32 v109, v102, v103
 v_cvt_pk_bf16_f32 v110, v104, v105
 MF 152,132,228
 TR 196,47,16384
 TR 198,47,20480
 MF 152,148,236
 buffer_store_dwordx4 v[108:111], v224, s[56:59], s9 offen offset:0 sc0 sc1
 v_cvt_pk_bf16_f32 v112, v106, v107
 v_cvt_pk_bf16_f32 v113, v140, v141
 MF 88,148,232
 TR 200,44,24576
 TR 202,44,28672
 TR 204,45,24576
 MF 88,132,224
 v_cvt_pk_bf16_f32 v114, v142, v143
 buffer_store_dwordx4 v[112:115], v224, s[56:59], s9 offen offset:1024 sc0 sc1
 v_cvt_pk_bf16_f32 v116, v144, v145
 MF 92,136,224
 TR 206,45,28672
 TR 208,46,24576
 TR 210,46,28672
 MF 92,152,232
 v_cvt_pk_bf16_f32 v117, v146, v147
 v_cvt_pk_bf16_f32 v118, v196, v197
 buffer_store_dwordx4 v[116:119], v224, s[56:59], s9 offen offset:2048 sc0 sc1
 MF 156,152,236
 TR 212,47,24576
 TR 214,47,28672
 v_cvt_pk_bf16_f32 v120, v198, v199
 MF 156,136,228
 v_cvt_pk_bf16_f32 v121, v200, v201
 v_cvt_pk_bf16_f32 v122, v202, v203
 buffer_store_dwordx4 v[120:123], v224, s[56:59], s9 offen offset:3072 sc0 sc1
 MF 160,140,228
 v_cvt_pk_bf16_f32 v124, v204, v205
 v_cvt_pk_bf16_f32 v125, v206, v207
 v_cvt_pk_bf16_f32 v126, v208, v209
 MF 160,156,236
 buffer_store_dwordx4 v[124:127], v224, s[56:59], s10 offen offset:0 sc0 sc1
 v_cvt_pk_bf16_f32 v128, v210, v211
 MF 96,156,232
 buffer_store_dwordx4 v[128:131], v224, s[56:59], s10 offen offset:1024 sc0 sc1
 MF 96,140,224
 s_waitcnt lgkmcnt(0)
 MF 84,184,240
 TR 128,36,0
 TR 130,36,4096
 TR 132,37,0
 MF 84,200,248
 MF 148,200,252
 TR 134,37,4096
 TR 136,38,0
 TR 138,38,4096
 MF 148,184,244
 MF 152,188,244
 TR 140,39,0
 TR 142,39,4096
 MF 152,204,252
 MF 88,204,248
 TR 144,36,8192
 TR 146,36,12288
 TR 148,37,8192
 MF 88,188,240
 MF 92,192,240
 TR 150,37,12288
 TR 152,38,8192
 TR 154,38,12288
 MF 92,208,248
 MF 156,208,252
 TR 156,39,8192
 TR 158,39,12288
 MF 156,192,244
 MF 160,196,244
 MF 160,212,252
 MF 96,212,248
 MF 96,196,240
 s_waitcnt lgkmcnt(0)
 MF 84,128,32
 TR 184,36,16384
 TR 186,36,20480
 TR 188,37,16384
 MF 84,144,40
 MF 148,144,44
 TR 190,37,20480
 TR 192,38,16384
 TR 194,38,20480
 MF 148,128,36
 MF 152,132,36
 TR 196,39,16384
 TR 198,39,20480
 MF 152,148,44
 MF 88,148,40
 TR 200,36,24576
 TR 202,36,28672
 TR 204,37,24576
 MF 88,132,32
 MF 92,136,32
 TR 206,37,28672
 TR 208,38,24576
 TR 210,38,28672
 MF 92,152,40
 MF 156,152,44
 TR 212,39,24576
 TR 214,39,28672
 MF 156,136,36
 MF 160,140,36
 MF 160,156,44
 MF 96,156,40
 MF 96,140,32
 s_waitcnt lgkmcnt(0)
 MF 84,184,48
 TR 128,36,32768
 TR 130,36,36864
 TR 132,37,32768
 MF 84,200,56
 MF 148,200,60
 TR 134,37,36864
 TR 136,38,32768
 TR 138,38,36864
 MF 148,184,52
 MF 152,188,52
 TR 140,39,32768
 TR 142,39,36864
 MF 152,204,60
 MF 88,204,56
 TR 144,36,40960
 TR 146,36,45056
 TR 148,37,40960
 MF 88,188,48
 MF 92,192,48
 TR 150,37,45056
 TR 152,38,40960
 TR 154,38,45056
 MF 92,208,56
 MF 156,208,60
 TR 156,39,40960
 TR 158,39,45056
 MF 156,192,52
 MF 160,196,52
 MF 160,212,60
 MF 96,212,56
 MF 96,196,48
 s_waitcnt lgkmcnt(0)
 MF 84,128,0
 TR 184,36,49152
 TR 186,36,53248
 TR 188,37,49152
 MF 84,144,8
 MF 148,144,12
 TR 190,37,53248
 TR 192,38,49152
 TR 194,38,53248
 MF 148,128,4
 buffer_load_dwordx4 v[164:167], v224, s[56:59], s13 offen offset:0 sc0 sc1
 MF 152,132,4
 TR 196,39,49152
 TR 198,39,53248
 MF 152,148,12
 MF 88,148,8
 TR 200,36,57344
 TR 202,36,61440
 TR 204,37,57344
 MF 88,132,0
 MF 92,136,0
 TR 206,37,61440
 TR 208,38,57344
 TR 210,38,61440
 MF 92,152,8
 buffer_load_dwordx4 v[168:171], v224, s[56:59], s13 offen offset:1024 sc0 sc1
 MF 156,152,12
 TR 212,39,57344
 TR 214,39,61440
 MF 156,136,4
 MF 160,140,4
 MF 160,156,12
 buffer_load_dwordx4 v[172:175], v224, s[56:59], s13 offen offset:2048 sc0 sc1
 MF 96,156,8
 MF 96,140,0
 s_waitcnt lgkmcnt(0)
 MF 84,184,16
 s_branch L_sequential_preLN__sliding_local_dilated__geglu_ffn__prompt_kernel_pg19_skip
.p2align 12
L_sequential_preLN__sliding_local_dilated__geglu_ffn__prompt_kernel_pg19:
 s_branch L_sequential_preLN__sliding_local_dilated__geglu_ffn__prompt_kernel_hop5_ret
L_sequential_preLN__sliding_local_dilated__geglu_ffn__prompt_kernel_pg19b:
 s_branch L_sequential_preLN__sliding_local_dilated__geglu_ffn__prompt_kernel_sp_ret
L_sequential_preLN__sliding_local_dilated__geglu_ffn__prompt_kernel_pg19_skip:
 TR 128,44,32768
 TR 130,44,36864
 TR 132,45,32768
 MF 84,200,24
 MF 148,200,28
 TR 134,45,36864
 TR 136,46,32768
 TR 138,46,36864
 MF 148,184,20
 buffer_load_dwordx4 v[176:179], v224, s[56:59], s13 offen offset:3072 sc0 sc1
 MF 152,188,20
 TR 140,47,32768
 TR 142,47,36864
 MF 152,204,28
 MF 88,204,24
 TR 144,44,40960
 TR 146,44,45056
 TR 148,45,40960
 MF 88,188,16
 MF 92,192,16
 TR 150,45,45056
 TR 152,46,40960
 TR 154,46,45056
 MF 92,208,24
 buffer_load_dwordx4 v[180:183], v224, s[56:59], s14 offen offset:0 sc0 sc1
 MF 156,208,28
 TR 156,47,40960
 TR 158,47,45056
 MF 156,192,20
 MF 160,196,20
 MF 160,212,28
 buffer_load_dwordx4 v[184:187], v224, s[56:59], s14 offen offset:1024 sc0 sc1
 MF 96,212,24
 MF 96,196,16
 s_waitcnt lgkmcnt(0)
 MF 84,128,160
 TR 184,44,49152
 TR 186,44,53248
 TR 188,45,49152
 MF 84,144,168
 MF 148,144,172
 TR 190,45,53248
 TR 192,46,49152
 TR 194,46,53248
 MF 148,128,164
 MF 152,132,164
 TR 196,47,49152
 TR 198,47,53248
 MF 152,148,172
 MF 88,148,168
 TR 200,44,57344
 TR 202,44,61440
 TR 204,45,57344
 MF 88,132,160
 MF 92,136,160
 TR 206,45,61440
 TR 208,46,57344
 TR 210,46,61440
 MF 92,152,168
 MF 156,152,172
 TR 212,47,57344
 TR 214,47,61440
 MF 156,136,164
 MF 160,140,164
 MF 160,156,172
 MF 96,156,168
 MF 96,140,160
 s_waitcnt lgkmcnt(0)
 MF 84,184,176
 MF 84,200,216
 MF 148,200,220
 MF 148,184,180
 MF 152,188,180
 MF 152,204,220
 MF 88,204,216
 MF 88,188,176
 MF 92,192,176
 MF 92,208,216
 MF 156,208,220
 MF 156,192,180
 MF 160,196,180
 MF 160,212,220
 MF 96,212,216
 MF 96,196,176
 s_mov_b32 s52, s30
 s_mov_b32 s53, s31
 s_mov_b32 s54, 4194304
 s_mov_b32 s55, 0x00020000
 s_mov_b32 s47, 0x40000
 s_waitcnt vmcnt(0)
L_rx:
 v_xor_b32 v52, s96, v167
 v_xor_b32 v53, s96, v171
 v_xor_b32 v54, s96, v175
 v_xor_b32 v55, s96, v179
 v_xor_b32 v56, s96, v183
 v_xor_b32 v57, s96, v187
 v_or3_b32 v52, v52, v53, v54
 v_or3_b32 v55, v55, v56, v57
 v_or_b32 v52, v52, v55
 v_cmp_ne_u32 vcc, 0, v52
 s_nop 1
 s_cmp_eq_u64 vcc, 0
 s_cbranch_scc1 L_rx_ok
 s_sub_u32 s47, s47, 1
 s_cbranch_scc1 L_rx_ok
 buffer_load_dwordx4 v[164:167], v224, s[56:59], s13 offen offset:0 sc0 sc1
 buffer_load_dwordx4 v[168:171], v224, s[56:59], s13 offen offset:1024 sc0 sc1
 buffer_load_dwordx4 v[172:175], v224, s[56:59], s13 offen offset:2048 sc0 sc1
 buffer_load_dwordx4 v[176:179], v224, s[56:59], s13 offen offset:3072 sc0 sc1
 buffer_load_dwordx4 v[180:183], v224, s[56:59], s14 offen offset:0 sc0 sc1
 buffer_load_dwordx4 v[184:187], v224, s[56:59], s14 offen offset:1024 sc0 sc1
 s_waitcnt vmcnt(0)
 s_branch L_rx
L_rx_ok:
 v_lshlrev_b32 v100, 16, v164
 v_and_b32 v101, 0xffff0000, v164
 v_lshlrev_b32 v102, 16, v165
 v_and_b32 v103, 0xffff0000, v165
 v_lshlrev_b32 v104, 16, v166
 v_and_b32 v105, 0xffff0000, v166
 v_lshlrev_b32 v106, 16, v168
 v_and_b32 v107, 0xffff0000, v168
 v_lshlrev_b32 v140, 16, v169
 v_and_b32 v141, 0xffff0000, v169
 v_lshlrev_b32 v142, 16, v170
 v_and_b32 v143, 0xffff0000, v170
 v_lshlrev_b32 v144, 16, v172
 v_and_b32 v145, 0xffff0000, v172
 v_lshlrev_b32 v146, 16, v173
 v_and_b32 v147, 0xffff0000, v173
 v_lshlrev_b32 v196, 16, v174
 v_and_b32 v197, 0xffff0000, v174
 v_lshlrev_b32 v198, 16, v176
 v_and_b32 v199, 0xffff0000, v176
 v_lshlrev_b32 v200, 16, v177
 v_and_b32 v201, 0xffff0000, v177
 v_lshlrev_b32 v202, 16, v178
 v_and_b32 v203, 0xffff0000, v178
 v_lshlrev_b32 v204, 16, v180
 v_and_b32 v205, 0xffff0000, v180
 v_lshlrev_b32 v206, 16, v181
 v_and_b32 v207, 0xffff0000, v181
 v_lshlrev_b32 v208, 16, v182
 v_and_b32 v209, 0xffff0000, v182
 v_lshlrev_b32 v210, 16, v184
 v_and_b32 v211, 0xffff0000, v184
 s_lshl_b32 s9, s75, 15
 s_lshl_b32 s10, s73, 8
 s_add_u32 s9, s9, s10
 s_lshl_b32 s10, s74, 7
 s_add_u32 s9, s9, s10
 s_add_u32 s10, s9, 32768
 v_pk_add_f32 v[84:85], v[84:85], v[100:101]
 v_pk_add_f32 v[86:87], v[86:87], v[102:103]
 v_cvt_pk_bf16_f32 v0, v84, v85
 v_cvt_pk_bf16_f32 v1, v86, v87
 v_pk_add_f32 v[88:89], v[88:89], v[104:105]
 v_pk_add_f32 v[90:91], v[90:91], v[106:107]
 v_cvt_pk_bf16_f32 v2, v88, v89
 v_cvt_pk_bf16_f32 v3, v90, v91
 s_nop 0
 v_permlane16_swap_b32 v0, v2
 v_permlane16_swap_b32 v1, v3
 buffer_store_dwordx4 v[0:3], v20, s[52:55], s9 offen offset:0
 v_pk_add_f32 v[92:93], v[92:93], v[140:141]
 v_pk_add_f32 v[94:95], v[94:95], v[142:143]
 v_cvt_pk_bf16_f32 v4, v92, v93
 v_cvt_pk_bf16_f32 v5, v94, v95
 v_pk_add_f32 v[96:97], v[96:97], v[144:145]
 v_pk_add_f32 v[98:99], v[98:99], v[146:147]
 v_cvt_pk_bf16_f32 v6, v96, v97
 v_cvt_pk_bf16_f32 v7, v98, v99
 s_nop 0
 v_permlane16_swap_b32 v4, v6
 v_permlane16_swap_b32 v5, v7
 buffer_store_dwordx4 v[4:7], v20, s[52:55], s9 offen offset:64
 v_pk_add_f32 v[148:149], v[148:149], v[196:197]
 v_pk_add_f32 v[150:151], v[150:151], v[198:199]
 v_cvt_pk_bf16_f32 v8, v148, v149
 v_cvt_pk_bf16_f32 v9, v150, v151
 v_pk_add_f32 v[152:153], v[152:153], v[200:201]
 v_pk_add_f32 v[154:155], v[154:155], v[202:203]
 v_cvt_pk_bf16_f32 v10, v152, v153
 v_cvt_pk_bf16_f32 v11, v154, v155
 s_nop 0
 v_permlane16_swap_b32 v8, v10
 v_permlane16_swap_b32 v9, v11
 buffer_store_dwordx4 v[8:11], v20, s[52:55], s10 offen offset:0
 v_pk_add_f32 v[156:157], v[156:157], v[204:205]
 v_pk_add_f32 v[158:159], v[158:159], v[206:207]
 v_cvt_pk_bf16_f32 v12, v156, v157
 v_cvt_pk_bf16_f32 v13, v158, v159
 v_pk_add_f32 v[160:161], v[160:161], v[208:209]
 v_pk_add_f32 v[162:163], v[162:163], v[210:211]
 v_cvt_pk_bf16_f32 v14, v160, v161
 v_cvt_pk_bf16_f32 v15, v162, v163
 s_nop 0
 v_permlane16_swap_b32 v12, v14
 v_permlane16_swap_b32 v13, v15
 buffer_store_dwordx4 v[12:15], v20, s[52:55], s10 offen offset:64
L_sequential_preLN__sliding_local_dilated__geglu_ffn__prompt_kernel_end:
 s_endpgm
.set L_sequential_preLN__sliding_local_dilated__geglu_ffn__prompt_kernel_hop0_e0, L_sequential_preLN__sliding_local_dilated__geglu_ffn__prompt_kernel_pg0
.set L_sequential_preLN__sliding_local_dilated__geglu_ffn__prompt_kernel_hop0_e1, L_sequential_preLN__sliding_local_dilated__geglu_ffn__prompt_kernel_pg1
.set L_sequential_preLN__sliding_local_dilated__geglu_ffn__prompt_kernel_hop0_e2, L_sequential_preLN__sliding_local_dilated__geglu_ffn__prompt_kernel_pg2
.set L_sequential_preLN__sliding_local_dilated__geglu_ffn__prompt_kernel_hop0_e3, L_sequential_preLN__sliding_local_dilated__geglu_ffn__prompt_kernel_pg3
.set L_sequential_preLN__sliding_local_dilated__geglu_ffn__prompt_kernel_hop4_e0, L_sequential_preLN__sliding_local_dilated__geglu_ffn__prompt_kernel_pg8
.set L_sequential_preLN__sliding_local_dilated__geglu_ffn__prompt_kernel_hop4_e1, L_sequential_preLN__sliding_local_dilated__geglu_ffn__prompt_kernel_pg9
.set L_sequential_preLN__sliding_local_dilated__geglu_ffn__prompt_kernel_hop4_e2, L_sequential_preLN__sliding_local_dilated__geglu_ffn__prompt_kernel_pg10
.set L_sequential_preLN__sliding_local_dilated__geglu_ffn__prompt_kernel_hop4_e3, L_sequential_preLN__sliding_local_dilated__geglu_ffn__prompt_kernel_pg11
.set L_sequential_preLN__sliding_local_dilated__geglu_ffn__prompt_kernel_hop5_e0, L_sequential_preLN__sliding_local_dilated__geglu_ffn__prompt_kernel_pg12
.set L_sequential_preLN__sliding_local_dilated__geglu_ffn__prompt_kernel_hop5_e1, L_sequential_preLN__sliding_local_dilated__geglu_ffn__prompt_kernel_pg13
.set L_sequential_preLN__sliding_local_dilated__geglu_ffn__prompt_kernel_hop5_e2, L_sequential_preLN__sliding_local_dilated__geglu_ffn__prompt_kernel_pg14
.set L_sequential_preLN__sliding_local_dilated__geglu_ffn__prompt_kernel_hop5_e3, L_sequential_preLN__sliding_local_dilated__geglu_ffn__prompt_kernel_pg15
.set L_sequential_preLN__sliding_local_dilated__geglu_ffn__prompt_kernel_sp_e0, L_sequential_preLN__sliding_local_dilated__geglu_ffn__prompt_kernel_pg0b
.set L_sequential_preLN__sliding_local_dilated__geglu_ffn__prompt_kernel_sp_e1, L_sequential_preLN__sliding_local_dilated__geglu_ffn__prompt_kernel_pg1b
.set L_sequential_preLN__sliding_local_dilated__geglu_ffn__prompt_kernel_sp_e2, L_sequential_preLN__sliding_local_dilated__geglu_ffn__prompt_kernel_pg2b
.set L_sequential_preLN__sliding_local_dilated__geglu_ffn__prompt_kernel_sp_e3, L_sequential_preLN__sliding_local_dilated__geglu_ffn__prompt_kernel_pg3b
.set L_sequential_preLN__sliding_local_dilated__geglu_ffn__prompt_kernel_sp_e4, L_sequential_preLN__sliding_local_dilated__geglu_ffn__prompt_kernel_pg4b
.set L_sequential_preLN__sliding_local_dilated__geglu_ffn__prompt_kernel_sp_e5, L_sequential_preLN__sliding_local_dilated__geglu_ffn__prompt_kernel_pg5b
.set L_sequential_preLN__sliding_local_dilated__geglu_ffn__prompt_kernel_sp_e6, L_sequential_preLN__sliding_local_dilated__geglu_ffn__prompt_kernel_pg6b
.set L_sequential_preLN__sliding_local_dilated__geglu_ffn__prompt_kernel_sp_e7, L_sequential_preLN__sliding_local_dilated__geglu_ffn__prompt_kernel_pg7b
.set L_sequential_preLN__sliding_local_dilated__geglu_ffn__prompt_kernel_sp_e8, L_sequential_preLN__sliding_local_dilated__geglu_ffn__prompt_kernel_pg8b
.set L_sequential_preLN__sliding_local_dilated__geglu_ffn__prompt_kernel_sp_e9, L_sequential_preLN__sliding_local_dilated__geglu_ffn__prompt_kernel_pg9b
.set L_sequential_preLN__sliding_local_dilated__geglu_ffn__prompt_kernel_sp_e10, L_sequential_preLN__sliding_local_dilated__geglu_ffn__prompt_kernel_pg10b
.set L_sequential_preLN__sliding_local_dilated__geglu_ffn__prompt_kernel_sp_e11, L_sequential_preLN__sliding_local_dilated__geglu_ffn__prompt_kernel_pg11b
.set L_sequential_preLN__sliding_local_dilated__geglu_ffn__prompt_kernel_sp_e12, L_sequential_preLN__sliding_local_dilated__geglu_ffn__prompt_kernel_pg12b
.set L_sequential_preLN__sliding_local_dilated__geglu_ffn__prompt_kernel_sp_e13, L_sequential_preLN__sliding_local_dilated__geglu_ffn__prompt_kernel_pg13b
.set L_sequential_preLN__sliding_local_dilated__geglu_ffn__prompt_kernel_sp_e14, L_sequential_preLN__sliding_local_dilated__geglu_ffn__prompt_kernel_pg14b
.set L_sequential_preLN__sliding_local_dilated__geglu_ffn__prompt_kernel_sp_e15, L_sequential_preLN__sliding_local_dilated__geglu_ffn__prompt_kernel_pg15b
.set L_sequential_preLN__sliding_local_dilated__geglu_ffn__prompt_kernel_sp_e16, L_sequential_preLN__sliding_local_dilated__geglu_ffn__prompt_kernel_pg16b
.set L_sequential_preLN__sliding_local_dilated__geglu_ffn__prompt_kernel_sp_e17, L_sequential_preLN__sliding_local_dilated__geglu_ffn__prompt_kernel_pg17b
.set L_sequential_preLN__sliding_local_dilated__geglu_ffn__prompt_kernel_sp_e18, L_sequential_preLN__sliding_local_dilated__geglu_ffn__prompt_kernel_pg18b
.set L_sequential_preLN__sliding_local_dilated__geglu_ffn__prompt_kernel_sp_e19, L_sequential_preLN__sliding_local_dilated__geglu_ffn__prompt_kernel_pg19b
.set L_sequential_preLN__sliding_local_dilated__geglu_ffn__prompt_kernel_sp_e20, L_sequential_preLN__sliding_local_dilated__geglu_ffn__prompt_kernel_pg0b
.set L_sequential_preLN__sliding_local_dilated__geglu_ffn__prompt_kernel_sp_e21, L_sequential_preLN__sliding_local_dilated__geglu_ffn__prompt_kernel_pg1b
.set L_sequential_preLN__sliding_local_dilated__geglu_ffn__prompt_kernel_sp_e22, L_sequential_preLN__sliding_local_dilated__geglu_ffn__prompt_kernel_pg2b
.set L_sequential_preLN__sliding_local_dilated__geglu_ffn__prompt_kernel_sp_e23, L_sequential_preLN__sliding_local_dilated__geglu_ffn__prompt_kernel_pg3b
.set L_sequential_preLN__sliding_local_dilated__geglu_ffn__prompt_kernel_sp_e24, L_sequential_preLN__sliding_local_dilated__geglu_ffn__prompt_kernel_pg4b
.set L_sequential_preLN__sliding_local_dilated__geglu_ffn__prompt_kernel_sp_e25, L_sequential_preLN__sliding_local_dilated__geglu_ffn__prompt_kernel_pg5b
.set L_sequential_preLN__sliding_local_dilated__geglu_ffn__prompt_kernel_sp_e26, L_sequential_preLN__sliding_local_dilated__geglu_ffn__prompt_kernel_pg6b
.set L_sequential_preLN__sliding_local_dilated__geglu_ffn__prompt_kernel_sp_e27, L_sequential_preLN__sliding_local_dilated__geglu_ffn__prompt_kernel_pg7b
.set L_sequential_preLN__sliding_local_dilated__geglu_ffn__prompt_kernel_sp_e28, L_sequential_preLN__sliding_local_dilated__geglu_ffn__prompt_kernel_pg8b
.set L_sequential_preLN__sliding_local_dilated__geglu_ffn__prompt_kernel_sp_e29, L_sequential_preLN__sliding_local_dilated__geglu_ffn__prompt_kernel_pg9b
.set L_sequential_preLN__sliding_local_dilated__geglu_ffn__prompt_kernel_sp_e30, L_sequential_preLN__sliding_local_dilated__geglu_ffn__prompt_kernel_pg10b
.set L_sequential_preLN__sliding_local_dilated__geglu_ffn__prompt_kernel_sp_e31, L_sequential_preLN__sliding_local_dilated__geglu_ffn__prompt_kernel_pg11b
.section .rodata,"a"
.p2align 6
.amdhsa_kernel sequential_preLN__sliding_local_dilated__geglu_ffn__prompt_kernel
  .amdhsa_next_free_vgpr 512
  .amdhsa_next_free_sgpr 102
  .amdhsa_accum_offset 256
  .amdhsa_group_segment_fixed_size 0
  .amdhsa_kernarg_size 80
  .amdhsa_user_sgpr_count 2
  .amdhsa_user_sgpr_kernarg_segment_ptr 1
  .amdhsa_system_sgpr_workgroup_id_x 1
  .amdhsa_float_denorm_mode_32 3
  .amdhsa_float_denorm_mode_16_64 3
.end_amdhsa_kernel
```
